```python
import torch

def _softmax(x, axis=-1):
    return torch.softmax(x, dim=axis)

def _gelu(x):
    return torch.nn.functional.gelu(x, approximate='tanh')

def _silu(x):
    return torch.nn.functional.silu(x)

def _sigmoid(x):
    return torch.sigmoid(x)

def _layernorm(x, axis=-1, eps=1e-05):
    m = x.mean(dim=axis, keepdim=True)
    v = x.var(dim=axis, keepdim=True, unbiased=False)
    return (x - m) / torch.sqrt(v + eps)

def _scatter_add(tgt, idx, src, axis=0):
    return tgt.clone().index_add_(axis, idx, src)

def _segment_sum(src, seg, n):
    out = torch.zeros((n,) + src.shape[1:], dtype=src.dtype)
    return out.index_add_(0, seg, src)

def _pad(x, pw):
    flat = tuple((v for pair in reversed(pw) for v in pair))
    return torch.nn.functional.pad(x, flat)
kernel_name = 'adaLN_cond__ssm_conv_s4d__glu_gated_glu__prompt'

def setup_inputs():

    _w = lambda a: (lambda t: t.to(torch.bfloat16) if t.is_floating_point() else t)(torch.as_tensor(a))

    def _A_setup():
        Bsz, L, D, N = (1, 2048, 512, 128)
        return {'u': _w((lambda *s: torch.randn(*s, dtype=torch.bfloat16) * 0.05)(Bsz, L, D)), 'log_A_real': _w((lambda *s: torch.randn(*s, dtype=torch.bfloat16) * 3.2)(D, N) * 0.5), 'A_imag': _w((lambda *s: torch.randn(*s, dtype=torch.bfloat16) * 0.1)(D, N) * 3.14), 'C_real': _w((lambda *s: torch.randn(*s, dtype=torch.bfloat16) * 0.8)(D, N) / N ** 0.5), 'C_imag': _w((lambda *s: torch.randn(*s, dtype=torch.bfloat16) * 0.8)(D, N) / N ** 0.5), 'log_dt': _w((lambda *s: torch.randn(*s, dtype=torch.bfloat16) * 0.1)(D) * 0.5 - 4.0), 'D_skip': _w((lambda *s: torch.randn(*s, dtype=torch.bfloat16) * 0.1)(D))}
    _A_in = _A_setup()

    def _B_setup():
        B, S, D, F = (1, 2048, 512, 1376)
        return {'x': _w((lambda *s: torch.randn(*s, dtype=torch.bfloat16) * 0.05)(B, S, D)), 'w_gate': _w((lambda *s: torch.randn(*s, dtype=torch.bfloat16) * 0.1)(D, F)), 'w_up': _w((lambda *s: torch.randn(*s, dtype=torch.bfloat16) * 0.05)(D, F)), 'w_down': _w((lambda *s: torch.randn(*s, dtype=torch.bfloat16) * 0.05)(F, D))}
    _B_in = _B_setup()
    return {'A_u': _A_in['u'], 'A_log_A_real': _A_in['log_A_real'], 'A_A_imag': _A_in['A_imag'], 'A_C_real': _A_in['C_real'], 'A_C_imag': _A_in['C_imag'], 'A_log_dt': _A_in['log_dt'], 'A_D_skip': _A_in['D_skip'], 'B_x': _B_in['x'], 'B_w_gate': _B_in['w_gate'], 'B_w_up': _B_in['w_up'], 'B_w_down': _B_in['w_down'], 'c': _w((lambda *s: torch.randn(*s, dtype=torch.bfloat16) * 0.4)(1, 512) * 8.0), 'w_mod': _w((lambda *s: torch.randn(*s, dtype=torch.bfloat16) * 0.4)(512, 6 * 512) * 512 ** (-0.5) * 8.0)}

def reference(A_u, A_log_A_real, A_A_imag, A_C_real, A_C_imag, A_log_dt, A_D_skip, B_x, B_w_gate, B_w_up, B_w_down, c, w_mod):

    def _A_ref(u, log_A_real, A_imag, C_real, C_imag, log_dt, D_skip):
        L = u.shape[1]
        dt = torch.exp(log_dt)
        A = -torch.exp(log_A_real) + 1j * A_imag
        C = (C_real + 1j * C_imag) * dt[:, None]
        pos = (lambda x, dt: x.to(dt))(torch.arange(L), log_dt.dtype)
        P = torch.exp((A * dt[:, None])[:, :, None] * pos[None, None, :])
        K = 2.0 * torch.einsum('dn,dnl->dl', C, P).real
        L2 = 2 * L
        u_t = (lambda x, *d: x.permute(*d))(u, 0, 2, 1)
        Kf = (lambda x, *a, **k: torch.fft.rfft(x.float(), *a, **k))(K, L2)
        Uf = (lambda x, *a, **k: torch.fft.rfft(x.float(), *a, **k))(u_t, L2)
        y = (lambda x, *a, **k: torch.fft.irfft(x, *a, **k).to(torch.bfloat16))(Uf * Kf[None, :, :], L2)[:, :, :L]
        y = (lambda x, *d: x.permute(*d))(y, 0, 2, 1)
        return y + u * D_skip[None, None, :]

    def _B_ref(x, w_gate, w_up, w_down):
        g = torch.einsum('bsd,df->bsf', x, w_gate)
        u = torch.einsum('bsd,df->bsf', x, w_up)
        h = _sigmoid(g) * u
        return torch.einsum('bsf,fd->bsd', h, w_down)
    x = A_u
    mod = (_silu(c) @ w_mod).reshape(c.shape[0], 6, 1, -1)
    sa, ca, ga, sb, cb, gb = (mod[:, 0].clone(), mod[:, 1].clone(), mod[:, 2].clone(), mod[:, 3].clone(), mod[:, 4].clone(), mod[:, 5].clone())
    h = _layernorm(x, axis=-1) * (1 + ca) + sa
    x = x + ga * _A_ref(h, A_log_A_real, A_A_imag, A_C_real, A_C_imag, A_log_dt, A_D_skip)
    h = _layernorm(x, axis=-1) * (1 + cb) + sb
    x = x + gb * _B_ref(h, B_w_gate, B_w_up, B_w_down)
    return x
```

```asm
; @launch grid=(256,1,1) block=(256,1,1) lds=163840
.amdgcn_target "amdgcn-amd-amdhsa--gfx950"
.text
.globl adaLN_cond__ssm_conv_s4d__glu_gated_glu__prompt_kernel
.p2align 8
.type adaLN_cond__ssm_conv_s4d__glu_gated_glu__prompt_kernel,@function
adaLN_cond__ssm_conv_s4d__glu_gated_glu__prompt_kernel:
    s_cmp_ge_u32 s2, 256
    s_cbranch_scc1 L_exit
    s_load_dwordx16 s[4:19], s[0:1], 0
    s_load_dwordx16 s[20:35], s[0:1], 64
    s_getpc_b64 s[64:65]
L_pc:
    v_lshrrev_b32 v1, 6, v0
    v_lshlrev_b32 v2, 2, v0
    v_readfirstlane_b32 s3, v1
    v_and_b32 v0, 63, v0
    s_and_b32 s56, s2, 7
    s_lshr_b32 s57, s2, 3
    s_xor_b32 s57, s57, 31
    s_mov_b32 s66, code_hot_end-L_pc
    s_mov_b32 s67, 0x20000
    s_lshl_b32 s61, s2, 2
    s_add_u32 s61, s61, s3
    s_cmp_eq_u32 s61, 30
    s_cselect_b32 s66, 0, s66
    s_lshl_b32 s61, s57, 10
    buffer_load_dword v46, v2, s[64:67], s61 offen
    s_add_u32 s61, s61, 0x8000
    buffer_load_dword v47, v2, s[64:67], s61 offen
    s_lshl_b32 s58, s56, 5
    s_add_u32 s58, s58, s57
    v_lshrrev_b32 v6, 3, v0
    v_and_b32 v7, 7, v0
    s_lshl_b32 s61, s58, 9
    s_lshl_b32 s62, s3, 7
    s_add_u32 s61, s61, s62
    v_lshl_add_u32 v58, v0, 1, s61
    s_lshr_b32 s68, s3, 1
    s_and_b32 s69, s3, 1
    s_lshl_b32 s70, s58, 1
    s_add_u32 s70, s70, s68
    s_lshl_b32 s61, s70, 1
    v_mov_b32 v59, s61
    v_mov_b32 v40, 0
    v_mov_b32 v41, 0
    v_mov_b32 v42, 0
    v_mov_b32 v43, 0
    v_mov_b32 v44, 0
    v_mov_b32 v45, 0
    v_lshlrev_b32 v3, 10, v6
    v_lshl_add_u32 v227, v7, 4, v3
    v_mov_b32 v255, 1
    s_cmp_ge_u32 s3, 2
    s_cbranch_scc1 L_gload
    s_cmp_eq_u32 s3, 1
    s_cbranch_scc1 L_sload
    s_lshr_b32 s61, s58, 3
    s_and_b32 s62, s58, 7
    s_lshl_b32 s63, s61, 16
    s_lshl_b32 s36, s62, 7
    s_add_u32 s63, s63, s36
    v_add_u32 v3, s63, v227
    s_mov_b32 m0, 125952
    s_waitcnt lgkmcnt(0)
    global_load_short_d16_hi v40, v59, s[14:15]
    global_load_short_d16_hi v41, v58, s[6:7]
    global_load_short_d16_hi v42, v58, s[8:9]
    global_load_short_d16_hi v44, v58, s[10:11]
    global_load_short_d16_hi v45, v58, s[12:13]
    global_load_short_d16_hi v43, v59, s[16:17]
    global_load_lds_dwordx4 v3, s[4:5]
    s_add_u32 m0, m0, 1056
    v_add_u32 v3, 8192, v3
    global_load_lds_dwordx4 v3, s[4:5]
    s_add_u32 m0, m0, 1056
    v_add_u32 v3, 8192, v3
    global_load_lds_dwordx4 v3, s[4:5]
    s_add_u32 m0, m0, 1056
    v_add_u32 v3, 8192, v3
    global_load_lds_dwordx4 v3, s[4:5]
    s_add_u32 m0, m0, 1056
    v_add_u32 v3, 8192, v3
    global_load_lds_dwordx4 v3, s[4:5]
    s_add_u32 m0, m0, 1056
    v_add_u32 v3, 8192, v3
    global_load_lds_dwordx4 v3, s[4:5]
    s_add_u32 m0, m0, 1056
    v_add_u32 v3, 8192, v3
    global_load_lds_dwordx4 v3, s[4:5]
    s_add_u32 m0, m0, 1056
    v_add_u32 v3, 8192, v3
    global_load_lds_dwordx4 v3, s[4:5]
    s_branch L_loaded
L_sload:
    s_lshl_b32 s63, s58, 13
    v_add_u32 v3, s63, v227
    s_waitcnt lgkmcnt(0)
    global_load_short_d16_hi v40, v59, s[14:15]
    global_load_short_d16_hi v41, v58, s[6:7]
    global_load_short_d16_hi v42, v58, s[8:9]
    global_load_short_d16_hi v44, v58, s[10:11]
    global_load_short_d16_hi v45, v58, s[12:13]
    global_load_short_d16_hi v43, v59, s[16:17]
    global_load_dwordx4 v[8:11], v3, s[4:5] offset:0
    global_load_dwordx4 v[12:15], v3, s[4:5] offset:128
    global_load_dwordx4 v[16:19], v3, s[4:5] offset:256
    global_load_dwordx4 v[20:23], v3, s[4:5] offset:384
    global_load_dwordx4 v[24:27], v3, s[4:5] offset:512
    global_load_dwordx4 v[28:31], v3, s[4:5] offset:640
    global_load_dwordx4 v[32:35], v3, s[4:5] offset:768
    global_load_dwordx4 v[36:39], v3, s[4:5] offset:896
    s_branch L_loaded
L_gload:
    s_cmp_ge_u32 s57, 24
    s_cbranch_scc1 L_idle
    s_mul_i32 s61, s56, 24
    s_add_u32 s61, s61, s57
    s_and_b32 s62, s61, 3
    s_lshl_b32 s62, s62, 1
    s_add_u32 s62, s62, s69
    s_lshr_b32 s61, s61, 2
    s_lshl_b32 s63, s62, 7
    v_lshl_add_u32 v60, v0, 1, s63
    s_mul_i32 s63, s62, 393216
    s_lshl_b32 s36, s61, 7
    s_add_u32 s63, s63, s36
    s_add_u32 s63, s63, 3072
    v_mul_u32_u24 v3, 49152, v6
    v_lshl_add_u32 v3, v7, 4, v3
    v_add_u32 v3, s63, v3
    v_mov_b32 v68, 0
    s_waitcnt lgkmcnt(0)
    global_load_short_d16_hi v68, v60, s[26:27]
    global_load_short_d16_hi v40, v59, s[14:15]
    global_load_short_d16_hi v41, v58, s[6:7]
    global_load_short_d16_hi v42, v58, s[8:9]
    global_load_short_d16_hi v44, v58, s[10:11]
    global_load_short_d16_hi v45, v58, s[12:13]
    global_load_short_d16_hi v43, v59, s[16:17]
    global_load_dwordx4 v[8:11], v3, s[28:29] offset:-3072
    global_load_dwordx4 v[12:15], v3, s[28:29] offset:3072
    v_add_u32 v3, 12288, v3
    global_load_dwordx4 v[16:19], v3, s[28:29] offset:-3072
    global_load_dwordx4 v[20:23], v3, s[28:29] offset:3072
    v_add_u32 v3, 12288, v3
    global_load_dwordx4 v[24:27], v3, s[28:29] offset:-3072
    global_load_dwordx4 v[28:31], v3, s[28:29] offset:3072
    v_add_u32 v3, 12288, v3
    global_load_dwordx4 v[32:35], v3, s[28:29] offset:-3072
    global_load_dwordx4 v[36:39], v3, s[28:29] offset:3072
    s_branch L_loaded
L_idle:
    s_cmp_lg_u32 s3, 2
    s_cbranch_scc1 L_idle2
    s_cmp_eq_u32 s2, 7
    s_cbranch_scc1 L_init1
    s_sub_u32 s61, s2, 8
    s_cmp_ge_u32 s61, 12
    s_cbranch_scc1 L_idle2
    s_lshl_b32 s61, s61, 14
    s_add_u32 s61, s61, 4980736
    v_lshl_add_u32 v3, v0, 8, s61
    s_waitcnt lgkmcnt(0)
    global_store_dword v3, v40, s[34:35] sc1
    s_branch L_idle2
L_init1:
    v_lshlrev_b32 v3, 8, v0
    v_add_u32 v3, 5242880, v3
    v_add_u32 v8, 0x4000, v3
    s_waitcnt lgkmcnt(0)
    global_store_dword v3, v40, s[34:35] sc1
    v_mov_b32 v8, 0
    global_load_short_d16_hi v40, v59, s[14:15]
    global_load_short_d16_hi v41, v58, s[6:7]
    global_load_short_d16_hi v42, v58, s[8:9]
    global_load_short_d16_hi v44, v58, s[10:11]
    global_load_short_d16_hi v45, v58, s[12:13]
    global_load_short_d16_hi v43, v59, s[16:17]
    s_waitcnt vmcnt(6)
    s_mov_b64 exec, 1
    global_store_dword v8, v255, s[32:33] sc1
    s_mov_b64 exec, -1
    s_branch L_loaded
L_idle2:
    s_waitcnt lgkmcnt(0)
    global_load_short_d16_hi v40, v59, s[14:15]
    global_load_short_d16_hi v41, v58, s[6:7]
    global_load_short_d16_hi v42, v58, s[8:9]
    global_load_short_d16_hi v44, v58, s[10:11]
    global_load_short_d16_hi v45, v58, s[12:13]
    global_load_short_d16_hi v43, v59, s[16:17]
L_loaded:
    v_and_b32 v4, 15, v0
    v_lshrrev_b32 v5, 4, v0
    v_lshlrev_b32 v1, 4, v0
    v_lshlrev_b32 v2, 2, v0
    v_mov_b32 v254, 0
    v_mov_b32 v255, 1
    v_lshrrev_b32 v54, 5, v0
    v_bfe_u32 v48, v0, 2, 2
    v_and_b32 v49, 3, v0
    v_and_b32 v55, 1, v0
    v_bfe_u32 v56, v0, 3, 1
    v_lshlrev_b32 v57, 8, v5
    s_mul_i32 s71, s68, 34816
    s_lshl_b32 s51, s69, 8
    s_add_u32 s79, s51, s71
    v_lshrrev_b32 v50, 1, v48
    s_cmp_eq_u32 s69, 0
    s_cselect_b32 s36, 4, 2
    s_cselect_b32 s37, 16, 32
    s_cselect_b32 s38, 2, 3
    s_cselect_b32 s39, 41, 51
    v_mad_u32_u24 v51, v48, s36, v49
    v_add_u32 v51, s37, v51
    s_xor_b32 s36, s69, 1
    v_mad_u32_u24 v52, v48, s38, v49
    v_mad_u32_u24 v52, v50, s36, v52
    v_add_u32 v52, s39, v52
    v_lshl_add_u32 v53, v5, 4, s71
    s_movk_i32 s36, 544
    v_mad_u32_u24 v236, v51, s36, v53
    v_mad_u32_u24 v237, v52, s36, v53
    v_mad_u32_u24 v238, v4, s36, v53
    s_mul_i32 s75, s68, 16640
    s_add_u32 s36, s75, 69664
    v_lshl_add_u32 v239, v4, 5, s36
    s_lshl_b32 s76, s3, 10
    s_add_u32 s36, s76, 69656
    v_add_u32 v235, s36, v1
    v_sub_u32 v51, 3, v49
    v_mul_u32_u24 v51, 4160, v51
    v_lshl_add_u32 v51, v48, 3, v51
    v_lshlrev_b32 v52, 4, v5
    v_sub_u32 v51, v51, v52
    s_add_u32 s36, s75, s51
    s_add_u32 s36, s36, 69688
    v_add_u32 v243, s36, v51
    v_lshl_add_u32 v51, v4, 5, v52
    s_mul_i32 s36, s68, 4608
    s_sub_u32 s36, s36, s51
    s_add_u32 s36, s36, 103200
    v_add_u32 v244, s36, v51
    v_mov_b32 v228, 2146435072
    s_movk_i32 s36, 2704
    v_mul_u32_u24 v51, 171, v0
    v_lshrrev_b32 v51, 9, v51
    v_mad_u32_u24 v229, v51, s36, v1
    v_add_u32 v230, 44032, v229
    s_mov_b64 s[44:45], s[20:21]
    s_mov_b64 s[64:65], s[22:23]
    s_mov_b64 s[36:37], s[34:35]
    s_mov_b64 s[40:41], s[30:31]
    s_mov_b64 s[52:53], s[24:25]
    s_mov_b32 s38, 17825792
    s_mov_b32 s39, 0x20000
    s_mov_b32 s42, 2097152
    s_mov_b32 s43, 0x20000
    s_mov_b32 s46, 1409024
    s_mov_b32 s47, 0x20000
    s_mov_b32 s54, 1409024
    s_mov_b32 s55, 0x20000
    s_mov_b32 s66, 1409024
    s_mov_b32 s67, 0x20000
    s_mov_b32 s72, 0x05040100
    s_mov_b32 s73, 0x07060302
    s_mov_b32 s74, 0x3f803f80
    s_mov_b32 m0, s79
    v_mov_b32 v60, 0
    v_mov_b32 v61, 0
    v_mov_b32 v62, 0
    v_mov_b32 v63, 0
    v_mul_u32_u24 v52, 4096, v54
    s_mov_b32 s4, 102912
    v_add3_u32 v52, v52, v1, s4
    v_lshrrev_b32 v53, 1, v4
    v_mul_u32_u24 v53, 4128, v53
    v_lshl_add_u32 v53, v4, 4, v53
    v_add_u32 v53, 69632, v53
    ds_write_b128 v52, v[60:63]
    ds_write_b128 v53, v[60:63]
    v_lshrrev_b32 v51, 2, v0
    v_mul_u32_u24 v51, 48, v51
    v_bfe_u32 v52, v0, 1, 1
    v_mul_u32_u24 v52, 1520, v52
    v_lshl_add_u32 v52, v49, 3, v52
    s_mul_i32 s31, s3, 3072
    s_add_u32 s31, s31, 112128
    v_add3_u32 v233, v51, v52, s31
    v_bfe_u32 v58, v0, 1, 2
    v_lshl_add_u32 v51, v58, 2, v55
    v_lshl_add_u32 v51, v56, 1, v51
    v_lshl_add_u32 v232, v51, 4, v57
    v_lshlrev_b32 v51, 10, v5
    v_lshl_add_u32 v51, v48, 7, v51
    v_lshl_add_u32 v51, v49, 3, v51
    s_lshl_b32 s4, s3, 5
    s_add_u32 s4, s4, 135168
    v_add_u32 v226, s4, v51
    v_bfe_u32 v51, v0, 1, 3
    v_lshl_add_u32 v51, v51, 4, v57
    v_lshl_add_u32 v234, v55, 10, v51
    s_and_b32 s50, s58, 7
    s_mul_i32 s51, s50, 180224
    s_lshl_b32 s50, s50, 7
    s_lshr_b32 s4, s58, 3
    s_lshl_b32 s4, s4, 12
    s_add_u32 s51, s51, s4
    s_lshl_b32 s4, s68, 11
    s_add_u32 s51, s51, s4
    s_lshl_b32 s4, s69, 7
    s_add_u32 s51, s51, s4
    s_add_u32 s51, s51, 5505024
    s_mov_b32 s48, 0
    s_lshl_b32 s4, s3, 11
    s_add_u32 s24, s4, 4718592
    s_add_u32 s25, s24, 8192
    s_lshl_b32 s4, s3, 9
    s_mul_i32 s5, s58, 8448
    s_add_u32 s26, s4, s5
    s_add_u32 s27, s26, 4224
    v_mul_u32_u24 v51, 12288, v7
    v_lshl_add_u32 v240, v6, 11, v51
    s_lshl_b32 s13, s58, 3
    s_add_u32 s13, s13, 4734976
    v_cmp_eq_u32 vcc, 1, v6
    v_xor_b32 v51, 12, v2
    s_add_u32 s4, s4, 103424
    v_cndmask_b32 v241, 0, 1.0, vcc
    v_add_u32 v242, s4, v51
    s_mul_i32 s6, s70, 4224
    s_lshl_b32 s7, s69, 10
    s_add_u32 s6, s6, s7
    s_lshr_b32 s77, s58, 4
    s_and_b32 s78, s58, 3
    s_lshl_b32 s78, s78, 2
    s_add_u32 s78, s78, s3
    s_lshr_b32 s7, s58, 2
    s_and_b32 s12, s7, 3
    s_lshl_b32 s7, s7, 8
    s_add_u32 s7, s7, 5144576
    s_mul_i32 s9, s77, 11
    s_mul_i32 s11, s12, 3
    s_add_u32 s9, s9, s11
    s_mul_i32 s9, s9, 17408
    s_lshl_b32 s8, s78, 10
    s_add_u32 s8, s8, s9
    s_add_u32 s8, s8, 7077888
    s_add_u32 s9, s8, 17408
    s_add_u32 s10, s8, 34816
    s_cmp_eq_u32 s12, 3
    s_cselect_b32 s10, 2146435072, s10
    s_cselect_b32 s22, 0x00400040, 0
    s_mov_b32 s23, s22
    v_mov_b32 v248, s74
    s_mul_i32 s30, s78, 88064
    s_mul_i32 s4, s77, 172
    s_add_u32 s30, s30, s4
    s_lshl_b32 s11, s11, 4
    s_add_u32 s30, s30, s11
    s_mul_i32 s77, s58, 384
    s_add_u32 s77, s77, 4849664
    s_cmp_eq_u32 s3, 0
    s_cselect_b32 s77, s77, 2146435072
    v_lshlrev_b32 v51, 3, v4
    v_lshl_add_u32 v51, v5, 4, v51
    s_mul_i32 s4, s3, 384
    s_add_u32 s4, s4, 143360
    v_add_u32 v249, s4, v51
    v_add_u32 v231, 143360, v1
    v_sub_u32 v52, 1, v56
    v_cvt_f32_u32 v251, v52
    v_mul_u32_u24 v51, 12288, v5
    v_lshl_add_u32 v51, v7, 4, v51
    v_lshl_add_u32 v250, v52, 11, v51
    s_lshl_b32 s12, s78, 7
    s_add_u32 s12, s12, 4741120
    s_lshl_b32 s14, s3, 8
    s_add_u32 s14, s14, 124416
    v_lshl_add_u32 v51, v4, 4, s14
    v_lshl_add_u32 v252, v5, 2, v51
    v_lshl_add_u32 v253, v5, 4, s14
    s_mov_b32 s14, 0x00ff00ff
    s_mov_b32 s15, s14
    s_lshr_b32 s4, s58, 3
    s_lshl_b32 s4, s4, 2
    s_add_u32 s4, s4, s3
    s_mul_i32 s5, s4, 373
    s_lshr_b32 s5, s5, 12
    s_mul_i32 s63, s5, 11
    s_add_u32 s63, s63, 10
    s_cmp_eq_u32 s63, s4
    s_cselect_b32 s49, 0xffff0000, 0
    s_lshl_b32 s4, s4, 2
    s_sub_u32 s4, s4, s5
    s_lshl_b32 s4, s4, 11
    s_add_u32 s34, s4, s50
    v_cndmask_b32 v224, v227, v228, s[48:49]
    s_lshr_b32 s4, s58, 3
    s_lshl_b32 s4, s4, 2
    s_add_u32 s4, s4, s3
    s_add_u32 s4, s4, 128
    s_mul_i32 s5, s4, 373
    s_lshr_b32 s5, s5, 12
    s_mul_i32 s63, s5, 11
    s_add_u32 s63, s63, 10
    s_cmp_eq_u32 s63, s4
    s_cselect_b32 s49, 0xffff0000, 0
    s_lshl_b32 s4, s4, 2
    s_sub_u32 s4, s4, s5
    s_lshl_b32 s4, s4, 11
    s_add_u32 s35, s4, s50
    v_cndmask_b32 v225, v227, v228, s[48:49]
    v_mov_b32 v51, 0x3f80
    ds_write_addtid_b32 v51 offset:8704
    v_lshl_add_u32 v51, v5, 6, v1
    s_mul_i32 s4, s3, 5120
    v_add_u32 v245, s4, v51
    v_lshrrev_b32 v51, 5, v0
    v_mul_u32_u24 v51, 1280, v51
    v_and_b32 v52, 1, v0
    v_mul_u32_u24 v53, 640, v52
    v_bfe_u32 v58, v0, 1, 4
    v_lshl_add_u32 v51, v58, 4, v51
    s_mul_i32 s4, s68, 10240
    s_mul_i32 s5, s69, 2560
    s_add_u32 s4, s4, s5
    v_add3_u32 v246, s4, v51, v53
    v_bfe_u32 v53, v0, 1, 2
    s_and_b32 s4, s58, 3
    v_xor_b32 v53, s4, v53
    v_lshlrev_b32 v53, 5, v53
    v_lshl_add_u32 v52, v52, 4, v53
    s_mov_b32 s4, 66816
    v_mad_u32_u24 v247, v6, s4, v52
    s_lshl_b32 s4, s70, 7
    s_mul_i32 s5, s69, 534528
    s_add_u32 s4, s4, s5
    s_add_u32 s4, s4, 2359296
    s_add_u32 s5, s4, 1069056
    s_and_b32 s59, s56, 3
    s_lshl_b32 s59, s59, 2
    s_and_b32 s63, s57, 3
    s_add_u32 s59, s59, s63
    s_lshr_b32 s60, s56, 2
    s_lshl_b32 s60, s60, 3
    s_lshr_b32 s63, s57, 2
    s_add_u32 s60, s60, s63
    s_mul_i32 s28, s60, 11
    s_mul_i32 s63, s3, 3
    s_add_u32 s28, s28, s63
    s_lshl_b32 s29, s60, 2
    s_add_u32 s29, s29, s3
    s_lshl_b32 s29, s29, 8
    s_add_u32 s29, s29, 5144576
    s_cmp_lt_u32 s3, 2
    s_cbranch_scc1 L_busy
    s_cmp_lt_u32 s57, 24
    s_cbranch_scc1 L_busy
    s_waitcnt vmcnt(0)
L_busy:
    s_waitcnt vmcnt(13)
    v_mul_f32 v40, 0x3fb8aa3b, v40
    s_waitcnt vmcnt(12)
    v_mul_f32 v41, 0x3fb8aa3b, v41
    v_exp_f32 v40, v40
    v_exp_f32 v41, v41
    s_nop 0
    v_cvt_pk_bf16_f32 v41, v40, v41
    v_lshlrev_b32 v40, 16, v41
    v_and_b32 v41, 0xffff0000, v41
    v_mul_f32 v41, v41, v40
    s_waitcnt vmcnt(11)
    v_mul_f32 v42, v42, v40
    v_mul_f32 v41, 0xbfb8aa3b, v41
    v_mul_f32 v42, 0.15915494, v42
    v_mul_f32 v102, 0x43800000, v41
    v_mul_f32 v103, 0x43800000, v42
    v_exp_f32 v98, v41
    v_fract_f32 v99, v42
    v_exp_f32 v102, v102
    v_fract_f32 v103, v103
    v_cos_f32 v96, v99
    v_sin_f32 v97, v99
    v_cos_f32 v100, v103
    v_sin_f32 v101, v103
    v_add_f32 v40, v40, v40
    v_pk_mul_f32 v[96:97], v[96:97], v[98:99] op_sel_hi:[1,0]
    v_pk_mul_f32 v[100:101], v[100:101], v[102:103] op_sel_hi:[1,0]
    s_waitcnt vmcnt(9)
    v_pk_mul_f32 v[44:45], v[44:45], v[40:41] op_sel_hi:[1,0]
    v_cvt_pk_bf16_f32 v120, v96, v97
    v_pk_mul_f32 v[116:117], v[96:97], v[96:97] op_sel:[0,0] op_sel_hi:[0,1]
    v_pk_fma_f32 v[104:105], v[96:97], v[96:97], v[116:117] op_sel:[1,1,0] op_sel_hi:[1,0,1] neg_lo:[1,0,0]
    v_cvt_pk_bf16_f32 v121, v104, v105
    v_pk_mul_f32 v[116:117], v[104:105], v[96:97] op_sel:[0,0] op_sel_hi:[0,1]
    v_pk_fma_f32 v[112:113], v[104:105], v[96:97], v[116:117] op_sel:[1,1,0] op_sel_hi:[1,0,1] neg_lo:[1,0,0]
    v_cvt_pk_bf16_f32 v122, v112, v113
    v_pk_mul_f32 v[116:117], v[104:105], v[104:105] op_sel:[0,0] op_sel_hi:[0,1]
    v_pk_fma_f32 v[106:107], v[104:105], v[104:105], v[116:117] op_sel:[1,1,0] op_sel_hi:[1,0,1] neg_lo:[1,0,0]
    v_cvt_pk_bf16_f32 v123, v106, v107
    v_pk_mul_f32 v[116:117], v[106:107], v[96:97] op_sel:[0,0] op_sel_hi:[0,1]
    v_pk_fma_f32 v[112:113], v[106:107], v[96:97], v[116:117] op_sel:[1,1,0] op_sel_hi:[1,0,1] neg_lo:[1,0,0]
    v_cvt_pk_bf16_f32 v124, v112, v113
    v_pk_mul_f32 v[116:117], v[112:113], v[96:97] op_sel:[0,0] op_sel_hi:[0,1]
    v_pk_fma_f32 v[112:113], v[112:113], v[96:97], v[116:117] op_sel:[1,1,0] op_sel_hi:[1,0,1] neg_lo:[1,0,0]
    v_cvt_pk_bf16_f32 v125, v112, v113
    v_pk_mul_f32 v[116:117], v[112:113], v[96:97] op_sel:[0,0] op_sel_hi:[0,1]
    v_pk_fma_f32 v[112:113], v[112:113], v[96:97], v[116:117] op_sel:[1,1,0] op_sel_hi:[1,0,1] neg_lo:[1,0,0]
    v_cvt_pk_bf16_f32 v126, v112, v113
    v_pk_mul_f32 v[116:117], v[106:107], v[106:107] op_sel:[0,0] op_sel_hi:[0,1]
    v_pk_fma_f32 v[108:109], v[106:107], v[106:107], v[116:117] op_sel:[1,1,0] op_sel_hi:[1,0,1] neg_lo:[1,0,0]
    v_cvt_pk_bf16_f32 v127, v108, v109
    ds_write_addtid_b32 v120 offset:9248
    ds_write_addtid_b32 v121 offset:9792
    ds_write_addtid_b32 v122 offset:10336
    ds_write_addtid_b32 v123 offset:10880
    ds_write_addtid_b32 v124 offset:11424
    ds_write_addtid_b32 v125 offset:11968
    ds_write_addtid_b32 v126 offset:12512
    ds_write_addtid_b32 v127 offset:13056
    s_cmp_ge_u32 s3, 2
    s_cbranch_scc1 L_g
    s_cmp_eq_u32 s3, 1
    s_cbranch_scc1 L_s
    v_mul_u32_u24 v3, 1056, v7
    v_lshl_add_u32 v3, v6, 4, v3
    v_add_u32 v3, 125952, v3
    s_mul_i32 s62, s62, 270336
    s_lshl_b32 s61, s61, 7
    s_add_u32 s61, s61, s62
    s_add_u32 s61, s61, 0
    s_waitcnt vmcnt(0)
    ds_read_b128 v[8:11], v3 offset:0
    ds_read_b128 v[12:15], v3 offset:128
    ds_read_b128 v[16:19], v3 offset:256
    ds_read_b128 v[20:23], v3 offset:384
    ds_read_b128 v[24:27], v3 offset:512
    ds_read_b128 v[28:31], v3 offset:640
    ds_read_b128 v[32:35], v3 offset:768
    ds_read_b128 v[36:39], v3 offset:896
    v_mul_u32_u24 v3, 33792, v6
    v_lshl_add_u32 v3, v7, 4, v3
    s_waitcnt lgkmcnt(6)
    v_perm_b32 v48, v12, v8, s72
    s_waitcnt lgkmcnt(4)
    v_perm_b32 v49, v20, v16, s72
    s_waitcnt lgkmcnt(2)
    v_perm_b32 v50, v28, v24, s72
    s_waitcnt lgkmcnt(0)
    v_perm_b32 v51, v36, v32, s72
    s_waitcnt vmcnt(0)
    buffer_store_dwordx4 v[48:51], v3, s[36:39], s61 offen sc1
    s_add_u32 s61, s61, 4224
    v_perm_b32 v52, v12, v8, s73
    v_perm_b32 v53, v20, v16, s73
    v_perm_b32 v54, v28, v24, s73
    v_perm_b32 v55, v36, v32, s73
    buffer_store_dwordx4 v[52:55], v3, s[36:39], s61 offen sc1
    s_add_u32 s61, s61, 4224
    v_perm_b32 v56, v13, v9, s72
    v_perm_b32 v57, v21, v17, s72
    v_perm_b32 v58, v29, v25, s72
    v_perm_b32 v59, v37, v33, s72
    buffer_store_dwordx4 v[56:59], v3, s[36:39], s61 offen sc1
    s_add_u32 s61, s61, 4224
    v_perm_b32 v60, v13, v9, s73
    v_perm_b32 v61, v21, v17, s73
    v_perm_b32 v62, v29, v25, s73
    v_perm_b32 v63, v37, v33, s73
    buffer_store_dwordx4 v[60:63], v3, s[36:39], s61 offen sc1
    s_add_u32 s61, s61, 4224
    v_perm_b32 v48, v14, v10, s72
    v_perm_b32 v49, v22, v18, s72
    v_perm_b32 v50, v30, v26, s72
    v_perm_b32 v51, v38, v34, s72
    buffer_store_dwordx4 v[48:51], v3, s[36:39], s61 offen sc1
    s_add_u32 s61, s61, 4224
    v_perm_b32 v52, v14, v10, s73
    v_perm_b32 v53, v22, v18, s73
    v_perm_b32 v54, v30, v26, s73
    v_perm_b32 v55, v38, v34, s73
    buffer_store_dwordx4 v[52:55], v3, s[36:39], s61 offen sc1
    s_add_u32 s61, s61, 4224
    v_perm_b32 v56, v15, v11, s72
    v_perm_b32 v57, v23, v19, s72
    v_perm_b32 v58, v31, v27, s72
    v_perm_b32 v59, v39, v35, s72
    buffer_store_dwordx4 v[56:59], v3, s[36:39], s61 offen sc1
    s_add_u32 s61, s61, 4224
    v_perm_b32 v60, v15, v11, s73
    v_perm_b32 v61, v23, v19, s73
    v_perm_b32 v62, v31, v27, s73
    v_perm_b32 v63, v39, v35, s73
    buffer_store_dwordx4 v[60:63], v3, s[36:39], s61 offen sc1
    s_branch L_g
L_s:
    v_mov_b32 v48, 0
    v_mov_b32 v49, 0
    v_mov_b32 v50, 0
    v_mov_b32 v51, 0
    v_lshlrev_b32 v3, 3, v6
    s_lshl_b32 s61, s58, 6
    s_add_u32 s61, s61, 4718592
    s_waitcnt vmcnt(7)
    v_dot2c_f32_bf16 v48, s74, v8
    v_dot2c_f32_bf16 v49, v8, v8
    v_dot2c_f32_bf16 v50, s74, v9
    v_dot2c_f32_bf16 v51, v9, v9
    v_dot2c_f32_bf16 v48, s74, v10
    v_dot2c_f32_bf16 v49, v10, v10
    v_dot2c_f32_bf16 v50, s74, v11
    v_dot2c_f32_bf16 v51, v11, v11
    s_waitcnt vmcnt(6)
    v_dot2c_f32_bf16 v48, s74, v12
    v_dot2c_f32_bf16 v49, v12, v12
    v_dot2c_f32_bf16 v50, s74, v13
    v_dot2c_f32_bf16 v51, v13, v13
    v_dot2c_f32_bf16 v48, s74, v14
    v_dot2c_f32_bf16 v49, v14, v14
    v_dot2c_f32_bf16 v50, s74, v15
    v_dot2c_f32_bf16 v51, v15, v15
    s_waitcnt vmcnt(5)
    v_dot2c_f32_bf16 v48, s74, v16
    v_dot2c_f32_bf16 v49, v16, v16
    v_dot2c_f32_bf16 v50, s74, v17
    v_dot2c_f32_bf16 v51, v17, v17
    v_dot2c_f32_bf16 v48, s74, v18
    v_dot2c_f32_bf16 v49, v18, v18
    v_dot2c_f32_bf16 v50, s74, v19
    v_dot2c_f32_bf16 v51, v19, v19
    s_waitcnt vmcnt(4)
    v_dot2c_f32_bf16 v48, s74, v20
    v_dot2c_f32_bf16 v49, v20, v20
    v_dot2c_f32_bf16 v50, s74, v21
    v_dot2c_f32_bf16 v51, v21, v21
    v_dot2c_f32_bf16 v48, s74, v22
    v_dot2c_f32_bf16 v49, v22, v22
    v_dot2c_f32_bf16 v50, s74, v23
    v_dot2c_f32_bf16 v51, v23, v23
    s_waitcnt vmcnt(3)
    v_dot2c_f32_bf16 v48, s74, v24
    v_dot2c_f32_bf16 v49, v24, v24
    v_dot2c_f32_bf16 v50, s74, v25
    v_dot2c_f32_bf16 v51, v25, v25
    v_dot2c_f32_bf16 v48, s74, v26
    v_dot2c_f32_bf16 v49, v26, v26
    v_dot2c_f32_bf16 v50, s74, v27
    v_dot2c_f32_bf16 v51, v27, v27
    s_waitcnt vmcnt(2)
    v_dot2c_f32_bf16 v48, s74, v28
    v_dot2c_f32_bf16 v49, v28, v28
    v_dot2c_f32_bf16 v50, s74, v29
    v_dot2c_f32_bf16 v51, v29, v29
    v_dot2c_f32_bf16 v48, s74, v30
    v_dot2c_f32_bf16 v49, v30, v30
    v_dot2c_f32_bf16 v50, s74, v31
    v_dot2c_f32_bf16 v51, v31, v31
    s_waitcnt vmcnt(1)
    v_dot2c_f32_bf16 v48, s74, v32
    v_dot2c_f32_bf16 v49, v32, v32
    v_dot2c_f32_bf16 v50, s74, v33
    v_dot2c_f32_bf16 v51, v33, v33
    v_dot2c_f32_bf16 v48, s74, v34
    v_dot2c_f32_bf16 v49, v34, v34
    v_dot2c_f32_bf16 v50, s74, v35
    v_dot2c_f32_bf16 v51, v35, v35
    s_waitcnt vmcnt(0)
    v_dot2c_f32_bf16 v48, s74, v36
    v_dot2c_f32_bf16 v49, v36, v36
    v_dot2c_f32_bf16 v50, s74, v37
    v_dot2c_f32_bf16 v51, v37, v37
    v_dot2c_f32_bf16 v48, s74, v38
    v_dot2c_f32_bf16 v49, v38, v38
    v_dot2c_f32_bf16 v50, s74, v39
    v_dot2c_f32_bf16 v51, v39, v39
    s_nop 1
    v_add_f32 v48, v48, v50
    v_add_f32 v49, v49, v51
    s_nop 0
    v_add_f32_dpp v48, v48, v48 quad_perm:[1,0,3,2] row_mask:0xf bank_mask:0xf
    v_add_f32_dpp v49, v49, v49 quad_perm:[1,0,3,2] row_mask:0xf bank_mask:0xf
    s_nop 0
    v_add_f32_dpp v48, v48, v48 quad_perm:[2,3,0,1] row_mask:0xf bank_mask:0xf
    v_add_f32_dpp v49, v49, v49 quad_perm:[2,3,0,1] row_mask:0xf bank_mask:0xf
    s_nop 0
    v_add_f32_dpp v48, v48, v48 row_half_mirror row_mask:0xf bank_mask:0xf
    v_add_f32_dpp v49, v49, v49 row_half_mirror row_mask:0xf bank_mask:0xf
    v_mul_f32 v48, 0x3b000000, v48
    v_mul_f32 v49, 0x3b000000, v49
    v_fma_f32 v49, -v48, v48, v49
    v_max_f32 v49, 0, v49
    v_cvt_pk_bf16_f32 v49, v48, v49
    v_lshlrev_b32 v48, 16, v49
    v_and_b32 v49, 0xffff0000, v49
    v_add_f32 v49, 0x3727c5ac, v49
    v_cvt_pk_bf16_f32 v49, v49, v49
    v_lshlrev_b32 v49, 16, v49
    v_sqrt_f32 v49, v49
    s_nop 0
    v_cvt_pk_bf16_f32 v49, v49, v49
    v_lshlrev_b32 v49, 16, v49
    v_rcp_f32 v50, v49
    v_cmp_eq_u32 vcc, 0, v7
    v_mul_f32 v51, -v48, v50
    s_waitcnt vmcnt(0)
    s_mov_b64 exec, vcc
    buffer_store_dwordx2 v[50:51], v3, s[36:39], s61 offen sc1
    s_mov_b64 exec, -1
L_g:
    v_pk_mul_f32 v[116:117], v[108:109], v[96:97] op_sel:[0,0] op_sel_hi:[0,1]
    v_pk_fma_f32 v[112:113], v[108:109], v[96:97], v[116:117] op_sel:[1,1,0] op_sel_hi:[1,0,1] neg_lo:[1,0,0]
    v_cvt_pk_bf16_f32 v120, v112, v113
    v_pk_mul_f32 v[116:117], v[112:113], v[96:97] op_sel:[0,0] op_sel_hi:[0,1]
    v_pk_fma_f32 v[112:113], v[112:113], v[96:97], v[116:117] op_sel:[1,1,0] op_sel_hi:[1,0,1] neg_lo:[1,0,0]
    v_cvt_pk_bf16_f32 v121, v112, v113
    v_pk_mul_f32 v[116:117], v[112:113], v[96:97] op_sel:[0,0] op_sel_hi:[0,1]
    v_pk_fma_f32 v[112:113], v[112:113], v[96:97], v[116:117] op_sel:[1,1,0] op_sel_hi:[1,0,1] neg_lo:[1,0,0]
    v_cvt_pk_bf16_f32 v122, v112, v113
    v_pk_mul_f32 v[116:117], v[112:113], v[96:97] op_sel:[0,0] op_sel_hi:[0,1]
    v_pk_fma_f32 v[112:113], v[112:113], v[96:97], v[116:117] op_sel:[1,1,0] op_sel_hi:[1,0,1] neg_lo:[1,0,0]
    v_cvt_pk_bf16_f32 v123, v112, v113
    v_pk_mul_f32 v[116:117], v[112:113], v[96:97] op_sel:[0,0] op_sel_hi:[0,1]
    v_pk_fma_f32 v[112:113], v[112:113], v[96:97], v[116:117] op_sel:[1,1,0] op_sel_hi:[1,0,1] neg_lo:[1,0,0]
    v_cvt_pk_bf16_f32 v124, v112, v113
    v_pk_mul_f32 v[116:117], v[112:113], v[96:97] op_sel:[0,0] op_sel_hi:[0,1]
    v_pk_fma_f32 v[112:113], v[112:113], v[96:97], v[116:117] op_sel:[1,1,0] op_sel_hi:[1,0,1] neg_lo:[1,0,0]
    v_cvt_pk_bf16_f32 v125, v112, v113
    v_pk_mul_f32 v[116:117], v[112:113], v[96:97] op_sel:[0,0] op_sel_hi:[0,1]
    v_pk_fma_f32 v[112:113], v[112:113], v[96:97], v[116:117] op_sel:[1,1,0] op_sel_hi:[1,0,1] neg_lo:[1,0,0]
    v_cvt_pk_bf16_f32 v126, v112, v113
    v_pk_mul_f32 v[116:117], v[108:109], v[108:109] op_sel:[0,0] op_sel_hi:[0,1]
    v_pk_fma_f32 v[110:111], v[108:109], v[108:109], v[116:117] op_sel:[1,1,0] op_sel_hi:[1,0,1] neg_lo:[1,0,0]
    v_cvt_pk_bf16_f32 v127, v44, -v45
    ds_write_addtid_b32 v120 offset:13600
    ds_write_addtid_b32 v121 offset:14144
    ds_write_addtid_b32 v122 offset:14688
    ds_write_addtid_b32 v123 offset:15232
    ds_write_addtid_b32 v124 offset:15776
    ds_write_addtid_b32 v125 offset:16320
    ds_write_addtid_b32 v126 offset:16864
    ds_write_addtid_b32 v127 offset:0
    v_pk_mul_f32 v[116:117], v[44:45], v[110:111] op_sel:[0,0] op_sel_hi:[0,1]
    v_pk_fma_f32 v[44:45], v[44:45], v[110:111], v[116:117] op_sel:[1,1,0] op_sel_hi:[1,0,1] neg_lo:[1,0,0]
    v_cvt_pk_bf16_f32 v120, v44, -v45
    v_pk_mul_f32 v[116:117], v[44:45], v[110:111] op_sel:[0,0] op_sel_hi:[0,1]
    v_pk_fma_f32 v[44:45], v[44:45], v[110:111], v[116:117] op_sel:[1,1,0] op_sel_hi:[1,0,1] neg_lo:[1,0,0]
    v_cvt_pk_bf16_f32 v121, v44, -v45
    v_pk_mul_f32 v[116:117], v[44:45], v[110:111] op_sel:[0,0] op_sel_hi:[0,1]
    v_pk_fma_f32 v[44:45], v[44:45], v[110:111], v[116:117] op_sel:[1,1,0] op_sel_hi:[1,0,1] neg_lo:[1,0,0]
    v_cvt_pk_bf16_f32 v122, v44, -v45
    v_pk_mul_f32 v[116:117], v[44:45], v[110:111] op_sel:[0,0] op_sel_hi:[0,1]
    v_pk_fma_f32 v[44:45], v[44:45], v[110:111], v[116:117] op_sel:[1,1,0] op_sel_hi:[1,0,1] neg_lo:[1,0,0]
    v_cvt_pk_bf16_f32 v123, v44, -v45
    v_pk_mul_f32 v[116:117], v[44:45], v[110:111] op_sel:[0,0] op_sel_hi:[0,1]
    v_pk_fma_f32 v[44:45], v[44:45], v[110:111], v[116:117] op_sel:[1,1,0] op_sel_hi:[1,0,1] neg_lo:[1,0,0]
    v_cvt_pk_bf16_f32 v124, v44, -v45
    v_pk_mul_f32 v[116:117], v[44:45], v[110:111] op_sel:[0,0] op_sel_hi:[0,1]
    v_pk_fma_f32 v[44:45], v[44:45], v[110:111], v[116:117] op_sel:[1,1,0] op_sel_hi:[1,0,1] neg_lo:[1,0,0]
    v_cvt_pk_bf16_f32 v125, v44, -v45
    v_pk_mul_f32 v[116:117], v[44:45], v[110:111] op_sel:[0,0] op_sel_hi:[0,1]
    v_pk_fma_f32 v[44:45], v[44:45], v[110:111], v[116:117] op_sel:[1,1,0] op_sel_hi:[1,0,1] neg_lo:[1,0,0]
    v_cvt_pk_bf16_f32 v126, v44, -v45
    v_pk_mul_f32 v[116:117], v[44:45], v[110:111] op_sel:[0,0] op_sel_hi:[0,1]
    v_pk_fma_f32 v[44:45], v[44:45], v[110:111], v[116:117] op_sel:[1,1,0] op_sel_hi:[1,0,1] neg_lo:[1,0,0]
    v_cvt_pk_bf16_f32 v127, v44, -v45
    ds_write_addtid_b32 v120 offset:544
    ds_write_addtid_b32 v121 offset:1088
    ds_write_addtid_b32 v122 offset:1632
    ds_write_addtid_b32 v123 offset:2176
    ds_write_addtid_b32 v124 offset:2720
    ds_write_addtid_b32 v125 offset:3264
    ds_write_addtid_b32 v126 offset:3808
    ds_write_addtid_b32 v127 offset:4352
    v_pk_mul_f32 v[116:117], v[44:45], v[110:111] op_sel:[0,0] op_sel_hi:[0,1]
    v_pk_fma_f32 v[44:45], v[44:45], v[110:111], v[116:117] op_sel:[1,1,0] op_sel_hi:[1,0,1] neg_lo:[1,0,0]
    v_cvt_pk_bf16_f32 v120, v44, -v45
    v_pk_mul_f32 v[116:117], v[44:45], v[110:111] op_sel:[0,0] op_sel_hi:[0,1]
    v_pk_fma_f32 v[44:45], v[44:45], v[110:111], v[116:117] op_sel:[1,1,0] op_sel_hi:[1,0,1] neg_lo:[1,0,0]
    v_cvt_pk_bf16_f32 v121, v44, -v45
    v_pk_mul_f32 v[116:117], v[44:45], v[110:111] op_sel:[0,0] op_sel_hi:[0,1]
    v_pk_fma_f32 v[44:45], v[44:45], v[110:111], v[116:117] op_sel:[1,1,0] op_sel_hi:[1,0,1] neg_lo:[1,0,0]
    v_cvt_pk_bf16_f32 v122, v44, -v45
    v_pk_mul_f32 v[116:117], v[44:45], v[110:111] op_sel:[0,0] op_sel_hi:[0,1]
    v_pk_fma_f32 v[44:45], v[44:45], v[110:111], v[116:117] op_sel:[1,1,0] op_sel_hi:[1,0,1] neg_lo:[1,0,0]
    v_cvt_pk_bf16_f32 v123, v44, -v45
    v_pk_mul_f32 v[116:117], v[44:45], v[110:111] op_sel:[0,0] op_sel_hi:[0,1]
    v_pk_fma_f32 v[44:45], v[44:45], v[110:111], v[116:117] op_sel:[1,1,0] op_sel_hi:[1,0,1] neg_lo:[1,0,0]
    v_cvt_pk_bf16_f32 v124, v44, -v45
    v_pk_mul_f32 v[116:117], v[44:45], v[110:111] op_sel:[0,0] op_sel_hi:[0,1]
    v_pk_fma_f32 v[44:45], v[44:45], v[110:111], v[116:117] op_sel:[1,1,0] op_sel_hi:[1,0,1] neg_lo:[1,0,0]
    v_cvt_pk_bf16_f32 v125, v44, -v45
    v_pk_mul_f32 v[116:117], v[44:45], v[110:111] op_sel:[0,0] op_sel_hi:[0,1]
    v_pk_fma_f32 v[44:45], v[44:45], v[110:111], v[116:117] op_sel:[1,1,0] op_sel_hi:[1,0,1] neg_lo:[1,0,0]
    v_cvt_pk_bf16_f32 v126, v44, -v45
    ds_write_addtid_b32 v120 offset:4896
    ds_write_addtid_b32 v121 offset:5440
    ds_write_addtid_b32 v122 offset:5984
    ds_write_addtid_b32 v123 offset:6528
    ds_write_addtid_b32 v124 offset:7072
    ds_write_addtid_b32 v125 offset:7616
    ds_write_addtid_b32 v126 offset:8160
    s_cmp_lt_u32 s3, 2
    s_cbranch_scc1 L_wload
    s_cmp_ge_u32 s57, 24
    s_cbranch_scc1 L_wload
    v_mov_b32 v56, 0
    v_mov_b32 v57, 0
    v_mov_b32 v58, 0
    v_mov_b32 v59, 0
    v_mov_b32 v60, 0
    v_mov_b32 v61, 0
    v_mov_b32 v62, 0
    v_mov_b32 v63, 0
    v_lshlrev_b32 v3, 5, v6
    v_mul_f32 v48, 0xbfb8aa3b, v68
    v_exp_f32 v48, v48
    s_nop 0
    v_add_f32 v48, 1.0, v48
    v_min_f32 v48, 0x7f000000, v48
    v_rcp_f32 v49, v48
    s_nop 0
    v_mul_f32 v50, v68, v49
    v_fma_f32 v68, -v50, v48, v68
    v_fmac_f32 v50, v68, v49
    s_nop 1
    v_mov_b32_dpp v51, v50 quad_perm:[1,0,3,2] row_mask:0xf bank_mask:0xf
    v_cvt_pk_bf16_f32 v50, v50, v51
    ds_bpermute_b32 v64, v3, v50 offset:0
    ds_bpermute_b32 v65, v3, v50 offset:8
    ds_bpermute_b32 v66, v3, v50 offset:16
    ds_bpermute_b32 v67, v3, v50 offset:24
    s_waitcnt vmcnt(6)
    v_perm_b32 v48, v12, v8, s72
    v_perm_b32 v49, v12, v8, s73
    v_perm_b32 v50, v13, v9, s72
    v_perm_b32 v51, v13, v9, s73
    v_perm_b32 v52, v14, v10, s72
    v_perm_b32 v53, v14, v10, s73
    v_perm_b32 v54, v15, v11, s72
    v_perm_b32 v55, v15, v11, s73
    s_waitcnt lgkmcnt(3)
    v_dot2c_f32_bf16 v56, v48, v64
    v_dot2c_f32_bf16 v57, v49, v64
    v_dot2c_f32_bf16 v58, v50, v64
    v_dot2c_f32_bf16 v59, v51, v64
    v_dot2c_f32_bf16 v60, v52, v64
    v_dot2c_f32_bf16 v61, v53, v64
    v_dot2c_f32_bf16 v62, v54, v64
    v_dot2c_f32_bf16 v63, v55, v64
    s_waitcnt vmcnt(4)
    v_perm_b32 v48, v20, v16, s72
    v_perm_b32 v49, v20, v16, s73
    v_perm_b32 v50, v21, v17, s72
    v_perm_b32 v51, v21, v17, s73
    v_perm_b32 v52, v22, v18, s72
    v_perm_b32 v53, v22, v18, s73
    v_perm_b32 v54, v23, v19, s72
    v_perm_b32 v55, v23, v19, s73
    s_waitcnt lgkmcnt(2)
    v_dot2c_f32_bf16 v56, v48, v65
    v_dot2c_f32_bf16 v57, v49, v65
    v_dot2c_f32_bf16 v58, v50, v65
    v_dot2c_f32_bf16 v59, v51, v65
    v_dot2c_f32_bf16 v60, v52, v65
    v_dot2c_f32_bf16 v61, v53, v65
    v_dot2c_f32_bf16 v62, v54, v65
    v_dot2c_f32_bf16 v63, v55, v65
    s_waitcnt vmcnt(2)
    v_perm_b32 v48, v28, v24, s72
    v_perm_b32 v49, v28, v24, s73
    v_perm_b32 v50, v29, v25, s72
    v_perm_b32 v51, v29, v25, s73
    v_perm_b32 v52, v30, v26, s72
    v_perm_b32 v53, v30, v26, s73
    v_perm_b32 v54, v31, v27, s72
    v_perm_b32 v55, v31, v27, s73
    s_waitcnt lgkmcnt(1)
    v_dot2c_f32_bf16 v56, v48, v66
    v_dot2c_f32_bf16 v57, v49, v66
    v_dot2c_f32_bf16 v58, v50, v66
    v_dot2c_f32_bf16 v59, v51, v66
    v_dot2c_f32_bf16 v60, v52, v66
    v_dot2c_f32_bf16 v61, v53, v66
    v_dot2c_f32_bf16 v62, v54, v66
    v_dot2c_f32_bf16 v63, v55, v66
    s_waitcnt vmcnt(0)
    v_perm_b32 v48, v36, v32, s72
    v_perm_b32 v49, v36, v32, s73
    v_perm_b32 v50, v37, v33, s72
    v_perm_b32 v51, v37, v33, s73
    v_perm_b32 v52, v38, v34, s72
    v_perm_b32 v53, v38, v34, s73
    v_perm_b32 v54, v39, v35, s72
    v_perm_b32 v55, v39, v35, s73
    s_waitcnt lgkmcnt(0)
    v_dot2c_f32_bf16 v56, v48, v67
    v_dot2c_f32_bf16 v57, v49, v67
    v_dot2c_f32_bf16 v58, v50, v67
    v_dot2c_f32_bf16 v59, v51, v67
    v_dot2c_f32_bf16 v60, v52, v67
    v_dot2c_f32_bf16 v61, v53, v67
    v_dot2c_f32_bf16 v62, v54, v67
    v_dot2c_f32_bf16 v63, v55, v67
    v_lshlrev_b32 v3, 5, v7
    v_lshl_add_u32 v3, v5, 3, v3
    s_mul_i32 s62, s62, 12288
    s_lshl_b32 s61, s61, 8
    s_add_u32 s61, s61, s62
    s_add_u32 s61, s61, 4734976
    v_permlane32_swap_b32 v56, v60
    v_permlane32_swap_b32 v57, v61
    v_permlane32_swap_b32 v58, v62
    v_permlane32_swap_b32 v59, v63
    v_add_f32 v56, v56, v60
    v_add_f32 v57, v57, v61
    v_add_f32 v58, v58, v62
    v_add_f32 v59, v59, v63
    s_nop 0
    v_permlane16_swap_b32 v56, v58
    v_permlane16_swap_b32 v57, v59
    v_add_f32 v56, v56, v58
    v_add_f32 v57, v57, v59
    s_mov_b32 s62, 0x00ff00ff
    s_mov_b32 s63, 0x00ff00ff
    v_add_f32_dpp v56, v56, v56 row_ror:8 row_mask:0xf bank_mask:0xf
    v_add_f32_dpp v57, v57, v57 row_ror:8 row_mask:0xf bank_mask:0xf
    s_waitcnt vmcnt(0)
    s_mov_b64 exec, s[62:63]
    buffer_store_dwordx2 v[56:57], v3, s[36:39], s61 offen sc1
    s_mov_b64 exec, -1
L_wload:
    v_cvt_pk_bf16_f32 v127, v100, v101
    v_pk_mul_f32 v[116:117], v[100:101], v[104:105] op_sel:[0,0] op_sel_hi:[0,1]
    v_pk_fma_f32 v[112:113], v[100:101], v[104:105], v[116:117] op_sel:[1,1,0] op_sel_hi:[1,0,1] neg_lo:[1,0,0]
    v_cvt_pk_bf16_f32 v120, v112, v113
    v_pk_mul_f32 v[116:117], v[112:113], v[104:105] op_sel:[0,0] op_sel_hi:[0,1]
    v_pk_fma_f32 v[112:113], v[112:113], v[104:105], v[116:117] op_sel:[1,1,0] op_sel_hi:[1,0,1] neg_lo:[1,0,0]
    v_cvt_pk_bf16_f32 v121, v112, v113
    v_pk_mul_f32 v[116:117], v[112:113], v[104:105] op_sel:[0,0] op_sel_hi:[0,1]
    v_pk_fma_f32 v[112:113], v[112:113], v[104:105], v[116:117] op_sel:[1,1,0] op_sel_hi:[1,0,1] neg_lo:[1,0,0]
    v_cvt_pk_bf16_f32 v122, v112, v113
    s_cmp_lg_u32 s3, 1
    s_cbranch_scc1 L_noflag
    global_load_dword v69, v254, s[32:33] sc1
L_noflag:
    v_pk_mul_f32 v[116:117], v[112:113], v[104:105] op_sel:[0,0] op_sel_hi:[0,1]
    v_pk_fma_f32 v[112:113], v[112:113], v[104:105], v[116:117] op_sel:[1,1,0] op_sel_hi:[1,0,1] neg_lo:[1,0,0]
    v_cvt_pk_bf16_f32 v123, v112, v113
    v_pk_mul_f32 v[116:117], v[112:113], v[104:105] op_sel:[0,0] op_sel_hi:[0,1]
    v_pk_fma_f32 v[112:113], v[112:113], v[104:105], v[116:117] op_sel:[1,1,0] op_sel_hi:[1,0,1] neg_lo:[1,0,0]
    v_cvt_pk_bf16_f32 v124, v112, v113
    v_pk_mul_f32 v[116:117], v[112:113], v[104:105] op_sel:[0,0] op_sel_hi:[0,1]
    v_pk_fma_f32 v[112:113], v[112:113], v[104:105], v[116:117] op_sel:[1,1,0] op_sel_hi:[1,0,1] neg_lo:[1,0,0]
    v_cvt_pk_bf16_f32 v125, v112, v113
    v_pk_mul_f32 v[116:117], v[112:113], v[104:105] op_sel:[0,0] op_sel_hi:[0,1]
    v_pk_fma_f32 v[112:113], v[112:113], v[104:105], v[116:117] op_sel:[1,1,0] op_sel_hi:[1,0,1] neg_lo:[1,0,0]
    v_cvt_pk_bf16_f32 v126, v112, v113
    ds_write_addtid_b32 v127 offset:17408
    ds_write_addtid_b32 v120 offset:17952
    ds_write_addtid_b32 v121 offset:18496
    ds_write_addtid_b32 v122 offset:19040
    ds_write_addtid_b32 v123 offset:19584
    ds_write_addtid_b32 v124 offset:20128
    ds_write_addtid_b32 v125 offset:20672
    ds_write_addtid_b32 v126 offset:21216
    v_pk_mul_f32 v[116:117], v[112:113], v[104:105] op_sel:[0,0] op_sel_hi:[0,1]
    v_pk_fma_f32 v[112:113], v[112:113], v[104:105], v[116:117] op_sel:[1,1,0] op_sel_hi:[1,0,1] neg_lo:[1,0,0]
    v_cvt_pk_bf16_f32 v127, v112, v113
    v_pk_mul_f32 v[116:117], v[100:101], v[100:101] op_sel:[0,0] op_sel_hi:[0,1]
    v_pk_fma_f32 v[114:115], v[100:101], v[100:101], v[116:117] op_sel:[1,1,0] op_sel_hi:[1,0,1] neg_lo:[1,0,0]
    v_cvt_pk_bf16_f32 v120, v114, v115
    v_pk_mul_f32 v[116:117], v[114:115], v[106:107] op_sel:[0,0] op_sel_hi:[0,1]
    v_pk_fma_f32 v[112:113], v[114:115], v[106:107], v[116:117] op_sel:[1,1,0] op_sel_hi:[1,0,1] neg_lo:[1,0,0]
    v_cvt_pk_bf16_f32 v121, v112, v113
    v_pk_mul_f32 v[116:117], v[112:113], v[106:107] op_sel:[0,0] op_sel_hi:[0,1]
    v_pk_fma_f32 v[112:113], v[112:113], v[106:107], v[116:117] op_sel:[1,1,0] op_sel_hi:[1,0,1] neg_lo:[1,0,0]
    v_cvt_pk_bf16_f32 v122, v112, v113
    v_pk_mul_f32 v[116:117], v[112:113], v[106:107] op_sel:[0,0] op_sel_hi:[0,1]
    v_pk_fma_f32 v[112:113], v[112:113], v[106:107], v[116:117] op_sel:[1,1,0] op_sel_hi:[1,0,1] neg_lo:[1,0,0]
    v_cvt_pk_bf16_f32 v123, v112, v113
    v_pk_mul_f32 v[116:117], v[112:113], v[106:107] op_sel:[0,0] op_sel_hi:[0,1]
    v_pk_fma_f32 v[112:113], v[112:113], v[106:107], v[116:117] op_sel:[1,1,0] op_sel_hi:[1,0,1] neg_lo:[1,0,0]
    v_cvt_pk_bf16_f32 v124, v112, v113
    v_pk_mul_f32 v[116:117], v[114:115], v[100:101] op_sel:[0,0] op_sel_hi:[0,1]
    v_pk_fma_f32 v[114:115], v[114:115], v[100:101], v[116:117] op_sel:[1,1,0] op_sel_hi:[1,0,1] neg_lo:[1,0,0]
    v_cvt_pk_bf16_f32 v125, v114, v115
    v_pk_mul_f32 v[116:117], v[114:115], v[106:107] op_sel:[0,0] op_sel_hi:[0,1]
    v_pk_fma_f32 v[112:113], v[114:115], v[106:107], v[116:117] op_sel:[1,1,0] op_sel_hi:[1,0,1] neg_lo:[1,0,0]
    v_cvt_pk_bf16_f32 v126, v112, v113
    ds_write_addtid_b32 v127 offset:21760
    ds_write_addtid_b32 v120 offset:22304
    ds_write_addtid_b32 v121 offset:22848
    ds_write_addtid_b32 v122 offset:23392
    ds_write_addtid_b32 v123 offset:23936
    ds_write_addtid_b32 v124 offset:24480
    ds_write_addtid_b32 v125 offset:25024
    ds_write_addtid_b32 v126 offset:25568
    s_mov_b32 s75, 0
    s_waitcnt vmcnt(0)
    s_waitcnt lgkmcnt(0)
    s_barrier
    s_cmp_lg_u32 s3, 1
    s_cbranch_scc1 L_arr1_done
    v_cmp_eq_u32 vcc, 0, v69
    s_cbranch_vccz L_arr1
    s_mov_b32 s75, 1
    global_load_dword v69, v254, s[32:33] sc1
    s_branch L_arr1_done
L_arr1:
    s_lshr_b32 s61, s2, 4
    s_and_b32 s61, s61, 3
    s_lshl_b32 s61, s61, 8
    s_add_u32 s61, s61, 5242880
    v_mul_u32_u24 v3, 1024, v0
    s_mov_b64 exec, 65535
    buffer_atomic_add v255, v3, s[36:39], s61 offen sc1
    s_mov_b64 exec, -1
L_arr1_done:
    s_mov_b32 exec_hi, 0xffff
    s_add_u32 m0, s31, 0
    s_nop 0
    buffer_load_dwordx4 v229, s[44:47], s30 offen lds
    s_add_u32 m0, s31, 768
    s_nop 0
    buffer_load_dwordx4 v230, s[44:47], s30 offen lds
    s_add_u32 m0, s31, 1536
    s_nop 0
    buffer_load_dwordx4 v229, s[64:67], s30 offen lds
    s_add_u32 m0, s31, 2304
    s_nop 0
    buffer_load_dwordx4 v230, s[64:67], s30 offen lds
    s_mov_b32 exec_hi, -1
    s_add_u32 m0, s76, 135168
    s_nop 0
    buffer_load_dwordx4 v224, s[52:55], s34 offen lds
    s_add_u32 m0, s76, 139264
    s_nop 0
    buffer_load_dwordx4 v225, s[52:55], s35 offen lds
    s_mov_b32 m0, s79
    ds_read_b128 v[128:131], v238 offset:0
    ds_read_b128 v[132:135], v236 offset:0
    ds_read_b128 v[140:143], v238 offset:64
    ds_read_b128 v[144:147], v236 offset:64
    ds_read_b128 v[152:155], v238 offset:128
    ds_read_b128 v[156:159], v236 offset:128
    ds_read_b128 v[164:167], v238 offset:192
    ds_read_b128 v[168:171], v236 offset:192
    ds_read_b128 v[176:179], v238 offset:256
    ds_read_b128 v[180:183], v236 offset:256
    ds_read_b128 v[188:191], v238 offset:320
    ds_read_b128 v[192:195], v236 offset:320
    ds_read_b128 v[200:203], v238 offset:384
    ds_read_b128 v[204:207], v236 offset:384
    ds_read_b128 v[212:215], v238 offset:448
    ds_read_b128 v[216:219], v236 offset:448
    v_pk_mul_f32 v[116:117], v[112:113], v[106:107] op_sel:[0,0] op_sel_hi:[0,1]
    v_pk_fma_f32 v[112:113], v[112:113], v[106:107], v[116:117] op_sel:[1,1,0] op_sel_hi:[1,0,1] neg_lo:[1,0,0]
    v_cvt_pk_bf16_f32 v127, v112, v113
    v_pk_mul_f32 v[116:117], v[112:113], v[106:107] op_sel:[0,0] op_sel_hi:[0,1]
    v_pk_fma_f32 v[112:113], v[112:113], v[106:107], v[116:117] op_sel:[1,1,0] op_sel_hi:[1,0,1] neg_lo:[1,0,0]
    v_cvt_pk_bf16_f32 v120, v112, v113
    v_pk_mul_f32 v[116:117], v[112:113], v[106:107] op_sel:[0,0] op_sel_hi:[0,1]
    v_pk_fma_f32 v[112:113], v[112:113], v[106:107], v[116:117] op_sel:[1,1,0] op_sel_hi:[1,0,1] neg_lo:[1,0,0]
    v_cvt_pk_bf16_f32 v121, v112, v113
    v_pk_mul_f32 v[116:117], v[114:115], v[100:101] op_sel:[0,0] op_sel_hi:[0,1]
    v_pk_fma_f32 v[114:115], v[114:115], v[100:101], v[116:117] op_sel:[1,1,0] op_sel_hi:[1,0,1] neg_lo:[1,0,0]
    v_cvt_pk_bf16_f32 v122, v114, v115
    v_pk_mul_f32 v[116:117], v[114:115], v[108:109] op_sel:[0,0] op_sel_hi:[0,1]
    v_pk_fma_f32 v[112:113], v[114:115], v[108:109], v[116:117] op_sel:[1,1,0] op_sel_hi:[1,0,1] neg_lo:[1,0,0]
    v_cvt_pk_bf16_f32 v123, v112, v113
    v_pk_mul_f32 v[116:117], v[114:115], v[110:111] op_sel:[0,0] op_sel_hi:[0,1]
    v_pk_fma_f32 v[112:113], v[114:115], v[110:111], v[116:117] op_sel:[1,1,0] op_sel_hi:[1,0,1] neg_lo:[1,0,0]
    v_cvt_pk_bf16_f32 v124, v112, v113
    v_pk_mul_f32 v[116:117], v[114:115], v[100:101] op_sel:[0,0] op_sel_hi:[0,1]
    v_pk_fma_f32 v[114:115], v[114:115], v[100:101], v[116:117] op_sel:[1,1,0] op_sel_hi:[1,0,1] neg_lo:[1,0,0]
    v_cvt_pk_bf16_f32 v125, v114, v115
    v_pk_mul_f32 v[116:117], v[114:115], v[108:109] op_sel:[0,0] op_sel_hi:[0,1]
    v_pk_fma_f32 v[112:113], v[114:115], v[108:109], v[116:117] op_sel:[1,1,0] op_sel_hi:[1,0,1] neg_lo:[1,0,0]
    v_cvt_pk_bf16_f32 v126, v112, v113
    ds_write_addtid_b32 v127 offset:26112
    ds_write_addtid_b32 v120 offset:26656
    ds_write_addtid_b32 v121 offset:27200
    ds_write_addtid_b32 v122 offset:27744
    ds_write_addtid_b32 v123 offset:28288
    ds_write_addtid_b32 v124 offset:28832
    ds_write_addtid_b32 v125 offset:29376
    ds_write_addtid_b32 v126 offset:29920
    v_pk_mul_f32 v[116:117], v[114:115], v[110:111] op_sel:[0,0] op_sel_hi:[0,1]
    v_pk_fma_f32 v[112:113], v[114:115], v[110:111], v[116:117] op_sel:[1,1,0] op_sel_hi:[1,0,1] neg_lo:[1,0,0]
    v_cvt_pk_bf16_f32 v127, v112, v113
    v_pk_mul_f32 v[116:117], v[114:115], v[100:101] op_sel:[0,0] op_sel_hi:[0,1]
    v_pk_fma_f32 v[114:115], v[114:115], v[100:101], v[116:117] op_sel:[1,1,0] op_sel_hi:[1,0,1] neg_lo:[1,0,0]
    v_cvt_pk_bf16_f32 v120, v114, v115
    v_pk_mul_f32 v[116:117], v[114:115], v[108:109] op_sel:[0,0] op_sel_hi:[0,1]
    v_pk_fma_f32 v[112:113], v[114:115], v[108:109], v[116:117] op_sel:[1,1,0] op_sel_hi:[1,0,1] neg_lo:[1,0,0]
    v_cvt_pk_bf16_f32 v121, v112, v113
    v_pk_mul_f32 v[116:117], v[114:115], v[110:111] op_sel:[0,0] op_sel_hi:[0,1]
    v_pk_fma_f32 v[112:113], v[114:115], v[110:111], v[116:117] op_sel:[1,1,0] op_sel_hi:[1,0,1] neg_lo:[1,0,0]
    v_cvt_pk_bf16_f32 v122, v112, v113
    v_pk_mul_f32 v[116:117], v[114:115], v[100:101] op_sel:[0,0] op_sel_hi:[0,1]
    v_pk_fma_f32 v[114:115], v[114:115], v[100:101], v[116:117] op_sel:[1,1,0] op_sel_hi:[1,0,1] neg_lo:[1,0,0]
    v_cvt_pk_bf16_f32 v123, v114, v115
    v_pk_mul_f32 v[116:117], v[114:115], v[108:109] op_sel:[0,0] op_sel_hi:[0,1]
    v_pk_fma_f32 v[112:113], v[114:115], v[108:109], v[116:117] op_sel:[1,1,0] op_sel_hi:[1,0,1] neg_lo:[1,0,0]
    v_cvt_pk_bf16_f32 v124, v112, v113
    v_pk_mul_f32 v[116:117], v[114:115], v[110:111] op_sel:[0,0] op_sel_hi:[0,1]
    v_pk_fma_f32 v[112:113], v[114:115], v[110:111], v[116:117] op_sel:[1,1,0] op_sel_hi:[1,0,1] neg_lo:[1,0,0]
    v_cvt_pk_bf16_f32 v125, v112, v113
    ds_write_addtid_b32 v127 offset:30464
    ds_write_addtid_b32 v120 offset:31008
    ds_write_addtid_b32 v121 offset:31552
    ds_write_addtid_b32 v122 offset:32096
    ds_write_addtid_b32 v123 offset:32640
    ds_write_addtid_b32 v124 offset:33184
    ds_write_addtid_b32 v125 offset:33728
    s_cmp_eq_u32 s75, 0
    s_cbranch_scc1 L_arr2_done
    s_waitcnt vmcnt(6)
    v_cmp_eq_u32 vcc, 0, v69
    s_cbranch_vccz L_arr2
    s_mov_b32 s62, 0
L_flagspin:
    global_load_dword v69, v254, s[32:33] sc1
    s_add_u32 s62, s62, 1
    s_cmp_ge_u32 s62, 262144
    s_cbranch_scc1 L_arr2
    s_waitcnt vmcnt(0)
    v_cmp_eq_u32 vcc, 0, v69
    s_cbranch_vccnz L_flagspin
L_arr2:
    s_lshr_b32 s61, s2, 4
    s_and_b32 s61, s61, 3
    s_lshl_b32 s61, s61, 8
    s_add_u32 s61, s61, 5242880
    v_mul_u32_u24 v3, 1024, v0
    s_mov_b64 exec, 65535
    buffer_atomic_add v255, v3, s[36:39], s61 offen sc1
    s_mov_b64 exec, -1
L_arr2_done:
    s_waitcnt lgkmcnt(15)
    v_mfma_f32_16x16x32_bf16 v[16:19], v[132:135], v[128:131], 0
    v_mfma_f32_16x16x32_bf16 v[16:19], v[144:147], v[140:143], v[16:19]
    v_mfma_f32_16x16x32_bf16 v[16:19], v[156:159], v[152:155], v[16:19]
    v_mfma_f32_16x16x32_bf16 v[16:19], v[168:171], v[164:167], v[16:19]
    s_waitcnt lgkmcnt(0)
    s_barrier
    v_mfma_f32_16x16x32_bf16 v[16:19], v[180:183], v[176:179], v[16:19]
    ds_read_b128 v[136:139], v237 offset:0
    v_mfma_f32_16x16x32_bf16 v[16:19], v[192:195], v[188:191], v[16:19]
    ds_read_b128 v[148:151], v237 offset:64
    v_mfma_f32_16x16x32_bf16 v[16:19], v[204:207], v[200:203], v[16:19]
    ds_read_b128 v[160:163], v237 offset:128
    v_mfma_f32_16x16x32_bf16 v[16:19], v[216:219], v[212:215], v[16:19]
    ds_read_b128 v[172:175], v237 offset:192
    ds_read_b128 v[184:187], v237 offset:256
    ds_read_b128 v[196:199], v237 offset:320
    ds_read_b128 v[208:211], v237 offset:384
    ds_read_b128 v[220:223], v237 offset:448
    v_lshl_add_u32 v8, v5, 3, v239
    s_cmp_eq_u32 s69, 1
    s_cbranch_scc1 L_seg13
    s_waitcnt lgkmcnt(7)
    v_mfma_f32_16x16x32_bf16 v[20:23], v[136:139], v[128:131], 0
    v_cmp_eq_u32 vcc, 0, v0
    v_lshrrev_b32 v10, 1, v5
    s_waitcnt lgkmcnt(6)
    v_mfma_f32_16x16x32_bf16 v[20:23], v[148:151], v[140:143], v[20:23]
    v_lshl_add_u32 v9, v10, 9, v239
    v_cndmask_b32 v43, 0, v43, vcc
    s_waitcnt lgkmcnt(5)
    v_mfma_f32_16x16x32_bf16 v[20:23], v[160:163], v[152:155], v[20:23]
    v_add_f32 v16, v16, v43
    v_and_b32 v10, 1, v5
    s_waitcnt lgkmcnt(4)
    v_mfma_f32_16x16x32_bf16 v[20:23], v[172:175], v[164:167], v[20:23]
    v_cvt_pk_bf16_f32 v24, v16, v17
    v_cvt_pk_bf16_f32 v25, v18, v19
    s_waitcnt lgkmcnt(3)
    v_mfma_f32_16x16x32_bf16 v[20:23], v[184:187], v[176:179], v[20:23]
    v_lshl_add_u32 v9, v10, 4, v9
    s_waitcnt lgkmcnt(2)
    v_mfma_f32_16x16x32_bf16 v[20:23], v[196:199], v[188:191], v[20:23]
    s_waitcnt lgkmcnt(1)
    v_mfma_f32_16x16x32_bf16 v[20:23], v[208:211], v[200:203], v[20:23]
    s_waitcnt lgkmcnt(0)
    v_mfma_f32_16x16x32_bf16 v[20:23], v[220:223], v[212:215], v[20:23]
    ds_write_b64 v8, v[24:25]
    s_nop 6
    v_cvt_pk_bf16_f32 v28, v20, v20
    v_cvt_pk_bf16_f32 v29, v20, v21
    v_cvt_pk_bf16_f32 v30, v21, v21
    v_cvt_pk_bf16_f32 v31, v22, v22
    ds_write_b128 v9, v[28:31] offset:1024
    s_branch L_segdone
L_seg13:
    s_waitcnt lgkmcnt(7)
    v_mfma_f32_16x16x32_bf16 v[20:23], v[136:139], v[128:131], 0
    v_lshl_add_u32 v9, v5, 9, v239
    s_waitcnt lgkmcnt(6)
    v_mfma_f32_16x16x32_bf16 v[20:23], v[148:151], v[140:143], v[20:23]
    s_waitcnt lgkmcnt(5)
    v_mfma_f32_16x16x32_bf16 v[20:23], v[160:163], v[152:155], v[20:23]
    s_waitcnt lgkmcnt(4)
    v_mfma_f32_16x16x32_bf16 v[20:23], v[172:175], v[164:167], v[20:23]
    v_cvt_pk_bf16_f32 v24, v16, v16
    v_cvt_pk_bf16_f32 v25, v17, v18
    s_waitcnt lgkmcnt(3)
    v_mfma_f32_16x16x32_bf16 v[20:23], v[184:187], v[176:179], v[20:23]
    s_waitcnt lgkmcnt(2)
    v_mfma_f32_16x16x32_bf16 v[20:23], v[196:199], v[188:191], v[20:23]
    s_waitcnt lgkmcnt(1)
    v_mfma_f32_16x16x32_bf16 v[20:23], v[208:211], v[200:203], v[20:23]
    s_waitcnt lgkmcnt(0)
    v_mfma_f32_16x16x32_bf16 v[20:23], v[220:223], v[212:215], v[20:23]
    ds_write_b64 v8, v[24:25] offset:512
    s_nop 6
    v_cvt_pk_bf16_f32 v28, v20, v20
    v_cvt_pk_bf16_f32 v29, v20, v20
    v_cvt_pk_bf16_f32 v30, v20, v21
    v_cvt_pk_bf16_f32 v31, v21, v21
    v_cvt_pk_bf16_f32 v32, v21, v21
    v_cvt_pk_bf16_f32 v33, v21, v21
    v_cvt_pk_bf16_f32 v34, v22, v22
    v_cvt_pk_bf16_f32 v35, v22, v22
    ds_write_b128 v9, v[28:31] offset:2048
    ds_write_b128 v9, v[32:35] offset:2064
L_segdone:
    s_waitcnt lgkmcnt(0)
    s_barrier
    s_cmp_lg_u32 s3, 0
    s_cbranch_scc1 L_nosample
    s_and_b32 s61, s2, 15
    s_mul_i32 s61, s61, 1024
    s_add_u32 s61, s61, 5242880
    v_lshlrev_b32 v70, 8, v0
    s_mov_b64 exec, 15
    v_mov_b32 v71, 0
    buffer_atomic_add v71, v70, s[36:39], s61 offen sc0 sc1
    s_mov_b64 exec, -1
L_nosample:
    ds_read_b64 v[8:9], v235 offset:0
    ds_read_b128 v[12:15], v235 offset:8
    ds_read_b64 v[16:17], v235 offset:16640
    ds_read_b128 v[20:23], v235 offset:16648
    s_add_u32 s50, s51, 131072
    s_cmp_ge_u32 s58, 96
    s_cselect_b32 s50, 2146435072, s50
    s_waitcnt lgkmcnt(2)
    v_alignbyte_b32 v24, v12, v9, 2
    v_alignbyte_b32 v25, v13, v12, 2
    v_alignbyte_b32 v26, v14, v13, 2
    v_alignbyte_b32 v27, v15, v14, 2
    v_mov_b32 v28, v9
    v_mov_b32 v29, v12
    v_mov_b32 v30, v13
    v_mov_b32 v31, v14
    v_alignbyte_b32 v32, v9, v8, 2
    v_alignbyte_b32 v33, v12, v9, 2
    v_alignbyte_b32 v34, v13, v12, 2
    v_alignbyte_b32 v35, v14, v13, 2
    ds_write_b128 v235, v[24:27] offset:4168
    ds_write_b128 v235, v[28:31] offset:8328
    ds_write_b128 v235, v[32:35] offset:12488
    s_waitcnt lgkmcnt(3)
    v_alignbyte_b32 v36, v20, v17, 2
    v_alignbyte_b32 v37, v21, v20, 2
    v_alignbyte_b32 v38, v22, v21, 2
    v_alignbyte_b32 v39, v23, v22, 2
    v_mov_b32 v40, v17
    v_mov_b32 v41, v20
    v_mov_b32 v42, v21
    v_mov_b32 v43, v22
    v_alignbyte_b32 v44, v17, v16, 2
    v_alignbyte_b32 v45, v20, v17, 2
    v_alignbyte_b32 v46, v21, v20, 2
    v_alignbyte_b32 v47, v22, v21, 2
    ds_write_b128 v235, v[36:39] offset:20808
    ds_write_b128 v235, v[40:43] offset:24968
    ds_write_b128 v235, v[44:47] offset:29128
    s_waitcnt vmcnt(0)
    s_cmp_lg_u32 s3, 0
    s_cbranch_scc1 L_s1_go
    s_mov_b64 exec, 15
    v_cmp_gt_u32 vcc, 64, v71
    s_mov_b64 exec, -1
    s_cbranch_vccz L_pollS1_go
    s_and_b32 s61, s2, 15
    s_mul_i32 s61, s61, 1024
    s_add_u32 s61, s61, 5242880
    v_lshlrev_b32 v70, 8, v0
    s_mov_b64 exec, 15
    s_mov_b64 exec, vcc
    s_mov_b32 s62, 0
L_pollS1:
    v_mov_b32 v71, 0
    buffer_atomic_add v71, v70, s[36:39], s61 offen sc0 sc1
    s_add_u32 s62, s62, 1
    s_cmp_ge_u32 s62, 262144
    s_cbranch_scc1 L_pollS1_out
    s_waitcnt vmcnt(0)
    v_cmp_gt_u32 vcc, 64, v71
    s_and_b64 exec, exec, vcc
    s_cbranch_scc1 L_pollS1
L_pollS1_out:
    s_mov_b64 exec, -1
L_pollS1_go:
L_s1_go:
    s_add_u32 s61, s12, 49152
    s_waitcnt lgkmcnt(0)
    s_barrier
    buffer_load_dwordx4 v[100:103], v250, s[36:39], s12 offen sc1
    buffer_load_dwordx4 v[104:107], v250, s[36:39], s61 offen sc1
    ds_read_b64_tr_b16 v[136:137], v233 offset:0
    ds_read_b64_tr_b16 v[138:139], v233 offset:768
    ds_read_b64_tr_b16 v[140:141], v233 offset:16
    ds_read_b64_tr_b16 v[142:143], v233 offset:784
    ds_read_b64_tr_b16 v[144:145], v233 offset:32
    ds_read_b64_tr_b16 v[146:147], v233 offset:800
    ds_read_b64_tr_b16 a[120:121], v226 offset:0
    ds_read_b64_tr_b16 a[122:123], v226 offset:512
    ds_read_b64_tr_b16 a[124:125], v226 offset:4096
    ds_read_b64_tr_b16 a[126:127], v226 offset:4608
    s_mov_b64 exec, 0xffffff
    buffer_load_dwordx2 v[212:213], v240, s[36:39], s13 offen sc1
    s_mov_b64 exec, -1
    buffer_load_dwordx4 v[56:59], v1, s[36:39], s24 offen offset:0 sc1
    buffer_load_dword v64, v2, s[36:39], s26 offen offset:0 sc1
    buffer_load_dword v65, v2, s[36:39], s27 offen offset:0 sc1
    buffer_load_dwordx4 v[60:63], v1, s[36:39], s24 offen offset:1024 sc1
    buffer_load_dword v66, v2, s[36:39], s26 offen offset:256 sc1
    buffer_load_dword v67, v2, s[36:39], s27 offen offset:256 sc1
    s_waitcnt lgkmcnt(9)
    v_lshlrev_b32 v76, 16, v136
    v_and_b32 v77, 0xffff0000, v136
    v_lshlrev_b32 v78, 16, v137
    v_and_b32 v79, 0xffff0000, v137
    s_waitcnt lgkmcnt(8)
    v_lshlrev_b32 v80, 16, v138
    v_and_b32 v81, 0xffff0000, v138
    v_lshlrev_b32 v82, 16, v139
    v_and_b32 v83, 0xffff0000, v139
    s_waitcnt lgkmcnt(7)
    v_lshlrev_b32 v84, 16, v140
    v_and_b32 v85, 0xffff0000, v140
    v_lshlrev_b32 v86, 16, v141
    v_and_b32 v87, 0xffff0000, v141
    s_waitcnt lgkmcnt(6)
    v_lshlrev_b32 v88, 16, v142
    v_and_b32 v89, 0xffff0000, v142
    v_lshlrev_b32 v90, 16, v143
    v_and_b32 v91, 0xffff0000, v143
    s_waitcnt lgkmcnt(5)
    v_lshlrev_b32 v92, 16, v144
    v_and_b32 v93, 0xffff0000, v144
    v_lshlrev_b32 v94, 16, v145
    v_and_b32 v95, 0xffff0000, v145
    s_waitcnt lgkmcnt(4)
    v_lshlrev_b32 v96, 16, v146
    v_and_b32 v97, 0xffff0000, v146
    v_lshlrev_b32 v98, 16, v147
    v_and_b32 v99, 0xffff0000, v147
    buffer_load_dwordx4 v[116:119], v1, s[36:39], s25 offen offset:0 sc1
    buffer_load_dword v124, v2, s[36:39], s26 offen offset:2048 sc1
    buffer_load_dword v125, v2, s[36:39], s27 offen offset:2048 sc1
    buffer_load_dwordx4 v[120:123], v1, s[36:39], s25 offen offset:1024 sc1
    buffer_load_dword v126, v2, s[36:39], s26 offen offset:2304 sc1
    buffer_load_dword v127, v2, s[36:39], s27 offen offset:2304 sc1
    buffer_load_dwordx4 v[204:207], v1, s[36:39], s6 offen sc1
    buffer_load_dwordx4 v[208:211], v1, s[36:39], s6 offen offset:2048 sc1
    ds_read_b64 a[128:129], v243 offset:0
    ds_read_b64 a[130:131], v243 offset:8
    ds_read_b64 a[160:161], v243 offset:64
    ds_read_b64 a[162:163], v243 offset:72
    ds_read_b64 a[192:193], v243 offset:128
    ds_read_b64 a[194:195], v243 offset:136
    ds_read_b64 a[224:225], v243 offset:192
    ds_read_b64 a[226:227], v243 offset:200
    ds_read_b64 a[132:133], v243 offset:512
    ds_read_b64 a[134:135], v243 offset:520
    ds_read_b64 a[164:165], v243 offset:576
    ds_read_b64 a[166:167], v243 offset:584
    ds_read_b64 a[196:197], v243 offset:640
    ds_read_b64 a[198:199], v243 offset:648
    ds_read_b64 a[228:229], v243 offset:704
    ds_read_b64 a[230:231], v243 offset:712
    ds_read_b64 a[136:137], v243 offset:1024
    ds_read_b64 a[138:139], v243 offset:1032
    ds_read_b64 a[168:169], v243 offset:1088
    ds_read_b64 a[170:171], v243 offset:1096
    ds_read_b64 a[200:201], v243 offset:1152
    ds_read_b64 a[202:203], v243 offset:1160
    ds_read_b64 a[232:233], v243 offset:1216
    ds_read_b64 a[234:235], v243 offset:1224
    ds_read_b64 a[140:141], v243 offset:1536
    ds_read_b64 a[142:143], v243 offset:1544
    ds_read_b64 a[172:173], v243 offset:1600
    ds_read_b64 a[174:175], v243 offset:1608
    ds_read_b64 a[204:205], v243 offset:1664
    ds_read_b64 a[206:207], v243 offset:1672
    ds_read_b64 a[236:237], v243 offset:1728
    ds_read_b64 a[238:239], v243 offset:1736
    ds_read_b64 a[144:145], v243 offset:2048
    ds_read_b64 a[146:147], v243 offset:2056
    ds_read_b64 a[176:177], v243 offset:2112
    ds_read_b64 a[178:179], v243 offset:2120
    ds_read_b64 a[208:209], v243 offset:2176
    ds_read_b64 a[210:211], v243 offset:2184
    ds_read_b64 a[240:241], v243 offset:2240
    ds_read_b64 a[242:243], v243 offset:2248
    ds_read_b64 a[148:149], v243 offset:2560
    ds_read_b64 a[150:151], v243 offset:2568
    ds_read_b64 a[180:181], v243 offset:2624
    ds_read_b64 a[182:183], v243 offset:2632
    ds_read_b64 a[212:213], v243 offset:2688
    ds_read_b64 a[214:215], v243 offset:2696
    ds_read_b64 a[244:245], v243 offset:2752
    ds_read_b64 a[246:247], v243 offset:2760
    s_waitcnt vmcnt(15)
    v_pk_add_f32 v[100:101], v[100:101], v[104:105]
    v_pk_add_f32 v[102:103], v[102:103], v[106:107]
    s_nop 1
    v_permlane32_swap_b32 v100, v102
    v_permlane32_swap_b32 v101, v103
    v_pk_add_f32 v[100:101], v[100:101], v[102:103]
    s_nop 1
    v_permlane16_swap_b32 v100, v101
    v_add_f32 v100, v100, v101
    v_cvt_pk_bf16_f32 v100, v100, v100
    v_lshlrev_b32 v100, 16, v100
    v_add_f32 v100, v100, v251
    v_cvt_pk_bf16_f32 v100, v100, v100
    v_lshlrev_b32 v100, 16, v100
    ds_write_b32 v252, v100
    ds_read_b128 v[100:103], v253 offset:0
    ds_read_b128 v[104:107], v253 offset:64
    ds_read_b128 v[168:171], v253 offset:128
    ds_read_b128 v[172:175], v253 offset:192
    s_waitcnt vmcnt(14)
    v_add_f32_dpp v212, v212, v212 quad_perm:[1,0,3,2] row_mask:0xf bank_mask:0xf
    v_add_f32_dpp v213, v213, v213 quad_perm:[1,0,3,2] row_mask:0xf bank_mask:0xf
    s_nop 0
    v_add_f32_dpp v212, v212, v212 quad_perm:[2,3,0,1] row_mask:0xf bank_mask:0xf
    v_add_f32_dpp v213, v213, v213 quad_perm:[2,3,0,1] row_mask:0xf bank_mask:0xf
    s_nop 0
    v_add_f32_dpp v212, v212, v212 row_half_mirror row_mask:0xf bank_mask:0xf
    v_add_f32_dpp v213, v213, v213 row_half_mirror row_mask:0xf bank_mask:0xf
    v_cvt_pk_bf16_f32 v213, v212, v213
    v_lshlrev_b32 v212, 16, v213
    v_and_b32 v213, 0xffff0000, v213
    v_add_f32 v212, v212, v241
    v_add_f32 v213, v213, v241
    v_cvt_pk_bf16_f32 v213, v212, v213
    s_waitcnt vmcnt(12)
    v_lshlrev_b32 v68, 16, v64
    v_readlane_b32 s17, v213, 0
    v_readlane_b32 s19, v213, 8
    v_readlane_b32 s21, v213, 16
    s_waitcnt vmcnt(11)
    v_lshlrev_b32 v69, 16, v65
    v_and_b32 v70, 0xffff0000, v64
    v_and_b32 v71, 0xffff0000, v65
    s_waitcnt vmcnt(9)
    v_lshlrev_b32 v72, 16, v66
    s_waitcnt vmcnt(8)
    v_lshlrev_b32 v73, 16, v67
    v_and_b32 v74, 0xffff0000, v66
    v_and_b32 v75, 0xffff0000, v67
    s_lshl_b32 s16, s17, 16
    s_and_b32 s17, s17, 0xffff0000
    s_lshl_b32 s18, s19, 16
    s_and_b32 s19, s19, 0xffff0000
    s_lshl_b32 s20, s21, 16
    s_and_b32 s21, s21, 0xffff0000
    s_waitcnt lgkmcnt(3)
    v_pk_mul_f32 v[76:77], v[76:77], v[100:101]
    v_pk_mul_f32 v[78:79], v[78:79], v[102:103]
    s_waitcnt lgkmcnt(2)
    v_pk_mul_f32 v[80:81], v[80:81], v[104:105]
    v_pk_mul_f32 v[82:83], v[82:83], v[106:107]
    v_cvt_pk_bf16_f32 v148, v76, v77
    v_cvt_pk_bf16_f32 v149, v78, v79
    v_cvt_pk_bf16_f32 v150, v80, v81
    v_cvt_pk_bf16_f32 v151, v82, v83
    buffer_store_dwordx4 v[148:151], v232, s[36:39], s8 offen sc1
    v_pk_mul_f32 v[84:85], v[84:85], v[100:101]
    v_pk_mul_f32 v[86:87], v[86:87], v[102:103]
    v_pk_mul_f32 v[88:89], v[88:89], v[104:105]
    v_pk_mul_f32 v[90:91], v[90:91], v[106:107]
    v_cvt_pk_bf16_f32 v152, v84, v85
    v_cvt_pk_bf16_f32 v153, v86, v87
    v_cvt_pk_bf16_f32 v154, v88, v89
    v_cvt_pk_bf16_f32 v155, v90, v91
    v_cndmask_b32 v152, v152, v248, s[22:23]
    v_cndmask_b32 v153, v153, v248, s[22:23]
    v_cndmask_b32 v154, v154, v248, s[22:23]
    v_cndmask_b32 v155, v155, v248, s[22:23]
    buffer_store_dwordx4 v[152:155], v232, s[36:39], s9 offen sc1
    v_pk_mul_f32 v[92:93], v[92:93], v[100:101]
    v_pk_mul_f32 v[94:95], v[94:95], v[102:103]
    v_pk_mul_f32 v[96:97], v[96:97], v[104:105]
    v_pk_mul_f32 v[98:99], v[98:99], v[106:107]
    v_cvt_pk_bf16_f32 v156, v92, v93
    v_cvt_pk_bf16_f32 v157, v94, v95
    v_cvt_pk_bf16_f32 v158, v96, v97
    v_cvt_pk_bf16_f32 v159, v98, v99
    buffer_store_dwordx4 v[156:159], v232, s[36:39], s10 offen sc1
    v_mov_b32 v10, s16
    v_mov_b32 v11, s17
    v_pk_fma_f32 v[68:69], v[68:69], v[56:57], v[56:57] op_sel:[0,0,1] op_sel_hi:[1,0,1]
    v_pk_fma_f32 v[70:71], v[70:71], v[58:59], v[58:59] op_sel:[0,0,1] op_sel_hi:[1,0,1]
    v_pk_fma_f32 v[72:73], v[72:73], v[60:61], v[60:61] op_sel:[0,0,1] op_sel_hi:[1,0,1]
    v_pk_fma_f32 v[74:75], v[74:75], v[62:63], v[62:63] op_sel:[0,0,1] op_sel_hi:[1,0,1]
    v_pk_fma_f32 v[68:69], v[68:69], s[18:19], v[10:11]
    v_pk_fma_f32 v[70:71], v[70:71], s[18:19], v[10:11]
    v_pk_fma_f32 v[72:73], v[72:73], s[18:19], v[10:11]
    v_pk_fma_f32 v[74:75], v[74:75], s[18:19], v[10:11]
    v_cvt_pk_bf16_f32 v64, v70, v68
    v_cvt_pk_bf16_f32 v66, v71, v69
    v_cvt_pk_bf16_f32 v65, v74, v72
    v_cvt_pk_bf16_f32 v67, v75, v73
    ds_write2st64_b32 v242, v64, v65 offset0:0 offset1:1
    ds_write2st64_b32 v242, v66, v67 offset0:18 offset1:19
    s_cmp_eq_u32 s68, 0
    s_cselect_b32 s20, s20, s21
    s_waitcnt lgkmcnt(0)
    s_barrier
    ds_read_b128 v[48:51], v244 offset:192
    ds_read_b128 v[64:67], v244 offset:128
    ds_read_b128 v[80:83], v244 offset:64
    ds_read_b128 v[96:99], v244 offset:0
    ds_read_b128 v[52:55], v244 offset:704
    ds_read_b128 v[68:71], v244 offset:640
    s_waitcnt lgkmcnt(5)
    v_mfma_f32_16x16x32_bf16 v[16:19], a[128:131], v[48:51], 0
    ds_read_b128 v[84:87], v244 offset:576
    s_waitcnt vmcnt(9)
    v_lshlrev_b32 v128, 16, v124
    s_waitcnt lgkmcnt(5)
    v_mfma_f32_16x16x32_bf16 v[16:19], a[160:163], v[64:67], v[16:19]
    ds_read_b128 v[100:103], v244 offset:512
    s_waitcnt vmcnt(8)
    v_lshlrev_b32 v129, 16, v125
    s_waitcnt lgkmcnt(5)
    v_mfma_f32_16x16x32_bf16 v[16:19], a[192:195], v[80:83], v[16:19]
    ds_read_b128 v[56:59], v244 offset:1216
    v_and_b32 v130, 0xffff0000, v124
    s_waitcnt lgkmcnt(5)
    v_mfma_f32_16x16x32_bf16 v[16:19], a[224:227], v[96:99], v[16:19]
    ds_read_b128 v[72:75], v244 offset:1152
    v_and_b32 v131, 0xffff0000, v125
    v_mfma_f32_16x16x32_bf16 v[20:23], a[132:135], v[48:51], 0
    ds_read_b128 v[88:91], v244 offset:1088
    v_fma_f32 v128, v128, v116, v117
    v_mfma_f32_16x16x32_bf16 v[20:23], a[164:167], v[64:67], v[20:23]
    ds_read_b128 v[104:107], v244 offset:1024
    v_fma_f32 v129, v129, v116, v117
    v_mfma_f32_16x16x32_bf16 v[20:23], a[196:199], v[80:83], v[20:23]
    ds_read_b128 v[60:63], v244 offset:1728
    v_fma_f32 v130, v130, v118, v119
    v_mfma_f32_16x16x32_bf16 v[20:23], a[228:231], v[96:99], v[20:23]
    ds_read_b128 v[76:79], v244 offset:1664
    v_fma_f32 v131, v131, v118, v119
    v_mfma_f32_16x16x32_bf16 v[24:27], a[136:139], v[48:51], 0
    ds_read_b128 v[92:95], v244 offset:1600
    v_fma_f32 v128, v128, s18, v10
    v_mfma_f32_16x16x32_bf16 v[24:27], a[168:171], v[64:67], v[24:27]
    ds_read_b128 v[108:111], v244 offset:1536
    v_fma_f32 v129, v129, s19, v11
    v_mfma_f32_16x16x32_bf16 v[24:27], a[200:203], v[80:83], v[24:27]
    s_waitcnt lgkmcnt(4)
    v_fma_f32 v130, v130, s18, v10
    v_fma_f32 v131, v131, s19, v11
    v_mfma_f32_16x16x32_bf16 v[24:27], a[232:235], v[96:99], v[24:27]
    s_waitcnt lgkmcnt(3)
    s_waitcnt vmcnt(6)
    v_lshlrev_b32 v132, 16, v126
    v_mfma_f32_16x16x32_bf16 v[28:31], a[140:143], v[48:51], 0
    s_waitcnt vmcnt(0)
    s_mov_b64 exec, 1
    buffer_atomic_add v255, v254, s[36:39], s7 offen sc1
    s_mov_b64 exec, -1
    v_mfma_f32_16x16x32_bf16 v[28:31], a[172:175], v[64:67], v[28:31]
    ds_read_b64 a[152:153], v243 offset:3072
    v_lshlrev_b32 v133, 16, v127
    v_mfma_f32_16x16x32_bf16 v[28:31], a[204:207], v[80:83], v[28:31]
    ds_read_b64 a[154:155], v243 offset:3080
    v_and_b32 v134, 0xffff0000, v126
    v_mfma_f32_16x16x32_bf16 v[28:31], a[236:239], v[96:99], v[28:31]
    ds_read_b64 a[184:185], v243 offset:3136
    v_and_b32 v135, 0xffff0000, v127
    v_mfma_f32_16x16x32_bf16 v[20:23], a[128:131], v[52:55], v[20:23]
    ds_read_b64 a[186:187], v243 offset:3144
    v_fma_f32 v132, v132, v120, v121
    v_mfma_f32_16x16x32_bf16 v[20:23], a[160:163], v[68:71], v[20:23]
    s_waitcnt lgkmcnt(4)
    v_fma_f32 v133, v133, v120, v121
    v_fma_f32 v134, v134, v122, v123
    v_mfma_f32_16x16x32_bf16 v[20:23], a[192:195], v[84:87], v[20:23]
    ds_read_b64 a[216:217], v243 offset:3200
    v_fma_f32 v135, v135, v122, v123
    v_mfma_f32_16x16x32_bf16 v[20:23], a[224:227], v[100:103], v[20:23]
    s_waitcnt lgkmcnt(3)
    v_fma_f32 v132, v132, s18, v10
    v_fma_f32 v133, v133, s19, v11
    v_mfma_f32_16x16x32_bf16 v[24:27], a[132:135], v[52:55], v[24:27]
    ds_read_b64 a[218:219], v243 offset:3208
    v_fma_f32 v134, v134, s18, v10
    v_mfma_f32_16x16x32_bf16 v[24:27], a[164:167], v[68:71], v[24:27]
    ds_read_b64 a[248:249], v243 offset:3264
    v_fma_f32 v135, v135, s19, v11
    v_mfma_f32_16x16x32_bf16 v[24:27], a[196:199], v[84:87], v[24:27]
    s_waitcnt lgkmcnt(3)
    v_cvt_pk_bf16_f32 v124, v130, v128
    v_cvt_pk_bf16_f32 v126, v131, v129
    v_mfma_f32_16x16x32_bf16 v[24:27], a[228:231], v[100:103], v[24:27]
    ds_read_b64 a[250:251], v243 offset:3272
    v_cvt_pk_bf16_f32 v125, v134, v132
    v_mfma_f32_16x16x32_bf16 v[28:31], a[136:139], v[52:55], v[28:31]
    ds_read_b64 a[156:157], v243 offset:3584
    v_cvt_pk_bf16_f32 v127, v135, v133
    v_mfma_f32_16x16x32_bf16 v[28:31], a[168:171], v[68:71], v[28:31]
    ds_write2st64_b32 v242, v124, v125 offset0:8 offset1:9
    v_mfma_f32_16x16x32_bf16 v[28:31], a[200:203], v[84:87], v[28:31]
    ds_write2st64_b32 v242, v126, v127 offset0:26 offset1:27
    v_mfma_f32_16x16x32_bf16 v[28:31], a[232:235], v[100:103], v[28:31]
    ds_read_b64 a[158:159], v243 offset:3592
    v_lshlrev_b32 v192, 16, v204
    v_mfma_f32_16x16x32_bf16 v[24:27], a[128:131], v[56:59], v[24:27]
    ds_read_b64 a[188:189], v243 offset:3648
    v_and_b32 v193, 0xffff0000, v204
    v_mfma_f32_16x16x32_bf16 v[24:27], a[160:163], v[72:75], v[24:27]
    ds_read_b64 a[190:191], v243 offset:3656
    v_lshlrev_b32 v194, 16, v205
    v_mfma_f32_16x16x32_bf16 v[24:27], a[192:195], v[88:91], v[24:27]
    ds_write_b128 v245, v[16:19] offset:0
    v_mfma_f32_16x16x32_bf16 v[24:27], a[224:227], v[104:107], v[24:27]
    ds_read_b64 a[220:221], v243 offset:3712
    v_and_b32 v195, 0xffff0000, v205
    v_mfma_f32_16x16x32_bf16 v[28:31], a[132:135], v[56:59], v[28:31]
    ds_read_b64 a[222:223], v243 offset:3720
    v_lshlrev_b32 v196, 16, v206
    v_mfma_f32_16x16x32_bf16 v[28:31], a[164:167], v[72:75], v[28:31]
    ds_write_b128 v245, v[20:23] offset:1280
    v_mfma_f32_16x16x32_bf16 v[28:31], a[196:199], v[88:91], v[28:31]
    ds_read_b64 a[252:253], v243 offset:3776
    v_and_b32 v197, 0xffff0000, v206
    v_mfma_f32_16x16x32_bf16 v[28:31], a[228:231], v[104:107], v[28:31]
    s_waitcnt lgkmcnt(5)
    v_lshlrev_b32 v198, 16, v207
    v_and_b32 v199, 0xffff0000, v207
    v_mfma_f32_16x16x32_bf16 v[28:31], a[128:131], v[60:63], v[28:31]
    ds_write_b128 v245, v[24:27] offset:2560
    v_mfma_f32_16x16x32_bf16 v[28:31], a[160:163], v[76:79], v[28:31]
    ds_read_b64 a[254:255], v243 offset:3784
    s_mul_i32 s8, s28, 17408
    v_mfma_f32_16x16x32_bf16 v[28:31], a[192:195], v[92:95], v[28:31]
    s_waitcnt lgkmcnt(4)
    s_add_u32 s8, s8, 7077888
    s_add_u32 s9, s8, 17408
    v_mfma_f32_16x16x32_bf16 v[28:31], a[224:227], v[108:111], v[28:31]
    s_waitcnt lgkmcnt(2)
    s_and_b32 s10, s68, s69
    s_mul_i32 s10, s10, 2146435072
    v_mfma_f32_16x16x32_bf16 v[32:35], a[132:135], v[60:63], 0
    s_add_u32 s10, s10, s9
    s_add_u32 s10, s10, 17408
    v_cndmask_b32 v164, v248, 0, s[14:15]
    v_mfma_f32_16x16x32_bf16 v[32:35], a[164:167], v[76:79], v[32:35]
    v_mov_b32 v165, v164
    v_mov_b32 v166, v164
    v_mfma_f32_16x16x32_bf16 v[32:35], a[196:199], v[92:95], v[32:35]
    s_waitcnt lgkmcnt(0)
    v_mov_b32 v167, v164
    v_cvt_pk_bf16_f32 v160, v168, v169
    v_mfma_f32_16x16x32_bf16 v[32:35], a[228:231], v[108:111], v[32:35]
    ds_write_b128 v245, v[28:31] offset:3840
    v_mfma_f32_16x16x32_bf16 v[32:35], a[136:139], v[56:59], v[32:35]
    v_cndmask_b32 v160, 0, v160, s[14:15]
    v_cvt_pk_bf16_f32 v161, v170, v171
    v_mfma_f32_16x16x32_bf16 v[32:35], a[168:171], v[72:75], v[32:35]
    v_cndmask_b32 v161, 0, v161, s[14:15]
    v_cvt_pk_bf16_f32 v162, v172, v173
    v_mfma_f32_16x16x32_bf16 v[32:35], a[200:203], v[88:91], v[32:35]
    s_waitcnt lgkmcnt(0)
    s_barrier
    v_cndmask_b32 v162, 0, v162, s[14:15]
    v_mfma_f32_16x16x32_bf16 v[32:35], a[232:235], v[104:107], v[32:35]
    ds_read_b128 v[176:179], v246 offset:0
    v_cvt_pk_bf16_f32 v163, v174, v175
    v_mfma_f32_16x16x32_bf16 v[36:39], a[136:139], v[60:63], 0
    ds_read_b128 v[180:183], v246 offset:320
    v_cndmask_b32 v163, 0, v163, s[14:15]
    v_mfma_f32_16x16x32_bf16 v[36:39], a[168:171], v[76:79], v[36:39]
    ds_read_b128 v[184:187], v246 offset:5120
    v_mfma_f32_16x16x32_bf16 v[36:39], a[200:203], v[92:95], v[36:39]
    s_mov_b64 exec, 1
    v_mov_b32 v13, 0
    buffer_atomic_add v13, v254, s[36:39], s29 offen sc0 sc1
    s_mov_b64 exec, -1
    v_mfma_f32_16x16x32_bf16 v[36:39], a[232:235], v[108:111], v[36:39]
    ds_read_b128 v[188:191], v246 offset:5440
    v_mfma_f32_16x16x32_bf16 v[32:35], a[140:143], v[52:55], v[32:35]
    v_mfma_f32_16x16x32_bf16 v[214:217], v[148:151], v[164:167], 0
    s_waitcnt lgkmcnt(3)
    v_mfma_f32_16x16x32_bf16 v[32:35], a[172:175], v[68:71], v[32:35]
    v_mfma_f32_16x16x32_bf16 v[218:221], v[152:155], v[164:167], 0
    s_waitcnt lgkmcnt(2)
    v_mfma_f32_16x16x32_bf16 v[32:35], a[204:207], v[84:87], v[32:35]
    v_mfma_f32_16x16x32_bf16 v[222:225], v[156:159], v[164:167], 0
    s_waitcnt lgkmcnt(1)
    v_pk_fma_f32 v[192:193], v[176:177], s[20:21], v[192:193] op_sel_hi:[1,0,1]
    v_pk_fma_f32 v[194:195], v[178:179], s[20:21], v[194:195] op_sel_hi:[1,0,1]
    v_pk_fma_f32 v[196:197], v[180:181], s[20:21], v[196:197] op_sel_hi:[1,0,1]
    v_pk_fma_f32 v[198:199], v[182:183], s[20:21], v[198:199] op_sel_hi:[1,0,1]
    v_pk_fma_f32 v[192:193], v[184:185], s[20:21], v[192:193] op_sel_hi:[1,0,1]
    v_pk_fma_f32 v[194:195], v[186:187], s[20:21], v[194:195] op_sel_hi:[1,0,1]
    s_waitcnt lgkmcnt(0)
    v_pk_fma_f32 v[196:197], v[188:189], s[20:21], v[196:197] op_sel_hi:[1,0,1]
    v_pk_fma_f32 v[198:199], v[190:191], s[20:21], v[198:199] op_sel_hi:[1,0,1]
    v_cvt_pk_bf16_f32 v200, v192, v193
    v_cvt_pk_bf16_f32 v201, v194, v195
    v_cvt_pk_bf16_f32 v202, v196, v197
    v_cvt_pk_bf16_f32 v203, v198, v199
    v_mfma_f32_16x16x32_bf16 v[32:35], a[236:239], v[100:103], v[32:35]
    buffer_store_dwordx4 v[200:203], v247, s[36:39], s4 offen sc1
    v_mfma_f32_16x16x32_bf16 v[36:39], a[140:143], v[56:59], v[36:39]
    v_mfma_f32_16x16x32_bf16 v[214:217], v[136:139], v[160:163], v[214:217]
    v_mfma_f32_16x16x32_bf16 v[36:39], a[172:175], v[72:75], v[36:39]
    v_mfma_f32_16x16x32_bf16 v[218:221], v[140:143], v[160:163], v[218:221]
    v_mfma_f32_16x16x32_bf16 v[36:39], a[204:207], v[88:91], v[36:39]
    v_mfma_f32_16x16x32_bf16 v[222:225], v[144:147], v[160:163], v[222:225]
    v_mfma_f32_16x16x32_bf16 v[36:39], a[236:239], v[104:107], v[36:39]
    v_mfma_f32_16x16x32_bf16 v[40:43], a[140:143], v[60:63], 0
    v_mfma_f32_16x16x32_bf16 v[40:43], a[172:175], v[76:79], v[40:43]
    v_mfma_f32_16x16x32_bf16 v[40:43], a[204:207], v[92:95], v[40:43]
    s_mov_b32 s61, 0x01010101
    s_mov_b32 exec_lo, s61
    s_mov_b32 exec_hi, s61
    ds_write_b128 v249, v[214:217] offset:0
    ds_write_b128 v249, v[218:221] offset:128
    ds_write_b128 v249, v[222:225] offset:256
    s_mov_b64 exec, -1
    v_mfma_f32_16x16x32_bf16 v[40:43], a[236:239], v[108:111], v[40:43]
    v_mfma_f32_16x16x32_bf16 v[32:35], a[144:147], v[48:51], v[32:35]
    v_mfma_f32_16x16x32_bf16 v[32:35], a[176:179], v[64:67], v[32:35]
    v_mfma_f32_16x16x32_bf16 v[32:35], a[208:211], v[80:83], v[32:35]
    v_mfma_f32_16x16x32_bf16 v[32:35], a[240:243], v[96:99], v[32:35]
    ds_read_b128 v[112:115], v244 offset:2240
    v_mfma_f32_16x16x32_bf16 v[36:39], a[144:147], v[52:55], v[36:39]
    ds_read_b128 v[128:131], v244 offset:2176
    v_mfma_f32_16x16x32_bf16 v[36:39], a[176:179], v[68:71], v[36:39]
    ds_read_b128 v[144:147], v244 offset:2112
    v_mfma_f32_16x16x32_bf16 v[36:39], a[208:211], v[84:87], v[36:39]
    ds_read_b128 v[160:163], v244 offset:2048
    v_mfma_f32_16x16x32_bf16 v[36:39], a[240:243], v[100:103], v[36:39]
    ds_read_b128 v[116:119], v244 offset:2752
    v_mfma_f32_16x16x32_bf16 v[40:43], a[144:147], v[56:59], v[40:43]
    ds_read_b128 v[132:135], v244 offset:2688
    v_mfma_f32_16x16x32_bf16 v[40:43], a[176:179], v[72:75], v[40:43]
    ds_read_b128 v[148:151], v244 offset:2624
    v_mfma_f32_16x16x32_bf16 v[40:43], a[208:211], v[88:91], v[40:43]
    ds_read_b128 v[164:167], v244 offset:2560
    v_mfma_f32_16x16x32_bf16 v[40:43], a[240:243], v[104:107], v[40:43]
    ds_read_b128 v[120:123], v244 offset:3264
    v_mfma_f32_16x16x32_bf16 v[44:47], a[144:147], v[60:63], 0
    ds_read_b128 v[136:139], v244 offset:3200
    v_mfma_f32_16x16x32_bf16 v[44:47], a[176:179], v[76:79], v[44:47]
    ds_read_b128 v[152:155], v244 offset:3136
    v_mfma_f32_16x16x32_bf16 v[44:47], a[208:211], v[92:95], v[44:47]
    ds_read_b128 v[168:171], v244 offset:3072
    v_mfma_f32_16x16x32_bf16 v[44:47], a[240:243], v[108:111], v[44:47]
    ds_read_b128 v[124:127], v244 offset:3776
    v_mfma_f32_16x16x32_bf16 v[36:39], a[148:151], v[48:51], v[36:39]
    ds_read_b128 v[140:143], v244 offset:3712
    v_mfma_f32_16x16x32_bf16 v[36:39], a[180:183], v[64:67], v[36:39]
    ds_read_b128 v[156:159], v244 offset:3648
    v_mfma_f32_16x16x32_bf16 v[36:39], a[212:215], v[80:83], v[36:39]
    ds_read_b128 v[172:175], v244 offset:3584
    v_mfma_f32_16x16x32_bf16 v[36:39], a[244:247], v[96:99], v[36:39]
    s_waitcnt lgkmcnt(4)
    v_mfma_f32_16x16x32_bf16 v[40:43], a[148:151], v[52:55], v[40:43]
    s_waitcnt lgkmcnt(3)
    v_mfma_f32_16x16x32_bf16 v[40:43], a[180:183], v[68:71], v[40:43]
    s_waitcnt lgkmcnt(2)
    v_mfma_f32_16x16x32_bf16 v[40:43], a[212:215], v[84:87], v[40:43]
    s_waitcnt vmcnt(1)
    v_readfirstlane_b32 s30, v13
    s_cmp_ge_u32 s30, 16
    s_cbranch_scc1 L_b_go
    v_mov_b32 v12, 0
    s_mov_b64 exec, 1
    s_mov_b32 s62, 0
L_pollB:
    v_mov_b32 v13, 0
    buffer_atomic_add v13, v12, s[36:39], s29 offen sc0 sc1
    s_add_u32 s62, s62, 1
    s_cmp_ge_u32 s62, 262144
    s_cbranch_scc1 L_pollB_out
    s_waitcnt vmcnt(0)
    v_cmp_gt_u32 vcc, 16, v13
    s_cbranch_vccnz L_pollB
L_pollB_out:
    s_mov_b64 exec, -1
L_b_go:
    v_mfma_f32_16x16x32_bf16 v[40:43], a[244:247], v[100:103], v[40:43]
    buffer_load_dwordx4 a[0:3], v1, s[36:39], s8 offen offset:0 sc1
    s_mul_i32 s48, s59, 66816
    v_mfma_f32_16x16x32_bf16 v[44:47], a[148:151], v[56:59], v[44:47]
    s_waitcnt lgkmcnt(0)
    s_add_u32 s48, s48, 2359296
    s_add_u32 s49, s48, 1003520
    v_mfma_f32_16x16x32_bf16 v[44:47], a[180:183], v[72:75], v[44:47]
    s_lshl_b32 s25, s3, 11
    s_lshl_b32 s63, s3, 12
    v_lshrrev_b32 v6, 2, v0
    v_mfma_f32_16x16x32_bf16 v[44:47], a[212:215], v[88:91], v[44:47]
    buffer_load_dwordx4 a[4:7], v1, s[36:39], s9 offen offset:0 sc1
    v_and_b32 v2, 3, v0
    v_mfma_f32_16x16x32_bf16 v[44:47], a[244:247], v[104:107], v[44:47]
    v_lshlrev_b32 v2, 3, v2
    v_lshl_add_u32 v2, v6, 7, v2
    v_mfma_f32_16x16x32_bf16 v[40:43], a[152:155], v[48:51], v[40:43]
    v_bfe_u32 v7, v0, 3, 2
    v_xor_b32 v6, 0, v7
    v_mfma_f32_16x16x32_bf16 v[40:43], a[184:187], v[64:67], v[40:43]
    v_lshl_add_u32 v8, v6, 5, v2
    v_add_u32 v12, 0x10000, v8
    v_mfma_f32_16x16x32_bf16 v[40:43], a[216:219], v[80:83], v[40:43]
    buffer_load_dwordx4 a[8:11], v1, s[36:39], s10 offen offset:0 sc1
    v_xor_b32 v6, 1, v7
    v_mfma_f32_16x16x32_bf16 v[40:43], a[248:251], v[96:99], v[40:43]
    v_lshl_add_u32 v9, v6, 5, v2
    s_waitcnt vmcnt(3)
    v_add_u32 v13, 0x10000, v9
    v_mfma_f32_16x16x32_bf16 v[44:47], a[152:155], v[52:55], v[44:47]
    v_xor_b32 v6, 2, v7
    v_lshl_add_u32 v10, v6, 5, v2
    v_mfma_f32_16x16x32_bf16 v[44:47], a[184:187], v[68:71], v[44:47]
    v_add_u32 v14, 0x10000, v10
    v_xor_b32 v6, 3, v7
    v_mfma_f32_16x16x32_bf16 v[44:47], a[216:219], v[84:87], v[44:47]
    buffer_load_dwordx4 a[12:15], v1, s[36:39], s8 offen offset:1024 sc1
    v_lshl_add_u32 v11, v6, 5, v2
    v_mfma_f32_16x16x32_bf16 v[44:47], a[248:251], v[100:103], v[44:47]
    v_add_u32 v15, 0x10000, v11
    s_mul_i32 s11, s60, 6144
    v_mfma_f32_16x16x32_bf16 v[44:47], a[156:159], v[48:51], v[44:47]
    v_lshlrev_b32 v192, 16, v208
    v_and_b32 v193, 0xffff0000, v208
    v_mfma_f32_16x16x32_bf16 v[44:47], a[188:191], v[64:67], v[44:47]
    v_lshlrev_b32 v194, 16, v209
    v_and_b32 v195, 0xffff0000, v209
    v_mfma_f32_16x16x32_bf16 v[44:47], a[220:223], v[80:83], v[44:47]
    buffer_load_dwordx4 a[16:19], v1, s[36:39], s9 offen offset:1024 sc1
    v_lshlrev_b32 v196, 16, v210
    v_mfma_f32_16x16x32_bf16 v[44:47], a[252:255], v[96:99], v[44:47]
    v_and_b32 v197, 0xffff0000, v210
    v_lshlrev_b32 v198, 16, v211
    v_mfma_f32_16x16x32_bf16 v[32:35], a[128:131], v[112:115], v[32:35]
    v_and_b32 v199, 0xffff0000, v211
    s_mul_i32 s12, s3, 1536
    v_mfma_f32_16x16x32_bf16 v[32:35], a[160:163], v[128:131], v[32:35]
    s_barrier
    s_cmp_lg_u32 s3, 0
    s_cbranch_scc1 L_arrCA
    s_lshr_b32 s61, s2, 4
    s_and_b32 s61, s61, 7
    s_lshl_b32 s61, s61, 8
    s_add_u32 s61, s61, 4980736
    v_mul_u32_u24 v3, 2048, v0
    s_mov_b32 exec_hi, 0
    buffer_atomic_add v255, v3, s[36:39], s61 offen sc1
    s_mov_b64 exec, -1
L_arrCA:
    v_mfma_f32_16x16x32_bf16 v[32:35], a[192:195], v[144:147], v[32:35]
    buffer_load_dwordx4 a[20:23], v1, s[36:39], s10 offen offset:1024 sc1
    s_add_u32 s11, s11, s12
    v_mfma_f32_16x16x32_bf16 v[32:35], a[224:227], v[160:163], v[32:35]
    buffer_store_dwordx4 a[120:123], v234, s[36:39], s51 offen sc1
    v_mfma_f32_16x16x32_bf16 v[36:39], a[132:135], v[112:115], v[36:39]
    buffer_store_dwordx4 a[124:127], v234, s[36:39], s50 offen sc1
    v_mfma_f32_16x16x32_bf16 v[36:39], a[164:167], v[128:131], v[36:39]
    ds_read_b128 v[176:179], v231 offset:0
    s_add_u32 s11, s11, 4849664
    v_mfma_f32_16x16x32_bf16 v[36:39], a[196:199], v[144:147], v[36:39]
    buffer_load_dwordx4 a[24:27], v1, s[36:39], s8 offen offset:2048 sc1
    v_lshrrev_b32 v2, 5, v0
    v_mfma_f32_16x16x32_bf16 v[36:39], a[228:231], v[160:163], v[36:39]
    ds_write_b128 v245, v[32:35] offset:20480
    v_mfma_f32_16x16x32_bf16 v[40:43], a[136:139], v[112:115], v[40:43]
    ds_read_b128 v[180:183], v231 offset:384
    v_mul_u32_u24 v2, 384, v2
    v_mfma_f32_16x16x32_bf16 v[40:43], a[168:171], v[128:131], v[40:43]
    ds_read_b128 v[184:187], v231 offset:768
    v_and_b32 v6, 31, v0
    v_mfma_f32_16x16x32_bf16 v[40:43], a[200:203], v[144:147], v[40:43]
    buffer_load_dwordx4 a[28:31], v1, s[36:39], s9 offen offset:2048 sc1
    v_min_u32 v6, 23, v6
    v_mfma_f32_16x16x32_bf16 v[40:43], a[232:235], v[160:163], v[40:43]
    ds_read_b128 v[188:191], v231 offset:1152
    v_lshl_add_u32 v2, v6, 4, v2
    v_mfma_f32_16x16x32_bf16 v[44:47], a[140:143], v[112:115], v[44:47]
    s_waitcnt lgkmcnt(4)
    s_lshr_b32 s23, s60, 3
    s_and_b32 s24, s60, 7
    v_mfma_f32_16x16x32_bf16 v[44:47], a[172:175], v[128:131], v[44:47]
    s_waitcnt lgkmcnt(2)
    s_mul_i32 s26, s24, 180224
    s_mul_i32 s12, s3, 45056
    v_mfma_f32_16x16x32_bf16 v[44:47], a[204:207], v[144:147], v[44:47]
    buffer_load_dwordx4 a[32:35], v1, s[36:39], s10 offen offset:2048 sc1
    v_add_f32 v176, v176, v180
    v_mfma_f32_16x16x32_bf16 v[44:47], a[236:239], v[160:163], v[44:47]
    s_waitcnt lgkmcnt(1)
    v_add_f32 v177, v177, v181
    v_add_f32 v178, v178, v182
    v_mfma_f32_16x16x32_bf16 v[36:39], a[128:131], v[116:119], v[36:39]
    s_waitcnt lgkmcnt(0)
    v_add_f32 v179, v179, v183
    v_add_f32 v176, v176, v184
    v_mfma_f32_16x16x32_bf16 v[36:39], a[160:163], v[132:135], v[36:39]
    v_add_f32 v177, v177, v185
    v_add_f32 v178, v178, v186
    v_mfma_f32_16x16x32_bf16 v[36:39], a[192:195], v[148:151], v[36:39]
    buffer_load_dwordx4 a[36:39], v1, s[36:39], s8 offen offset:3072 sc1
    v_add_f32 v179, v179, v187
    v_mfma_f32_16x16x32_bf16 v[36:39], a[224:227], v[164:167], v[36:39]
    v_add_f32 v176, v176, v188
    v_add_f32 v177, v177, v189
    v_mfma_f32_16x16x32_bf16 v[40:43], a[132:135], v[116:119], v[40:43]
    v_add_f32 v178, v178, v190
    v_add_f32 v179, v179, v191
    v_mfma_f32_16x16x32_bf16 v[40:43], a[164:167], v[132:135], v[40:43]
    s_mov_b64 exec, 0xffffff
    buffer_store_dwordx4 v[176:179], v1, s[36:39], s77 offen sc1
    s_mov_b64 exec, -1
    v_mfma_f32_16x16x32_bf16 v[40:43], a[196:199], v[148:151], v[40:43]
    buffer_load_dwordx4 a[40:43], v1, s[36:39], s9 offen offset:3072 sc1
    s_add_u32 s26, s26, s12
    v_mfma_f32_16x16x32_bf16 v[40:43], a[228:231], v[164:167], v[40:43]
    ds_write_b128 v245, v[36:39] offset:21760
    v_mfma_f32_16x16x32_bf16 v[44:47], a[136:139], v[116:119], v[44:47]
    s_add_u32 s26, s26, 5505024
    s_lshl_b32 s12, s69, 11
    s_add_u32 s27, s26, 2048
    v_mfma_f32_16x16x32_bf16 v[44:47], a[168:171], v[132:135], v[44:47]
    s_sub_u32 s27, s27, s12
    s_add_u32 s26, s26, s12
    v_mfma_f32_16x16x32_bf16 v[44:47], a[200:203], v[148:151], v[44:47]
    buffer_load_dwordx4 a[44:47], v1, s[36:39], s10 offen offset:3072 sc1
    v_mfma_f32_16x16x32_bf16 v[44:47], a[232:235], v[164:167], v[44:47]
    v_mfma_f32_16x16x32_bf16 v[40:43], a[128:131], v[120:123], v[40:43]
    v_mfma_f32_16x16x32_bf16 v[40:43], a[160:163], v[136:139], v[40:43]
    v_mfma_f32_16x16x32_bf16 v[40:43], a[192:195], v[152:155], v[40:43]
    s_add_u32 s8, s8, 4096
    s_add_u32 s9, s9, 4096
    s_add_u32 s10, s10, 4096
    v_mfma_f32_16x16x32_bf16 v[40:43], a[224:227], v[168:171], v[40:43]
    buffer_load_dwordx4 a[48:51], v1, s[36:39], s8 offen offset:0 sc1
    v_mfma_f32_16x16x32_bf16 v[44:47], a[132:135], v[120:123], v[44:47]
    v_mfma_f32_16x16x32_bf16 v[44:47], a[164:167], v[136:139], v[44:47]
    v_mfma_f32_16x16x32_bf16 v[44:47], a[196:199], v[152:155], v[44:47]
    buffer_load_dwordx4 a[52:55], v1, s[36:39], s9 offen offset:0 sc1
    v_mfma_f32_16x16x32_bf16 v[44:47], a[228:231], v[168:171], v[44:47]
    s_nop 1
    ds_write_b128 v245, v[40:43] offset:23040
    v_mfma_f32_16x16x32_bf16 v[44:47], a[128:131], v[124:127], v[44:47]
    v_mfma_f32_16x16x32_bf16 v[44:47], a[160:163], v[140:143], v[44:47]
    v_mfma_f32_16x16x32_bf16 v[44:47], a[192:195], v[156:159], v[44:47]
    s_cmp_lg_u32 s3, 3
    s_cbranch_scc1 L_noca
    s_and_b32 s61, s2, 31
    s_mul_i32 s61, s61, 2048
    s_add_u32 s61, s61, 4980736
    v_lshlrev_b32 v250, 8, v0
    s_mov_b64 exec, 255
    v_mov_b32 v251, 0
    buffer_atomic_add v251, v250, s[36:39], s61 offen sc0 sc1
    s_mov_b64 exec, -1
L_noca:
    v_mfma_f32_16x16x32_bf16 v[44:47], a[224:227], v[172:175], v[44:47]
    buffer_load_dwordx4 a[56:59], v1, s[36:39], s10 offen offset:0 sc1
    s_nop 6
    ds_write_b128 v245, v[44:47] offset:24320
    s_waitcnt lgkmcnt(0)
    s_barrier
    ds_read_b128 v[176:179], v246 offset:20480
    ds_read_b128 v[180:183], v246 offset:20800
    ds_read_b128 v[184:187], v246 offset:25600
    ds_read_b128 v[188:191], v246 offset:25920
    s_waitcnt lgkmcnt(3)
    v_pk_fma_f32 v[192:193], v[176:177], s[20:21], v[192:193] op_sel_hi:[1,0,1]
    v_pk_fma_f32 v[194:195], v[178:179], s[20:21], v[194:195] op_sel_hi:[1,0,1]
    s_waitcnt lgkmcnt(2)
    v_pk_fma_f32 v[196:197], v[180:181], s[20:21], v[196:197] op_sel_hi:[1,0,1]
    v_pk_fma_f32 v[198:199], v[182:183], s[20:21], v[198:199] op_sel_hi:[1,0,1]
    s_waitcnt lgkmcnt(1)
    v_pk_fma_f32 v[192:193], v[184:185], s[20:21], v[192:193] op_sel_hi:[1,0,1]
    v_pk_fma_f32 v[194:195], v[186:187], s[20:21], v[194:195] op_sel_hi:[1,0,1]
    s_waitcnt lgkmcnt(0)
    v_pk_fma_f32 v[196:197], v[188:189], s[20:21], v[196:197] op_sel_hi:[1,0,1]
    v_pk_fma_f32 v[198:199], v[190:191], s[20:21], v[198:199] op_sel_hi:[1,0,1]
    v_cvt_pk_bf16_f32 v200, v192, v193
    v_cvt_pk_bf16_f32 v201, v194, v195
    v_cvt_pk_bf16_f32 v202, v196, v197
    v_cvt_pk_bf16_f32 v203, v198, v199
    buffer_store_dwordx4 v[200:203], v247, s[36:39], s5 offen sc1
    s_cmp_eq_u32 s3, 3
    s_cbranch_scc1 L_g1_stat
    buffer_load_dwordx4 a[60:63], v1, s[36:39], s8 offen offset:1024 sc1
    buffer_load_dwordx4 a[64:67], v1, s[36:39], s9 offen offset:1024 sc1
    buffer_load_dwordx4 a[68:71], v1, s[36:39], s10 offen offset:1024 sc1
    s_barrier
    s_add_u32 m0, s25, 0
    s_add_u32 s6, m0, s48
    buffer_load_dwordx4 v1, s[36:39], s6 offen offset:0 sc1 lds
    buffer_load_dwordx4 v1, s[36:39], s6 offen offset:1024 sc1 lds
    s_add_u32 m0, s25, 8192
    s_add_u32 s6, m0, s48
    buffer_load_dwordx4 v1, s[36:39], s6 offen offset:0 sc1 lds
    buffer_load_dwordx4 v1, s[36:39], s6 offen offset:1024 sc1 lds
    s_add_u32 m0, s63, 16384
    s_add_u32 s6, m0, s48
    buffer_load_dwordx4 v1, s[36:39], s6 offen offset:0 sc1 lds
    buffer_load_dwordx4 v1, s[36:39], s6 offen offset:1024 sc1 lds
    buffer_load_dwordx4 v1, s[36:39], s6 offen offset:2048 sc1 lds
    buffer_load_dwordx4 v1, s[36:39], s6 offen offset:3072 sc1 lds
    s_mov_b32 s71, 45056
    v_lshlrev_b32 v6, 4, v4
    v_mad_u32_u24 v6, v5, s71, v6
    s_mul_i32 s16, s59, 180224
    s_lshl_b32 s71, s28, 8
    s_add_u32 s16, s16, s71
    s_add_u32 s16, s16, 10485760
    s_add_u32 s17, s16, 2883584
    s_lshl_b32 s71, s59, 11
    s_add_u32 s71, s71, 5111808
    s_lshr_b32 s75, s60, 2
    s_lshl_b32 s75, s75, 8
    s_add_u32 s18, s71, s75
    s_add_u32 s19, s18, 1024
    s_lshl_b32 s75, s3, 8
    s_add_u32 s20, s71, s75
    s_add_u32 s21, s20, 1024
    s_lshl_b32 s71, s23, 1
    s_add_u32 s71, s71, s68
    v_and_b32 v7, 3, v4
    v_xor_b32 v7, s71, v7
    v_lshlrev_b32 v7, 5, v7
    v_lshl_add_u32 v7, v4, 8, v7
    v_lshl_add_u32 v7, v5, 3, v7
    s_lshl_b32 s71, s24, 13
    s_lshl_b32 s75, s69, 12
    s_add_u32 s71, s71, s75
    v_add_u32 v7, s71, v7
    v_lshlrev_b32 v249, 3, v4
    v_add_u32 v249, 131072, v249
    s_mov_b32 s14, 0xcccccccc
    s_mov_b32 s15, s14
    s_lshl_b32 s71, s59, 2
    s_lshl_b32 s75, s23, 1
    s_add_u32 s71, s71, s75
    s_add_u32 s12, s71, s68
    s_xor_b32 s75, s68, 1
    s_add_u32 s75, s71, s75
    s_mul_i32 s71, s3, 11264
    s_add_u32 s71, s71, 10485760
    s_mul_i32 s64, s12, 45056
    s_add_u32 s64, s64, s71
    s_mul_i32 s65, s75, 45056
    s_add_u32 s65, s65, s71
    s_add_u32 s66, s64, 2883584
    s_add_u32 s67, s65, 2883584
    s_lshl_b32 s12, s12, 14
    s_lshl_b32 s71, s24, 7
    s_add_u32 s12, s12, s71
    s_lshl_b32 s71, s69, 6
    s_add_u32 s12, s12, s71
    s_add_u32 s13, s12, 0x100000
    v_mul_u32_u24 v3, 12288, v5
    v_lshl_add_u32 v3, v4, 3, v3
    s_lshl_b32 s4, s24, 8
    s_lshl_b32 s5, s69, 7
    s_add_u32 s4, s4, s5
    s_add_u32 s4, s4, 4745216
    s_add_u32 s5, s4, 49152
    buffer_load_dwordx2 v[216:217], v3, s[36:39], s4 offen sc1
    buffer_load_dwordx2 v[218:219], v3, s[36:39], s5 offen sc1
    s_waitcnt vmcnt(8)
    s_barrier
    ds_read_b64_tr_b16 v[112:113], v8 offset:0
    ds_read_b64_tr_b16 v[114:115], v8 offset:2048
    ds_read_b64_tr_b16 v[116:117], v9 offset:0
    ds_read_b64_tr_b16 v[118:119], v9 offset:2048
    ds_read_b64_tr_b16 v[120:121], v10 offset:0
    ds_read_b64_tr_b16 v[122:123], v10 offset:2048
    ds_read_b64_tr_b16 v[124:125], v11 offset:0
    ds_read_b64_tr_b16 v[126:127], v11 offset:2048
    s_waitcnt lgkmcnt(6)
    v_mfma_f32_16x16x32_bf16 v[16:19], a[0:3], v[112:115], 0
    ds_read_b64_tr_b16 v[128:129], v8 offset:4096
    v_mfma_f32_16x16x32_bf16 v[20:23], a[4:7], v[112:115], 0
    ds_read_b64_tr_b16 v[130:131], v8 offset:6144
    v_mfma_f32_16x16x32_bf16 v[24:27], a[8:11], v[112:115], 0
    ds_read_b64_tr_b16 v[132:133], v9 offset:4096
    s_waitcnt lgkmcnt(7)
    v_mfma_f32_16x16x32_bf16 v[28:31], a[0:3], v[116:119], 0
    buffer_load_dwordx4 a[72:75], v1, s[36:39], s8 offen offset:2048 sc1
    v_mfma_f32_16x16x32_bf16 v[32:35], a[4:7], v[116:119], 0
    ds_read_b64_tr_b16 v[134:135], v9 offset:6144
    v_mfma_f32_16x16x32_bf16 v[36:39], a[8:11], v[116:119], 0
    ds_read_b64_tr_b16 v[136:137], v10 offset:4096
    s_waitcnt lgkmcnt(7)
    v_mfma_f32_16x16x32_bf16 v[40:43], a[0:3], v[120:123], 0
    ds_read_b64_tr_b16 v[138:139], v10 offset:6144
    v_mfma_f32_16x16x32_bf16 v[44:47], a[4:7], v[120:123], 0
    buffer_load_dwordx4 a[76:79], v1, s[36:39], s9 offen offset:2048 sc1
    v_mfma_f32_16x16x32_bf16 v[48:51], a[8:11], v[120:123], 0
    ds_read_b64_tr_b16 v[140:141], v11 offset:4096
    s_waitcnt lgkmcnt(7)
    v_mfma_f32_16x16x32_bf16 v[52:55], a[0:3], v[124:127], 0
    ds_read_b64_tr_b16 v[142:143], v11 offset:6144
    v_mfma_f32_16x16x32_bf16 v[56:59], a[4:7], v[124:127], 0
    buffer_load_dwordx4 a[80:83], v1, s[36:39], s10 offen offset:2048 sc1
    v_mfma_f32_16x16x32_bf16 v[60:63], a[8:11], v[124:127], 0
    s_waitcnt lgkmcnt(2)
    v_mfma_f32_16x16x32_bf16 v[16:19], a[12:15], v[128:131], v[16:19]
    s_waitcnt vmcnt(9)
    s_barrier
    v_mfma_f32_16x16x32_bf16 v[20:23], a[16:19], v[128:131], v[20:23]
    ds_read_b64_tr_b16 v[112:113], v8 offset:8192
    v_mfma_f32_16x16x32_bf16 v[24:27], a[20:23], v[128:131], v[24:27]
    ds_read_b64_tr_b16 v[114:115], v8 offset:10240
    v_mfma_f32_16x16x32_bf16 v[28:31], a[12:15], v[132:135], v[28:31]
    ds_read_b64_tr_b16 v[116:117], v9 offset:8192
    buffer_load_dwordx4 a[84:87], v1, s[36:39], s8 offen offset:3072 sc1
    v_mfma_f32_16x16x32_bf16 v[32:35], a[16:19], v[132:135], v[32:35]
    buffer_load_dwordx4 a[88:91], v1, s[36:39], s9 offen offset:3072 sc1
    v_mfma_f32_16x16x32_bf16 v[36:39], a[20:23], v[132:135], v[36:39]
    ds_read_b64_tr_b16 v[118:119], v9 offset:10240
    v_mfma_f32_16x16x32_bf16 v[40:43], a[12:15], v[136:139], v[40:43]
    ds_read_b64_tr_b16 v[120:121], v10 offset:8192
    v_mfma_f32_16x16x32_bf16 v[44:47], a[16:19], v[136:139], v[44:47]
    ds_read_b64_tr_b16 v[122:123], v10 offset:10240
    v_mfma_f32_16x16x32_bf16 v[48:51], a[20:23], v[136:139], v[48:51]
    buffer_load_dwordx4 a[92:95], v1, s[36:39], s10 offen offset:3072 sc1
    s_add_u32 s8, s8, 4096
    s_add_u32 s9, s9, 4096
    s_add_u32 s10, s10, 4096
    s_waitcnt lgkmcnt(6)
    v_mfma_f32_16x16x32_bf16 v[52:55], a[12:15], v[140:143], v[52:55]
    ds_read_b64_tr_b16 v[124:125], v11 offset:8192
    v_mfma_f32_16x16x32_bf16 v[56:59], a[16:19], v[140:143], v[56:59]
    ds_read_b64_tr_b16 v[126:127], v11 offset:10240
    v_mfma_f32_16x16x32_bf16 v[60:63], a[20:23], v[140:143], v[60:63]
    s_waitcnt lgkmcnt(3)
    v_mfma_f32_16x16x32_bf16 v[16:19], a[24:27], v[112:115], v[16:19]
    ds_read_b64_tr_b16 v[128:129], v8 offset:12288
    s_add_u32 m0, s63, 32768
    s_add_u32 s6, m0, s48
    v_mfma_f32_16x16x32_bf16 v[20:23], a[28:31], v[112:115], v[20:23]
    ds_read_b64_tr_b16 v[130:131], v8 offset:14336
    v_mfma_f32_16x16x32_bf16 v[24:27], a[32:35], v[112:115], v[24:27]
    ds_read_b64_tr_b16 v[132:133], v9 offset:12288
    v_mfma_f32_16x16x32_bf16 v[28:31], a[24:27], v[116:119], v[28:31]
    buffer_load_dwordx4 v1, s[36:39], s6 offen offset:0 sc1 lds
    v_mfma_f32_16x16x32_bf16 v[32:35], a[28:31], v[116:119], v[32:35]
    ds_read_b64_tr_b16 v[134:135], v9 offset:14336
    v_mfma_f32_16x16x32_bf16 v[36:39], a[32:35], v[116:119], v[36:39]
    ds_read_b64_tr_b16 v[136:137], v10 offset:12288
    s_waitcnt lgkmcnt(7)
    v_mfma_f32_16x16x32_bf16 v[40:43], a[24:27], v[120:123], v[40:43]
    ds_read_b64_tr_b16 v[138:139], v10 offset:14336
    v_mfma_f32_16x16x32_bf16 v[44:47], a[28:31], v[120:123], v[44:47]
    buffer_load_dwordx4 v1, s[36:39], s6 offen offset:1024 sc1 lds
    v_mfma_f32_16x16x32_bf16 v[48:51], a[32:35], v[120:123], v[48:51]
    ds_read_b64_tr_b16 v[140:141], v11 offset:12288
    s_waitcnt lgkmcnt(7)
    v_mfma_f32_16x16x32_bf16 v[52:55], a[24:27], v[124:127], v[52:55]
    ds_read_b64_tr_b16 v[142:143], v11 offset:14336
    v_mfma_f32_16x16x32_bf16 v[56:59], a[28:31], v[124:127], v[56:59]
    buffer_load_dwordx4 v1, s[36:39], s6 offen offset:2048 sc1 lds
    v_mfma_f32_16x16x32_bf16 v[60:63], a[32:35], v[124:127], v[60:63]
    s_waitcnt lgkmcnt(2)
    v_mfma_f32_16x16x32_bf16 v[16:19], a[36:39], v[128:131], v[16:19]
    s_waitcnt vmcnt(11)
    s_barrier
    v_mfma_f32_16x16x32_bf16 v[20:23], a[40:43], v[128:131], v[20:23]
    ds_read_b64_tr_b16 v[112:113], v8 offset:16384
    v_mfma_f32_16x16x32_bf16 v[24:27], a[44:47], v[128:131], v[24:27]
    ds_read_b64_tr_b16 v[114:115], v8 offset:18432
    v_mfma_f32_16x16x32_bf16 v[28:31], a[36:39], v[132:135], v[28:31]
    ds_read_b64_tr_b16 v[116:117], v9 offset:16384
    buffer_load_dwordx4 v1, s[36:39], s6 offen offset:3072 sc1 lds
    v_mfma_f32_16x16x32_bf16 v[32:35], a[40:43], v[132:135], v[32:35]
    buffer_load_dwordx4 a[96:99], v1, s[36:39], s8 offen offset:0 sc1
    v_mfma_f32_16x16x32_bf16 v[36:39], a[44:47], v[132:135], v[36:39]
    ds_read_b64_tr_b16 v[118:119], v9 offset:18432
    v_mfma_f32_16x16x32_bf16 v[40:43], a[36:39], v[136:139], v[40:43]
    ds_read_b64_tr_b16 v[120:121], v10 offset:16384
    v_mfma_f32_16x16x32_bf16 v[44:47], a[40:43], v[136:139], v[44:47]
    ds_read_b64_tr_b16 v[122:123], v10 offset:18432
    v_mfma_f32_16x16x32_bf16 v[48:51], a[44:47], v[136:139], v[48:51]
    buffer_load_dwordx4 a[100:103], v1, s[36:39], s9 offen offset:0 sc1
    s_waitcnt lgkmcnt(6)
    v_mfma_f32_16x16x32_bf16 v[52:55], a[36:39], v[140:143], v[52:55]
    ds_read_b64_tr_b16 v[124:125], v11 offset:16384
    v_mfma_f32_16x16x32_bf16 v[56:59], a[40:43], v[140:143], v[56:59]
    ds_read_b64_tr_b16 v[126:127], v11 offset:18432
    v_mfma_f32_16x16x32_bf16 v[60:63], a[44:47], v[140:143], v[60:63]
    s_waitcnt lgkmcnt(3)
    v_mfma_f32_16x16x32_bf16 v[16:19], a[48:51], v[112:115], v[16:19]
    ds_read_b64_tr_b16 v[128:129], v8 offset:20480
    v_mfma_f32_16x16x32_bf16 v[20:23], a[52:55], v[112:115], v[20:23]
    ds_read_b64_tr_b16 v[130:131], v8 offset:22528
    v_mfma_f32_16x16x32_bf16 v[24:27], a[56:59], v[112:115], v[24:27]
    ds_read_b64_tr_b16 v[132:133], v9 offset:20480
    v_mfma_f32_16x16x32_bf16 v[28:31], a[48:51], v[116:119], v[28:31]
    buffer_load_dwordx4 a[104:107], v1, s[36:39], s10 offen offset:0 sc1
    v_mfma_f32_16x16x32_bf16 v[32:35], a[52:55], v[116:119], v[32:35]
    ds_read_b64_tr_b16 v[134:135], v9 offset:22528
    v_mfma_f32_16x16x32_bf16 v[36:39], a[56:59], v[116:119], v[36:39]
    ds_read_b64_tr_b16 v[136:137], v10 offset:20480
    s_waitcnt lgkmcnt(7)
    v_mfma_f32_16x16x32_bf16 v[40:43], a[48:51], v[120:123], v[40:43]
    ds_read_b64_tr_b16 v[138:139], v10 offset:22528
    v_mfma_f32_16x16x32_bf16 v[44:47], a[52:55], v[120:123], v[44:47]
    buffer_load_dwordx4 a[108:111], v1, s[36:39], s8 offen offset:1024 sc1
    v_mfma_f32_16x16x32_bf16 v[48:51], a[56:59], v[120:123], v[48:51]
    ds_read_b64_tr_b16 v[140:141], v11 offset:20480
    s_waitcnt lgkmcnt(7)
    v_mfma_f32_16x16x32_bf16 v[52:55], a[48:51], v[124:127], v[52:55]
    ds_read_b64_tr_b16 v[142:143], v11 offset:22528
    v_mfma_f32_16x16x32_bf16 v[56:59], a[52:55], v[124:127], v[56:59]
    buffer_load_dwordx4 a[112:115], v1, s[36:39], s9 offen offset:1024 sc1
    v_mfma_f32_16x16x32_bf16 v[60:63], a[56:59], v[124:127], v[60:63]
    s_waitcnt lgkmcnt(2)
    v_mfma_f32_16x16x32_bf16 v[16:19], a[60:63], v[128:131], v[16:19]
    ds_read_b64_tr_b16 v[112:113], v8 offset:24576
    v_mfma_f32_16x16x32_bf16 v[20:23], a[64:67], v[128:131], v[20:23]
    ds_read_b64_tr_b16 v[114:115], v8 offset:26624
    v_mfma_f32_16x16x32_bf16 v[24:27], a[68:71], v[128:131], v[24:27]
    ds_read_b64_tr_b16 v[116:117], v9 offset:24576
    v_mfma_f32_16x16x32_bf16 v[28:31], a[60:63], v[132:135], v[28:31]
    buffer_load_dwordx4 a[116:119], v1, s[36:39], s10 offen offset:1024 sc1
    v_mfma_f32_16x16x32_bf16 v[32:35], a[64:67], v[132:135], v[32:35]
    ds_read_b64_tr_b16 v[118:119], v9 offset:26624
    v_mfma_f32_16x16x32_bf16 v[36:39], a[68:71], v[132:135], v[36:39]
    ds_read_b64_tr_b16 v[120:121], v10 offset:24576
    v_mfma_f32_16x16x32_bf16 v[40:43], a[60:63], v[136:139], v[40:43]
    ds_read_b64_tr_b16 v[122:123], v10 offset:26624
    v_mfma_f32_16x16x32_bf16 v[44:47], a[64:67], v[136:139], v[44:47]
    buffer_load_dwordx4 a[120:123], v1, s[36:39], s8 offen offset:2048 sc1
    v_mfma_f32_16x16x32_bf16 v[48:51], a[68:71], v[136:139], v[48:51]
    ds_read_b64_tr_b16 v[124:125], v11 offset:24576
    s_waitcnt lgkmcnt(7)
    v_mfma_f32_16x16x32_bf16 v[52:55], a[60:63], v[140:143], v[52:55]
    ds_read_b64_tr_b16 v[126:127], v11 offset:26624
    v_mfma_f32_16x16x32_bf16 v[56:59], a[64:67], v[140:143], v[56:59]
    buffer_load_dwordx4 a[124:127], v1, s[36:39], s9 offen offset:2048 sc1
    v_mfma_f32_16x16x32_bf16 v[60:63], a[68:71], v[140:143], v[60:63]
    s_waitcnt vmcnt(15) lgkmcnt(2)
    v_mfma_f32_16x16x32_bf16 v[16:19], a[72:75], v[112:115], v[16:19]
    ds_read_b64_tr_b16 v[128:129], v8 offset:28672
    v_mfma_f32_16x16x32_bf16 v[20:23], a[76:79], v[112:115], v[20:23]
    ds_read_b64_tr_b16 v[130:131], v8 offset:30720
    v_mfma_f32_16x16x32_bf16 v[24:27], a[80:83], v[112:115], v[24:27]
    ds_read_b64_tr_b16 v[132:133], v9 offset:28672
    v_mfma_f32_16x16x32_bf16 v[28:31], a[72:75], v[116:119], v[28:31]
    buffer_load_dwordx4 a[128:131], v1, s[36:39], s10 offen offset:2048 sc1
    v_mfma_f32_16x16x32_bf16 v[32:35], a[76:79], v[116:119], v[32:35]
    ds_read_b64_tr_b16 v[134:135], v9 offset:30720
    v_mfma_f32_16x16x32_bf16 v[36:39], a[80:83], v[116:119], v[36:39]
    ds_read_b64_tr_b16 v[136:137], v10 offset:28672
    v_mfma_f32_16x16x32_bf16 v[40:43], a[72:75], v[120:123], v[40:43]
    ds_read_b64_tr_b16 v[138:139], v10 offset:30720
    v_mfma_f32_16x16x32_bf16 v[44:47], a[76:79], v[120:123], v[44:47]
    buffer_load_dwordx4 a[132:135], v1, s[36:39], s8 offen offset:3072 sc1
    v_mfma_f32_16x16x32_bf16 v[48:51], a[80:83], v[120:123], v[48:51]
    ds_read_b64_tr_b16 v[140:141], v11 offset:28672
    s_waitcnt lgkmcnt(7)
    v_mfma_f32_16x16x32_bf16 v[52:55], a[72:75], v[124:127], v[52:55]
    ds_read_b64_tr_b16 v[142:143], v11 offset:30720
    v_mfma_f32_16x16x32_bf16 v[56:59], a[76:79], v[124:127], v[56:59]
    buffer_load_dwordx4 a[136:139], v1, s[36:39], s9 offen offset:3072 sc1
    v_mfma_f32_16x16x32_bf16 v[60:63], a[80:83], v[124:127], v[60:63]
    s_waitcnt vmcnt(15) lgkmcnt(2)
    v_mfma_f32_16x16x32_bf16 v[16:19], a[84:87], v[128:131], v[16:19]
    s_waitcnt vmcnt(11)
    s_barrier
    v_mfma_f32_16x16x32_bf16 v[20:23], a[88:91], v[128:131], v[20:23]
    ds_read_b64_tr_b16 v[112:113], v8 offset:32768
    v_mfma_f32_16x16x32_bf16 v[24:27], a[92:95], v[128:131], v[24:27]
    ds_read_b64_tr_b16 v[114:115], v8 offset:34816
    v_mfma_f32_16x16x32_bf16 v[28:31], a[84:87], v[132:135], v[28:31]
    ds_read_b64_tr_b16 v[116:117], v9 offset:32768
    buffer_load_dwordx4 a[140:143], v1, s[36:39], s10 offen offset:3072 sc1
    s_add_u32 s8, s8, 4096
    s_add_u32 s9, s9, 4096
    v_mfma_f32_16x16x32_bf16 v[32:35], a[88:91], v[132:135], v[32:35]
    s_waitcnt lgkmcnt(3)
    s_add_u32 s10, s10, 4096
    s_add_u32 m0, s63, 65536
    v_mfma_f32_16x16x32_bf16 v[36:39], a[92:95], v[132:135], v[36:39]
    ds_read_b64_tr_b16 v[118:119], v9 offset:34816
    s_add_u32 s6, m0, s49
    v_mfma_f32_16x16x32_bf16 v[40:43], a[84:87], v[136:139], v[40:43]
    ds_read_b64_tr_b16 v[120:121], v10 offset:32768
    v_mfma_f32_16x16x32_bf16 v[44:47], a[88:91], v[136:139], v[44:47]
    ds_read_b64_tr_b16 v[122:123], v10 offset:34816
    buffer_load_dwordx4 v1, s[36:39], s6 offen offset:0 sc1 lds
    v_mfma_f32_16x16x32_bf16 v[48:51], a[92:95], v[136:139], v[48:51]
    buffer_load_dwordx4 v1, s[36:39], s6 offen offset:1024 sc1 lds
    v_mfma_f32_16x16x32_bf16 v[52:55], a[84:87], v[140:143], v[52:55]
    ds_read_b64_tr_b16 v[124:125], v11 offset:32768
    v_mfma_f32_16x16x32_bf16 v[56:59], a[88:91], v[140:143], v[56:59]
    ds_read_b64_tr_b16 v[126:127], v11 offset:34816
    v_mfma_f32_16x16x32_bf16 v[60:63], a[92:95], v[140:143], v[60:63]
    s_waitcnt vmcnt(11) lgkmcnt(3)
    v_mfma_f32_16x16x32_bf16 v[16:19], a[96:99], v[112:115], v[16:19]
    ds_read_b64_tr_b16 v[128:129], v8 offset:36864
    v_mfma_f32_16x16x32_bf16 v[20:23], a[100:103], v[112:115], v[20:23]
    ds_read_b64_tr_b16 v[130:131], v8 offset:38912
    v_mfma_f32_16x16x32_bf16 v[24:27], a[104:107], v[112:115], v[24:27]
    ds_read_b64_tr_b16 v[132:133], v9 offset:36864
    v_mfma_f32_16x16x32_bf16 v[28:31], a[96:99], v[116:119], v[28:31]
    buffer_load_dwordx4 v1, s[36:39], s6 offen offset:2048 sc1 lds
    v_mfma_f32_16x16x32_bf16 v[32:35], a[100:103], v[116:119], v[32:35]
    ds_read_b64_tr_b16 v[134:135], v9 offset:38912
    v_mfma_f32_16x16x32_bf16 v[36:39], a[104:107], v[116:119], v[36:39]
    ds_read_b64_tr_b16 v[136:137], v10 offset:36864
    s_waitcnt lgkmcnt(7)
    v_mfma_f32_16x16x32_bf16 v[40:43], a[96:99], v[120:123], v[40:43]
    ds_read_b64_tr_b16 v[138:139], v10 offset:38912
    v_mfma_f32_16x16x32_bf16 v[44:47], a[100:103], v[120:123], v[44:47]
    buffer_load_dwordx4 v1, s[36:39], s6 offen offset:3072 sc1 lds
    v_mfma_f32_16x16x32_bf16 v[48:51], a[104:107], v[120:123], v[48:51]
    ds_read_b64_tr_b16 v[140:141], v11 offset:36864
    s_waitcnt lgkmcnt(7)
    v_mfma_f32_16x16x32_bf16 v[52:55], a[96:99], v[124:127], v[52:55]
    ds_read_b64_tr_b16 v[142:143], v11 offset:38912
    v_mfma_f32_16x16x32_bf16 v[56:59], a[100:103], v[124:127], v[56:59]
    buffer_load_dwordx4 v[144:147], v2, s[36:39], s11 offen offset:0 sc1
    v_mfma_f32_16x16x32_bf16 v[60:63], a[104:107], v[124:127], v[60:63]
    s_waitcnt vmcnt(11) lgkmcnt(2)
    v_mfma_f32_16x16x32_bf16 v[16:19], a[108:111], v[128:131], v[16:19]
    ds_read_b64_tr_b16 v[112:113], v8 offset:40960
    v_mfma_f32_16x16x32_bf16 v[20:23], a[112:115], v[128:131], v[20:23]
    ds_read_b64_tr_b16 v[114:115], v8 offset:43008
    v_mfma_f32_16x16x32_bf16 v[24:27], a[116:119], v[128:131], v[24:27]
    ds_read_b64_tr_b16 v[116:117], v9 offset:40960
    v_mfma_f32_16x16x32_bf16 v[28:31], a[108:111], v[132:135], v[28:31]
    buffer_load_dwordx4 v[220:223], v2, s[36:39], s11 offen offset:768 sc1
    v_mfma_f32_16x16x32_bf16 v[32:35], a[112:115], v[132:135], v[32:35]
    ds_read_b64_tr_b16 v[118:119], v9 offset:43008
    s_add_u32 m0, s63, 49152
    s_add_u32 s6, m0, s48
    v_mfma_f32_16x16x32_bf16 v[36:39], a[116:119], v[132:135], v[36:39]
    ds_read_b64_tr_b16 v[120:121], v10 offset:40960
    v_mfma_f32_16x16x32_bf16 v[40:43], a[108:111], v[136:139], v[40:43]
    ds_read_b64_tr_b16 v[122:123], v10 offset:43008
    v_mfma_f32_16x16x32_bf16 v[44:47], a[112:115], v[136:139], v[44:47]
    buffer_load_dwordx4 v1, s[36:39], s6 offen offset:0 sc1 lds
    v_mfma_f32_16x16x32_bf16 v[48:51], a[116:119], v[136:139], v[48:51]
    ds_read_b64_tr_b16 v[124:125], v11 offset:40960
    s_waitcnt lgkmcnt(7)
    v_mfma_f32_16x16x32_bf16 v[52:55], a[108:111], v[140:143], v[52:55]
    ds_read_b64_tr_b16 v[126:127], v11 offset:43008
    v_mfma_f32_16x16x32_bf16 v[56:59], a[112:115], v[140:143], v[56:59]
    buffer_load_dwordx4 v1, s[36:39], s6 offen offset:1024 sc1 lds
    v_mfma_f32_16x16x32_bf16 v[60:63], a[116:119], v[140:143], v[60:63]
    s_waitcnt vmcnt(11) lgkmcnt(2)
    v_mfma_f32_16x16x32_bf16 v[16:19], a[120:123], v[112:115], v[16:19]
    ds_read_b64_tr_b16 v[128:129], v8 offset:45056
    v_mfma_f32_16x16x32_bf16 v[20:23], a[124:127], v[112:115], v[20:23]
    ds_read_b64_tr_b16 v[130:131], v8 offset:47104
    v_mfma_f32_16x16x32_bf16 v[24:27], a[128:131], v[112:115], v[24:27]
    ds_read_b64_tr_b16 v[132:133], v9 offset:45056
    v_mfma_f32_16x16x32_bf16 v[28:31], a[120:123], v[116:119], v[28:31]
    buffer_load_dwordx4 v1, s[36:39], s6 offen offset:2048 sc1 lds
    v_mfma_f32_16x16x32_bf16 v[32:35], a[124:127], v[116:119], v[32:35]
    ds_read_b64_tr_b16 v[134:135], v9 offset:47104
    v_mfma_f32_16x16x32_bf16 v[36:39], a[128:131], v[116:119], v[36:39]
    ds_read_b64_tr_b16 v[136:137], v10 offset:45056
    v_mfma_f32_16x16x32_bf16 v[40:43], a[120:123], v[120:123], v[40:43]
    ds_read_b64_tr_b16 v[138:139], v10 offset:47104
    v_mfma_f32_16x16x32_bf16 v[44:47], a[124:127], v[120:123], v[44:47]
    buffer_load_dwordx4 v1, s[36:39], s6 offen offset:3072 sc1 lds
    v_mfma_f32_16x16x32_bf16 v[48:51], a[128:131], v[120:123], v[48:51]
    ds_read_b64_tr_b16 v[140:141], v11 offset:45056
    s_waitcnt lgkmcnt(7)
    v_mfma_f32_16x16x32_bf16 v[52:55], a[120:123], v[124:127], v[52:55]
    ds_read_b64_tr_b16 v[142:143], v11 offset:47104
    v_mfma_f32_16x16x32_bf16 v[56:59], a[124:127], v[124:127], v[56:59]
    buffer_load_dwordx4 a[144:147], v1, s[36:39], s8 offen offset:0 sc1
    v_mfma_f32_16x16x32_bf16 v[60:63], a[128:131], v[124:127], v[60:63]
    s_waitcnt vmcnt(11) lgkmcnt(2)
    v_mfma_f32_16x16x32_bf16 v[16:19], a[132:135], v[128:131], v[16:19]
    s_waitcnt vmcnt(7)
    s_barrier
    v_mfma_f32_16x16x32_bf16 v[20:23], a[136:139], v[128:131], v[20:23]
    ds_read_b64_tr_b16 v[112:113], v12 offset:0
    v_mfma_f32_16x16x32_bf16 v[24:27], a[140:143], v[128:131], v[24:27]
    ds_read_b64_tr_b16 v[114:115], v12 offset:2048
    v_mfma_f32_16x16x32_bf16 v[28:31], a[132:135], v[132:135], v[28:31]
    ds_read_b64_tr_b16 v[116:117], v13 offset:0
    buffer_load_dwordx4 a[148:151], v1, s[36:39], s9 offen offset:0 sc1
    v_mfma_f32_16x16x32_bf16 v[32:35], a[136:139], v[132:135], v[32:35]
    buffer_load_dwordx4 a[152:155], v1, s[36:39], s10 offen offset:0 sc1
    v_mfma_f32_16x16x32_bf16 v[36:39], a[140:143], v[132:135], v[36:39]
    ds_read_b64_tr_b16 v[118:119], v13 offset:2048
    v_mfma_f32_16x16x32_bf16 v[40:43], a[132:135], v[136:139], v[40:43]
    ds_read_b64_tr_b16 v[120:121], v14 offset:0
    v_mfma_f32_16x16x32_bf16 v[44:47], a[136:139], v[136:139], v[44:47]
    ds_read_b64_tr_b16 v[122:123], v14 offset:2048
    v_mfma_f32_16x16x32_bf16 v[48:51], a[140:143], v[136:139], v[48:51]
    buffer_load_dwordx4 a[156:159], v1, s[36:39], s8 offen offset:1024 sc1
    s_waitcnt lgkmcnt(6)
    v_mfma_f32_16x16x32_bf16 v[52:55], a[132:135], v[140:143], v[52:55]
    ds_read_b64_tr_b16 v[124:125], v15 offset:0
    v_mfma_f32_16x16x32_bf16 v[56:59], a[136:139], v[140:143], v[56:59]
    ds_read_b64_tr_b16 v[126:127], v15 offset:2048
    v_mfma_f32_16x16x32_bf16 v[60:63], a[140:143], v[140:143], v[60:63]
    s_waitcnt lgkmcnt(3)
    v_mfma_f32_16x16x32_bf16 v[64:67], a[0:3], v[112:115], 0
    ds_read_b64_tr_b16 v[128:129], v12 offset:4096
    v_mfma_f32_16x16x32_bf16 v[68:71], a[4:7], v[112:115], 0
    ds_read_b64_tr_b16 v[130:131], v12 offset:6144
    v_mfma_f32_16x16x32_bf16 v[72:75], a[8:11], v[112:115], 0
    ds_read_b64_tr_b16 v[132:133], v13 offset:4096
    v_mfma_f32_16x16x32_bf16 v[76:79], a[0:3], v[116:119], 0
    buffer_load_dwordx4 a[160:163], v1, s[36:39], s9 offen offset:1024 sc1
    s_waitcnt vmcnt(9)
    v_add_f32 v144, v144, v220
    v_add_f32 v145, v145, v221
    v_add_f32 v146, v146, v222
    v_mfma_f32_16x16x32_bf16 v[80:83], a[4:7], v[116:119], 0
    ds_read_b64_tr_b16 v[134:135], v13 offset:6144
    v_add_f32 v147, v147, v223
    v_mfma_f32_16x16x32_bf16 v[84:87], a[8:11], v[116:119], 0
    ds_read_b64_tr_b16 v[136:137], v14 offset:4096
    v_mov_b32 v220, v144
    s_waitcnt lgkmcnt(7)
    v_mfma_f32_16x16x32_bf16 v[88:91], a[0:3], v[120:123], 0
    ds_read_b64_tr_b16 v[138:139], v14 offset:6144
    v_mov_b32 v221, v145
    v_mfma_f32_16x16x32_bf16 v[92:95], a[4:7], v[120:123], 0
    buffer_load_dwordx4 a[164:167], v1, s[36:39], s10 offen offset:1024 sc1
    v_mov_b32 v222, v146
    v_mov_b32 v223, v147
    v_mfma_f32_16x16x32_bf16 v[96:99], a[8:11], v[120:123], 0
    ds_read_b64_tr_b16 v[140:141], v15 offset:4096
    v_mov_b32 v224, 0xbfb8aa3b
    s_waitcnt lgkmcnt(7)
    v_mfma_f32_16x16x32_bf16 v[100:103], a[0:3], v[124:127], 0
    ds_read_b64_tr_b16 v[142:143], v15 offset:6144
    v_cndmask_b32 v224, v224, 1.0, s[14:15]
    v_mfma_f32_16x16x32_bf16 v[104:107], a[4:7], v[124:127], 0
    buffer_load_dwordx4 a[168:171], v1, s[36:39], s8 offen offset:2048 sc1
    s_add_u32 s71, s76, 132096
    v_add_u32 v2, s71, v1
    v_mfma_f32_16x16x32_bf16 v[108:111], a[8:11], v[124:127], 0
    s_waitcnt lgkmcnt(2)
    v_lshl_add_u32 v3, v5, 3, s71
    v_mfma_f32_16x16x32_bf16 v[64:67], a[12:15], v[128:131], v[64:67]
    ds_read_b64_tr_b16 v[112:113], v12 offset:8192
    v_mfma_f32_16x16x32_bf16 v[68:71], a[16:19], v[128:131], v[68:71]
    ds_read_b64_tr_b16 v[114:115], v12 offset:10240
    v_mfma_f32_16x16x32_bf16 v[72:75], a[20:23], v[128:131], v[72:75]
    ds_read_b64_tr_b16 v[116:117], v13 offset:8192
    v_permlane32_swap_b32 v144, v220
    v_mfma_f32_16x16x32_bf16 v[76:79], a[12:15], v[132:135], v[76:79]
    buffer_load_dwordx4 a[172:175], v1, s[36:39], s9 offen offset:2048 sc1
    v_mfma_f32_16x16x32_bf16 v[80:83], a[16:19], v[132:135], v[80:83]
    ds_read_b64_tr_b16 v[118:119], v13 offset:10240
    v_mfma_f32_16x16x32_bf16 v[84:87], a[20:23], v[132:135], v[84:87]
    ds_read_b64_tr_b16 v[120:121], v14 offset:8192
    v_permlane32_swap_b32 v145, v221
    v_mfma_f32_16x16x32_bf16 v[88:91], a[12:15], v[136:139], v[88:91]
    ds_read_b64_tr_b16 v[122:123], v14 offset:10240
    v_mfma_f32_16x16x32_bf16 v[92:95], a[16:19], v[136:139], v[92:95]
    buffer_load_dwordx4 a[176:179], v1, s[36:39], s10 offen offset:2048 sc1
    v_mfma_f32_16x16x32_bf16 v[96:99], a[20:23], v[136:139], v[96:99]
    ds_read_b64_tr_b16 v[124:125], v15 offset:8192
    v_permlane32_swap_b32 v146, v222
    s_waitcnt lgkmcnt(7)
    v_mfma_f32_16x16x32_bf16 v[100:103], a[12:15], v[140:143], v[100:103]
    ds_read_b64_tr_b16 v[126:127], v15 offset:10240
    v_mfma_f32_16x16x32_bf16 v[104:107], a[16:19], v[140:143], v[104:107]
    buffer_load_dwordx4 a[180:183], v1, s[36:39], s8 offen offset:3072 sc1
    v_mfma_f32_16x16x32_bf16 v[108:111], a[20:23], v[140:143], v[108:111]
    s_waitcnt lgkmcnt(2)
    v_permlane32_swap_b32 v147, v223
    v_mfma_f32_16x16x32_bf16 v[64:67], a[24:27], v[112:115], v[64:67]
    ds_read_b64_tr_b16 v[128:129], v12 offset:12288
    v_add_f32 v220, v144, v220
    v_add_f32 v221, v145, v221
    v_mfma_f32_16x16x32_bf16 v[68:71], a[28:31], v[112:115], v[68:71]
    ds_read_b64_tr_b16 v[130:131], v12 offset:14336
    v_add_f32 v222, v146, v222
    v_mfma_f32_16x16x32_bf16 v[72:75], a[32:35], v[112:115], v[72:75]
    ds_read_b64_tr_b16 v[132:133], v13 offset:12288
    v_add_f32 v223, v147, v223
    v_mfma_f32_16x16x32_bf16 v[76:79], a[24:27], v[116:119], v[76:79]
    buffer_load_dwordx4 a[184:187], v1, s[36:39], s9 offen offset:3072 sc1
    v_mul_f32 v220, v224, v220
    v_mul_f32 v221, v224, v221
    v_mfma_f32_16x16x32_bf16 v[80:83], a[28:31], v[116:119], v[80:83]
    ds_read_b64_tr_b16 v[134:135], v13 offset:14336
    v_mul_f32 v222, v224, v222
    v_mfma_f32_16x16x32_bf16 v[84:87], a[32:35], v[116:119], v[84:87]
    ds_read_b64_tr_b16 v[136:137], v14 offset:12288
    v_mul_f32 v223, v224, v223
    v_mfma_f32_16x16x32_bf16 v[88:91], a[24:27], v[120:123], v[88:91]
    ds_write_b128 v2, v[220:223]
    v_mfma_f32_16x16x32_bf16 v[92:95], a[28:31], v[120:123], v[92:95]
    ds_read2_b64 v[156:159], v3 offset0:0 offset1:4
    buffer_load_dwordx4 a[188:191], v1, s[36:39], s10 offen offset:3072 sc1
    v_mfma_f32_16x16x32_bf16 v[96:99], a[32:35], v[120:123], v[96:99]
    ds_read_b64_tr_b16 v[138:139], v14 offset:14336
    s_add_u32 m0, s63, 81920
    s_waitcnt lgkmcnt(8)
    v_mfma_f32_16x16x32_bf16 v[100:103], a[24:27], v[124:127], v[100:103]
    ds_read2_b64 v[144:147], v3 offset0:8 offset1:12
    s_add_u32 s6, m0, s49
    v_mfma_f32_16x16x32_bf16 v[104:107], a[28:31], v[124:127], v[104:107]
    ds_read_b64_tr_b16 v[140:141], v15 offset:12288
    v_mfma_f32_16x16x32_bf16 v[108:111], a[32:35], v[124:127], v[108:111]
    ds_read_b64_tr_b16 v[142:143], v15 offset:14336
    buffer_load_dwordx4 v1, s[36:39], s6 offen offset:0 sc1 lds
    s_waitcnt lgkmcnt(9)
    v_mfma_f32_16x16x32_bf16 v[64:67], a[36:39], v[128:131], v[64:67]
    ds_read2_b64 v[160:163], v3 offset0:16 offset1:20
    v_mfma_f32_16x16x32_bf16 v[68:71], a[40:43], v[128:131], v[68:71]
    ds_read2_b64 v[148:151], v3 offset0:24 offset1:28
    v_mfma_f32_16x16x32_bf16 v[72:75], a[44:47], v[128:131], v[72:75]
    s_waitcnt vmcnt(13)
    s_barrier
    s_waitcnt lgkmcnt(9)
    v_mfma_f32_16x16x32_bf16 v[76:79], a[36:39], v[132:135], v[76:79]
    ds_read_b64_tr_b16 v[112:113], v8 offset:49152
    buffer_load_dwordx4 v1, s[36:39], s6 offen offset:1024 sc1 lds
    v_mfma_f32_16x16x32_bf16 v[80:83], a[40:43], v[132:135], v[80:83]
    ds_read_b64_tr_b16 v[114:115], v8 offset:51200
    v_mfma_f32_16x16x32_bf16 v[84:87], a[44:47], v[132:135], v[84:87]
    ds_read_b64_tr_b16 v[116:117], v9 offset:49152
    s_waitcnt lgkmcnt(8)
    v_mfma_f32_16x16x32_bf16 v[88:91], a[36:39], v[136:139], v[88:91]
    ds_read2_b64 v[164:167], v3 offset0:32 offset1:36
    v_mfma_f32_16x16x32_bf16 v[92:95], a[40:43], v[136:139], v[92:95]
    ds_read_b64_tr_b16 v[118:119], v9 offset:51200
    buffer_load_dwordx4 v1, s[36:39], s6 offen offset:2048 sc1 lds
    v_mfma_f32_16x16x32_bf16 v[96:99], a[44:47], v[136:139], v[96:99]
    ds_read_b64_tr_b16 v[120:121], v10 offset:49152
    s_waitcnt lgkmcnt(8)
    v_mfma_f32_16x16x32_bf16 v[100:103], a[36:39], v[140:143], v[100:103]
    ds_read_b64_tr_b16 v[122:123], v10 offset:51200
    v_mfma_f32_16x16x32_bf16 v[104:107], a[40:43], v[140:143], v[104:107]
    ds_read2_b64 v[152:155], v3 offset0:40 offset1:44
    v_mfma_f32_16x16x32_bf16 v[108:111], a[44:47], v[140:143], v[108:111]
    ds_read_b64_tr_b16 v[124:125], v11 offset:49152
    buffer_load_dwordx4 v1, s[36:39], s6 offen offset:3072 sc1 lds
    s_waitcnt vmcnt(15) lgkmcnt(7)
    v_mfma_f32_16x16x32_bf16 v[16:19], a[144:147], v[112:115], v[16:19]
    ds_read_b64_tr_b16 v[126:127], v11 offset:51200
    s_add_u32 m0, s63, 98304
    s_add_u32 s6, m0, s49
    s_waitcnt vmcnt(14)
    v_mfma_f32_16x16x32_bf16 v[20:23], a[148:151], v[112:115], v[20:23]
    ds_read_b64 v[208:209], v7
    s_waitcnt vmcnt(13)
    v_mfma_f32_16x16x32_bf16 v[24:27], a[152:155], v[112:115], v[24:27]
    ds_read_b64_tr_b16 v[128:129], v8 offset:53248
    s_waitcnt lgkmcnt(7)
    v_mfma_f32_16x16x32_bf16 v[28:31], a[144:147], v[116:119], v[28:31]
    ds_read_b64_tr_b16 v[130:131], v8 offset:55296
    buffer_load_dwordx4 v1, s[36:39], s6 offen offset:0 sc1 lds
    v_mfma_f32_16x16x32_bf16 v[32:35], a[148:151], v[116:119], v[32:35]
    ds_read_b64_tr_b16 v[132:133], v9 offset:53248
    v_mfma_f32_16x16x32_bf16 v[36:39], a[152:155], v[116:119], v[36:39]
    ds_read_b64 v[210:211], v7 offset:128
    v_add_u32 v7, 0x10000, v7
    s_waitcnt lgkmcnt(8)
    v_mfma_f32_16x16x32_bf16 v[40:43], a[144:147], v[120:123], v[40:43]
    ds_read_b64_tr_b16 v[134:135], v9 offset:55296
    v_mfma_f32_16x16x32_bf16 v[44:47], a[148:151], v[120:123], v[44:47]
    ds_read_b64_tr_b16 v[136:137], v10 offset:53248
    buffer_load_dwordx4 v1, s[36:39], s6 offen offset:1024 sc1 lds
    v_mfma_f32_16x16x32_bf16 v[48:51], a[152:155], v[120:123], v[48:51]
    ds_read_b64_tr_b16 v[138:139], v10 offset:55296
    s_waitcnt lgkmcnt(8)
    v_mfma_f32_16x16x32_bf16 v[52:55], a[144:147], v[124:127], v[52:55]
    ds_read_b64_tr_b16 v[140:141], v11 offset:53248
    v_mfma_f32_16x16x32_bf16 v[56:59], a[148:151], v[124:127], v[56:59]
    ds_read_b64_tr_b16 v[142:143], v11 offset:55296
    v_mfma_f32_16x16x32_bf16 v[60:63], a[152:155], v[124:127], v[60:63]
    buffer_load_dwordx4 v1, s[36:39], s6 offen offset:2048 sc1 lds
    s_waitcnt vmcnt(15) lgkmcnt(7)
    v_mfma_f32_16x16x32_bf16 v[16:19], a[156:159], v[128:131], v[16:19]
    ds_read_b64_tr_b16 v[112:113], v8 offset:57344
    s_waitcnt vmcnt(14)
    v_mfma_f32_16x16x32_bf16 v[20:23], a[160:163], v[128:131], v[20:23]
    ds_read_b64_tr_b16 v[114:115], v8 offset:59392
    s_waitcnt vmcnt(13)
    v_mfma_f32_16x16x32_bf16 v[24:27], a[164:167], v[128:131], v[24:27]
    ds_read_b64_tr_b16 v[116:117], v9 offset:57344
    s_waitcnt lgkmcnt(7)
    v_mfma_f32_16x16x32_bf16 v[28:31], a[156:159], v[132:135], v[28:31]
    buffer_load_dwordx4 v1, s[36:39], s6 offen offset:3072 sc1 lds
    v_mfma_f32_16x16x32_bf16 v[32:35], a[160:163], v[132:135], v[32:35]
    ds_read_b64_tr_b16 v[118:119], v9 offset:59392
    s_add_u32 m0, s63, 114688
    s_add_u32 s6, m0, s49
    v_mfma_f32_16x16x32_bf16 v[36:39], a[164:167], v[132:135], v[36:39]
    ds_read_b64_tr_b16 v[120:121], v10 offset:57344
    s_waitcnt lgkmcnt(7)
    v_mfma_f32_16x16x32_bf16 v[40:43], a[156:159], v[136:139], v[40:43]
    ds_read_b64_tr_b16 v[122:123], v10 offset:59392
    v_mfma_f32_16x16x32_bf16 v[44:47], a[160:163], v[136:139], v[44:47]
    buffer_load_dwordx4 v1, s[36:39], s6 offen offset:0 sc1 lds
    v_mfma_f32_16x16x32_bf16 v[48:51], a[164:167], v[136:139], v[48:51]
    ds_read_b64_tr_b16 v[124:125], v11 offset:57344
    s_waitcnt lgkmcnt(7)
    v_mfma_f32_16x16x32_bf16 v[52:55], a[156:159], v[140:143], v[52:55]
    ds_read_b64_tr_b16 v[126:127], v11 offset:59392
    v_mfma_f32_16x16x32_bf16 v[56:59], a[160:163], v[140:143], v[56:59]
    buffer_load_dwordx4 v1, s[36:39], s6 offen offset:1024 sc1 lds
    v_mfma_f32_16x16x32_bf16 v[60:63], a[164:167], v[140:143], v[60:63]
    s_waitcnt vmcnt(13) lgkmcnt(2)
    v_mfma_f32_16x16x32_bf16 v[16:19], a[168:171], v[112:115], v[16:19]
    ds_read_b64_tr_b16 v[128:129], v8 offset:61440
    v_mfma_f32_16x16x32_bf16 v[20:23], a[172:175], v[112:115], v[20:23]
    ds_read_b64_tr_b16 v[130:131], v8 offset:63488
    v_mfma_f32_16x16x32_bf16 v[24:27], a[176:179], v[112:115], v[24:27]
    ds_read_b64_tr_b16 v[132:133], v9 offset:61440
    v_mfma_f32_16x16x32_bf16 v[28:31], a[168:171], v[116:119], v[28:31]
    buffer_load_dwordx4 v1, s[36:39], s6 offen offset:2048 sc1 lds
    v_mfma_f32_16x16x32_bf16 v[32:35], a[172:175], v[116:119], v[32:35]
    ds_read_b64_tr_b16 v[134:135], v9 offset:63488
    v_mfma_f32_16x16x32_bf16 v[36:39], a[176:179], v[116:119], v[36:39]
    ds_read_b64_tr_b16 v[136:137], v10 offset:61440
    v_mfma_f32_16x16x32_bf16 v[40:43], a[168:171], v[120:123], v[40:43]
    ds_read_b64_tr_b16 v[138:139], v10 offset:63488
    v_mfma_f32_16x16x32_bf16 v[44:47], a[172:175], v[120:123], v[44:47]
    buffer_load_dwordx4 v1, s[36:39], s6 offen offset:3072 sc1 lds
    v_mfma_f32_16x16x32_bf16 v[48:51], a[176:179], v[120:123], v[48:51]
    ds_read_b64_tr_b16 v[140:141], v11 offset:61440
    v_mov_b32 v228, -1
    v_mov_b32 v229, -1
    v_mov_b32 v230, -1
    v_mov_b32 v231, -1
    s_waitcnt lgkmcnt(7)
    v_mfma_f32_16x16x32_bf16 v[52:55], a[168:171], v[124:127], v[52:55]
    ds_read_b64_tr_b16 v[142:143], v11 offset:63488
    v_mfma_f32_16x16x32_bf16 v[56:59], a[172:175], v[124:127], v[56:59]
    buffer_store_dwordx4 v[228:231], v6, s[36:39], s17 offen offset:0 sc1
    v_mfma_f32_16x16x32_bf16 v[60:63], a[176:179], v[124:127], v[60:63]
    s_waitcnt vmcnt(13) lgkmcnt(2)
    v_mfma_f32_16x16x32_bf16 v[16:19], a[180:183], v[128:131], v[16:19]
    s_waitcnt vmcnt(9)
    s_barrier
    v_mfma_f32_16x16x32_bf16 v[20:23], a[184:187], v[128:131], v[20:23]
    ds_read_b64_tr_b16 v[112:113], v12 offset:16384
    v_mfma_f32_16x16x32_bf16 v[24:27], a[188:191], v[128:131], v[24:27]
    ds_read_b64_tr_b16 v[114:115], v12 offset:18432
    v_mfma_f32_16x16x32_bf16 v[28:31], a[180:183], v[132:135], v[28:31]
    ds_read_b64_tr_b16 v[116:117], v13 offset:16384
    buffer_store_dwordx4 v[228:231], v6, s[36:39], s17 offen offset:256 sc1
    v_mfma_f32_16x16x32_bf16 v[32:35], a[184:187], v[132:135], v[32:35]
    buffer_store_dwordx4 v[228:231], v6, s[36:39], s17 offen offset:512 sc1
    v_mfma_f32_16x16x32_bf16 v[36:39], a[188:191], v[132:135], v[36:39]
    ds_read_b64_tr_b16 v[118:119], v13 offset:18432
    v_mfma_f32_16x16x32_bf16 v[40:43], a[180:183], v[136:139], v[40:43]
    ds_read_b64_tr_b16 v[120:121], v14 offset:16384
    v_mfma_f32_16x16x32_bf16 v[44:47], a[184:187], v[136:139], v[44:47]
    ds_read_b64_tr_b16 v[122:123], v14 offset:18432
    v_mfma_f32_16x16x32_bf16 v[48:51], a[188:191], v[136:139], v[48:51]
    buffer_load_dwordx4 a[192:195], v1, s[36:39], s26 offen offset:0 sc1
    s_waitcnt lgkmcnt(6)
    v_mfma_f32_16x16x32_bf16 v[52:55], a[180:183], v[140:143], v[52:55]
    ds_read_b64_tr_b16 v[124:125], v15 offset:16384
    v_mfma_f32_16x16x32_bf16 v[56:59], a[184:187], v[140:143], v[56:59]
    ds_read_b64_tr_b16 v[126:127], v15 offset:18432
    v_mfma_f32_16x16x32_bf16 v[60:63], a[188:191], v[140:143], v[60:63]
    s_waitcnt lgkmcnt(3)
    v_mfma_f32_16x16x32_bf16 v[64:67], a[48:51], v[112:115], v[64:67]
    ds_read_b64_tr_b16 v[128:129], v12 offset:20480
    v_mfma_f32_16x16x32_bf16 v[68:71], a[52:55], v[112:115], v[68:71]
    ds_read_b64_tr_b16 v[130:131], v12 offset:22528
    v_mfma_f32_16x16x32_bf16 v[72:75], a[56:59], v[112:115], v[72:75]
    ds_read_b64_tr_b16 v[132:133], v13 offset:20480
    v_mfma_f32_16x16x32_bf16 v[76:79], a[48:51], v[116:119], v[76:79]
    buffer_load_dwordx4 a[196:199], v1, s[36:39], s26 offen offset:1024 sc1
    v_mfma_f32_16x16x32_bf16 v[80:83], a[52:55], v[116:119], v[80:83]
    ds_read_b64_tr_b16 v[134:135], v13 offset:22528
    v_mfma_f32_16x16x32_bf16 v[84:87], a[56:59], v[116:119], v[84:87]
    ds_read_b64_tr_b16 v[136:137], v14 offset:20480
    s_waitcnt lgkmcnt(7)
    v_mfma_f32_16x16x32_bf16 v[88:91], a[48:51], v[120:123], v[88:91]
    ds_read_b64_tr_b16 v[138:139], v14 offset:22528
    v_mfma_f32_16x16x32_bf16 v[92:95], a[52:55], v[120:123], v[92:95]
    buffer_load_dwordx4 a[200:203], v1, s[36:39], s27 offen offset:0 sc1
    v_mfma_f32_16x16x32_bf16 v[96:99], a[56:59], v[120:123], v[96:99]
    ds_read_b64_tr_b16 v[140:141], v15 offset:20480
    s_waitcnt lgkmcnt(7)
    v_mfma_f32_16x16x32_bf16 v[100:103], a[48:51], v[124:127], v[100:103]
    ds_read_b64_tr_b16 v[142:143], v15 offset:22528
    v_mfma_f32_16x16x32_bf16 v[104:107], a[52:55], v[124:127], v[104:107]
    buffer_load_dwordx4 a[204:207], v1, s[36:39], s27 offen offset:1024 sc1
    s_add_u32 s26, s26, 4096
    s_add_u32 s27, s27, 4096
    v_mfma_f32_16x16x32_bf16 v[108:111], a[56:59], v[124:127], v[108:111]
    s_waitcnt lgkmcnt(2)
    v_mfma_f32_16x16x32_bf16 v[64:67], a[60:63], v[128:131], v[64:67]
    s_barrier
    v_mfma_f32_16x16x32_bf16 v[68:71], a[64:67], v[128:131], v[68:71]
    ds_read_b64 v[168:169], v249 offset:0
    v_mfma_f32_16x16x32_bf16 v[72:75], a[68:71], v[128:131], v[72:75]
    ds_read_b64_tr_b16 v[112:113], v12 offset:24576
    v_mfma_f32_16x16x32_bf16 v[76:79], a[60:63], v[132:135], v[76:79]
    ds_read_b64_tr_b16 v[114:115], v12 offset:26624
    buffer_load_dwordx4 a[208:211], v1, s[36:39], s26 offen offset:0 sc1
    v_mfma_f32_16x16x32_bf16 v[80:83], a[64:67], v[132:135], v[80:83]
    ds_read_b64_tr_b16 v[116:117], v13 offset:24576
    v_mfma_f32_16x16x32_bf16 v[84:87], a[68:71], v[132:135], v[84:87]
    ds_read_b64 v[170:171], v249 offset:128
    v_mfma_f32_16x16x32_bf16 v[88:91], a[60:63], v[136:139], v[88:91]
    ds_read_b64_tr_b16 v[118:119], v13 offset:26624
    v_mfma_f32_16x16x32_bf16 v[92:95], a[64:67], v[136:139], v[92:95]
    ds_read_b64_tr_b16 v[120:121], v14 offset:24576
    buffer_load_dwordx4 a[212:215], v1, s[36:39], s26 offen offset:1024 sc1
    v_mfma_f32_16x16x32_bf16 v[96:99], a[68:71], v[136:139], v[96:99]
    ds_read_b64_tr_b16 v[122:123], v14 offset:26624
    s_waitcnt lgkmcnt(8)
    v_mfma_f32_16x16x32_bf16 v[100:103], a[60:63], v[140:143], v[100:103]
    ds_read_b64 v[172:173], v249 offset:256
    v_mfma_f32_16x16x32_bf16 v[104:107], a[64:67], v[140:143], v[104:107]
    ds_read_b64_tr_b16 v[124:125], v15 offset:24576
    v_mfma_f32_16x16x32_bf16 v[108:111], a[68:71], v[140:143], v[108:111]
    ds_read_b64_tr_b16 v[126:127], v15 offset:26624
    buffer_load_dwordx4 a[216:219], v1, s[36:39], s27 offen offset:0 sc1
    s_waitcnt lgkmcnt(8)
    v_mfma_f32_16x16x32_bf16 v[64:67], a[72:75], v[112:115], v[64:67]
    ds_read_b64 v[174:175], v249 offset:384
    v_mul_f32 v176, 0xbfb8aa3b, v168
    s_waitcnt lgkmcnt(7)
    v_mul_f32 v177, 0xbfb8aa3b, v170
    s_waitcnt lgkmcnt(3)
    v_mul_f32 v178, 0xbfb8aa3b, v172
    v_mfma_f32_16x16x32_bf16 v[68:71], a[76:79], v[112:115], v[68:71]
    ds_read_b64_tr_b16 v[128:129], v12 offset:28672
    s_waitcnt lgkmcnt(1)
    v_mul_f32 v179, 0xbfb8aa3b, v174
    v_pk_fma_f32 v[180:181], v[168:169], v[144:145], v[156:157] op_sel:[1,0,0] op_sel_hi:[1,1,1]
    v_pk_fma_f32 v[182:183], v[168:169], v[146:147], v[158:159] op_sel:[1,0,0] op_sel_hi:[1,1,1]
    v_pk_fma_f32 v[180:181], v[176:177], v[16:17], v[180:181] op_sel:[0,0,0] op_sel_hi:[0,1,1]
    v_pk_fma_f32 v[184:185], v[170:171], v[144:145], v[156:157] op_sel:[1,0,0] op_sel_hi:[1,1,1]
    v_pk_fma_f32 v[186:187], v[170:171], v[146:147], v[158:159] op_sel:[1,0,0] op_sel_hi:[1,1,1]
    v_pk_fma_f32 v[184:185], v[176:177], v[28:29], v[184:185] op_sel:[1,0,0] op_sel_hi:[1,1,1]
    v_pk_fma_f32 v[188:189], v[172:173], v[144:145], v[156:157] op_sel:[1,0,0] op_sel_hi:[1,1,1]
    v_pk_fma_f32 v[190:191], v[172:173], v[146:147], v[158:159] op_sel:[1,0,0] op_sel_hi:[1,1,1]
    v_pk_fma_f32 v[188:189], v[178:179], v[40:41], v[188:189] op_sel:[0,0,0] op_sel_hi:[0,1,1]
    v_pk_fma_f32 v[192:193], v[174:175], v[144:145], v[156:157] op_sel:[1,0,0] op_sel_hi:[1,1,1]
    v_pk_fma_f32 v[194:195], v[174:175], v[146:147], v[158:159] op_sel:[1,0,0] op_sel_hi:[1,1,1]
    v_pk_fma_f32 v[192:193], v[178:179], v[52:53], v[192:193] op_sel:[1,0,0] op_sel_hi:[1,1,1]
    v_pk_fma_f32 v[182:183], v[168:169], v[18:19], v[182:183] op_sel_hi:[0,1,1]
    v_pk_fma_f32 v[186:187], v[170:171], v[30:31], v[186:187] op_sel_hi:[0,1,1]
    v_pk_fma_f32 v[190:191], v[172:173], v[42:43], v[190:191] op_sel_hi:[0,1,1]
    v_pk_fma_f32 v[194:195], v[174:175], v[54:55], v[194:195] op_sel_hi:[0,1,1]
    v_mfma_f32_16x16x32_bf16 v[72:75], a[80:83], v[112:115], v[72:75]
    ds_read_b64_tr_b16 v[130:131], v12 offset:30720
    v_exp_f32 v180, v180
    v_mfma_f32_16x16x32_bf16 v[76:79], a[72:75], v[116:119], v[76:79]
    ds_read_b64_tr_b16 v[132:133], v13 offset:28672
    buffer_load_dwordx4 a[220:223], v1, s[36:39], s27 offen offset:1024 sc1
    s_add_u32 s26, s26, 4096
    v_mfma_f32_16x16x32_bf16 v[80:83], a[76:79], v[116:119], v[80:83]
    ds_read_b64_tr_b16 v[134:135], v13 offset:30720
    s_add_u32 s27, s27, 4096
    v_exp_f32 v181, v181
    v_mfma_f32_16x16x32_bf16 v[84:87], a[80:83], v[116:119], v[84:87]
    ds_read_b64_tr_b16 v[136:137], v14 offset:28672
    v_exp_f32 v184, v184
    v_mfma_f32_16x16x32_bf16 v[88:91], a[72:75], v[120:123], v[88:91]
    ds_read_b64_tr_b16 v[138:139], v14 offset:30720
    v_exp_f32 v185, v185
    v_mfma_f32_16x16x32_bf16 v[92:95], a[76:79], v[120:123], v[92:95]
    buffer_load_dwordx4 a[224:227], v1, s[36:39], s26 offen offset:0 sc1
    v_exp_f32 v188, v188
    v_mfma_f32_16x16x32_bf16 v[96:99], a[80:83], v[120:123], v[96:99]
    ds_read_b64_tr_b16 v[140:141], v15 offset:28672
    v_exp_f32 v189, v189
    v_exp_f32 v192, v192
    v_mfma_f32_16x16x32_bf16 v[100:103], a[72:75], v[124:127], v[100:103]
    ds_read_b64_tr_b16 v[142:143], v15 offset:30720
    v_exp_f32 v193, v193
    v_pk_add_f32 v[180:181], v[180:181], 1.0 op_sel_hi:[1,0]
    v_pk_add_f32 v[184:185], v[184:185], 1.0 op_sel_hi:[1,0]
    v_pk_add_f32 v[188:189], v[188:189], 1.0 op_sel_hi:[1,0]
    v_pk_add_f32 v[192:193], v[192:193], 1.0 op_sel_hi:[1,0]
    v_mfma_f32_16x16x32_bf16 v[104:107], a[76:79], v[124:127], v[104:107]
    buffer_load_dwordx4 a[228:231], v1, s[36:39], s26 offen offset:1024 sc1
    v_rcp_f32 v180, v180
    v_mfma_f32_16x16x32_bf16 v[108:111], a[80:83], v[124:127], v[108:111]
    s_waitcnt lgkmcnt(2)
    v_rcp_f32 v181, v181
    v_rcp_f32 v184, v184
    v_mfma_f32_16x16x32_bf16 v[64:67], a[84:87], v[128:131], v[64:67]
    s_waitcnt vmcnt(13)
    s_barrier
    v_rcp_f32 v185, v185
    v_mfma_f32_16x16x32_bf16 v[68:71], a[88:91], v[128:131], v[68:71]
    ds_read_b64_tr_b16 v[112:113], v12 offset:32768
    v_rcp_f32 v188, v188
    v_mfma_f32_16x16x32_bf16 v[72:75], a[92:95], v[128:131], v[72:75]
    ds_read_b64_tr_b16 v[114:115], v12 offset:34816
    v_rcp_f32 v189, v189
    v_rcp_f32 v192, v192
    v_mfma_f32_16x16x32_bf16 v[76:79], a[84:87], v[132:135], v[76:79]
    ds_read_b64_tr_b16 v[116:117], v13 offset:32768
    buffer_load_dwordx4 a[232:235], v1, s[36:39], s27 offen offset:0 sc1
    v_mfma_f32_16x16x32_bf16 v[80:83], a[88:91], v[132:135], v[80:83]
    buffer_load_dwordx4 a[236:239], v1, s[36:39], s27 offen offset:1024 sc1
    s_add_u32 s26, s26, 4096
    s_add_u32 s27, s27, 4096
    v_mfma_f32_16x16x32_bf16 v[84:87], a[92:95], v[132:135], v[84:87]
    ds_read_b64_tr_b16 v[118:119], v13 offset:34816
    v_rcp_f32 v193, v193
    v_pk_mul_f32 v[180:181], v[180:181], v[182:183]
    v_pk_mul_f32 v[184:185], v[184:185], v[186:187]
    v_pk_mul_f32 v[188:189], v[188:189], v[190:191]
    v_pk_mul_f32 v[192:193], v[192:193], v[194:195]
    v_mfma_f32_16x16x32_bf16 v[88:91], a[84:87], v[136:139], v[88:91]
    ds_read_b64_tr_b16 v[120:121], v14 offset:32768
    v_cvt_pk_bf16_f32 v196, v180, v181
    v_cvt_pk_bf16_f32 v197, v184, v185
    v_cvt_pk_bf16_f32 v198, v188, v189
    v_cvt_pk_bf16_f32 v199, v192, v193
    v_mfma_f32_16x16x32_bf16 v[92:95], a[88:91], v[136:139], v[92:95]
    ds_read_b64_tr_b16 v[122:123], v14 offset:34816
    v_permlane32_swap_b32 v196, v198
    v_mfma_f32_16x16x32_bf16 v[96:99], a[92:95], v[136:139], v[96:99]
    buffer_load_dwordx4 a[240:243], v1, s[36:39], s26 offen offset:0 sc1
    v_permlane32_swap_b32 v197, v199
    s_waitcnt lgkmcnt(6)
    v_mfma_f32_16x16x32_bf16 v[100:103], a[84:87], v[140:143], v[100:103]
    ds_read_b64_tr_b16 v[124:125], v15 offset:32768
    v_permlane16_swap_b32 v196, v197
    v_mfma_f32_16x16x32_bf16 v[104:107], a[88:91], v[140:143], v[104:107]
    ds_read_b64_tr_b16 v[126:127], v15 offset:34816
    v_permlane16_swap_b32 v198, v199
    v_mfma_f32_16x16x32_bf16 v[108:111], a[92:95], v[140:143], v[108:111]
    buffer_store_dwordx4 v[196:199], v6, s[36:39], s16 offen offset:0 sc1
    v_pk_fma_f32 v[180:181], v[168:169], v[148:149], v[160:161] op_sel:[1,0,0] op_sel_hi:[1,1,1]
    v_pk_fma_f32 v[182:183], v[168:169], v[150:151], v[162:163] op_sel:[1,0,0] op_sel_hi:[1,1,1]
    v_pk_fma_f32 v[180:181], v[176:177], v[20:21], v[180:181] op_sel:[0,0,0] op_sel_hi:[0,1,1]
    v_pk_fma_f32 v[184:185], v[170:171], v[148:149], v[160:161] op_sel:[1,0,0] op_sel_hi:[1,1,1]
    v_pk_fma_f32 v[186:187], v[170:171], v[150:151], v[162:163] op_sel:[1,0,0] op_sel_hi:[1,1,1]
    v_pk_fma_f32 v[184:185], v[176:177], v[32:33], v[184:185] op_sel:[1,0,0] op_sel_hi:[1,1,1]
    v_pk_fma_f32 v[188:189], v[172:173], v[148:149], v[160:161] op_sel:[1,0,0] op_sel_hi:[1,1,1]
    v_pk_fma_f32 v[190:191], v[172:173], v[150:151], v[162:163] op_sel:[1,0,0] op_sel_hi:[1,1,1]
    v_pk_fma_f32 v[188:189], v[178:179], v[44:45], v[188:189] op_sel:[0,0,0] op_sel_hi:[0,1,1]
    v_pk_fma_f32 v[192:193], v[174:175], v[148:149], v[160:161] op_sel:[1,0,0] op_sel_hi:[1,1,1]
    v_pk_fma_f32 v[194:195], v[174:175], v[150:151], v[162:163] op_sel:[1,0,0] op_sel_hi:[1,1,1]
    v_pk_fma_f32 v[192:193], v[178:179], v[56:57], v[192:193] op_sel:[1,0,0] op_sel_hi:[1,1,1]
    v_pk_fma_f32 v[182:183], v[168:169], v[22:23], v[182:183] op_sel_hi:[0,1,1]
    v_pk_fma_f32 v[186:187], v[170:171], v[34:35], v[186:187] op_sel_hi:[0,1,1]
    v_pk_fma_f32 v[190:191], v[172:173], v[46:47], v[190:191] op_sel_hi:[0,1,1]
    v_pk_fma_f32 v[194:195], v[174:175], v[58:59], v[194:195] op_sel_hi:[0,1,1]
    s_waitcnt lgkmcnt(6)
    v_mfma_f32_16x16x32_bf16 v[64:67], a[96:99], v[112:115], v[64:67]
    ds_read_b64_tr_b16 v[128:129], v12 offset:36864
    v_exp_f32 v180, v180
    v_mfma_f32_16x16x32_bf16 v[68:71], a[100:103], v[112:115], v[68:71]
    ds_read_b64_tr_b16 v[130:131], v12 offset:38912
    v_exp_f32 v181, v181
    v_mfma_f32_16x16x32_bf16 v[72:75], a[104:107], v[112:115], v[72:75]
    ds_read_b64_tr_b16 v[132:133], v13 offset:36864
    v_exp_f32 v184, v184
    s_waitcnt lgkmcnt(7)
    v_mfma_f32_16x16x32_bf16 v[76:79], a[96:99], v[116:119], v[76:79]
    buffer_load_dwordx4 a[244:247], v1, s[36:39], s26 offen offset:1024 sc1
    v_exp_f32 v185, v185
    v_exp_f32 v188, v188
    v_mfma_f32_16x16x32_bf16 v[80:83], a[100:103], v[116:119], v[80:83]
    ds_read_b64_tr_b16 v[134:135], v13 offset:38912
    v_exp_f32 v189, v189
    v_mfma_f32_16x16x32_bf16 v[84:87], a[104:107], v[116:119], v[84:87]
    ds_read_b64_tr_b16 v[136:137], v14 offset:36864
    v_exp_f32 v192, v192
    s_waitcnt lgkmcnt(7)
    v_mfma_f32_16x16x32_bf16 v[88:91], a[96:99], v[120:123], v[88:91]
    ds_read_b64_tr_b16 v[138:139], v14 offset:38912
    v_exp_f32 v193, v193
    v_pk_add_f32 v[180:181], v[180:181], 1.0 op_sel_hi:[1,0]
    v_pk_add_f32 v[184:185], v[184:185], 1.0 op_sel_hi:[1,0]
    v_pk_add_f32 v[188:189], v[188:189], 1.0 op_sel_hi:[1,0]
    v_pk_add_f32 v[192:193], v[192:193], 1.0 op_sel_hi:[1,0]
    v_mfma_f32_16x16x32_bf16 v[92:95], a[100:103], v[120:123], v[92:95]
    buffer_load_dwordx4 a[248:251], v1, s[36:39], s27 offen offset:0 sc1
    v_rcp_f32 v180, v180
    v_rcp_f32 v181, v181
    v_mfma_f32_16x16x32_bf16 v[96:99], a[104:107], v[120:123], v[96:99]
    ds_read_b64_tr_b16 v[140:141], v15 offset:36864
    v_rcp_f32 v184, v184
    s_waitcnt lgkmcnt(7)
    v_mfma_f32_16x16x32_bf16 v[100:103], a[96:99], v[124:127], v[100:103]
    ds_read_b64_tr_b16 v[142:143], v15 offset:38912
    v_rcp_f32 v185, v185
    v_mfma_f32_16x16x32_bf16 v[104:107], a[100:103], v[124:127], v[104:107]
    buffer_load_dwordx4 a[252:255], v1, s[36:39], s27 offen offset:1024 sc1
    s_add_u32 s26, s26, 4096
    s_add_u32 s27, s27, 4096
    v_mfma_f32_16x16x32_bf16 v[108:111], a[104:107], v[124:127], v[108:111]
    s_waitcnt lgkmcnt(2)
    v_rcp_f32 v188, v188
    v_rcp_f32 v189, v189
    v_mfma_f32_16x16x32_bf16 v[64:67], a[108:111], v[128:131], v[64:67]
    ds_read_b64_tr_b16 v[112:113], v12 offset:40960
    v_rcp_f32 v192, v192
    v_mfma_f32_16x16x32_bf16 v[68:71], a[112:115], v[128:131], v[68:71]
    ds_read_b64_tr_b16 v[114:115], v12 offset:43008
    v_rcp_f32 v193, v193
    v_pk_mul_f32 v[180:181], v[180:181], v[182:183]
    v_pk_mul_f32 v[184:185], v[184:185], v[186:187]
    v_pk_mul_f32 v[188:189], v[188:189], v[190:191]
    v_pk_mul_f32 v[192:193], v[192:193], v[194:195]
    v_mfma_f32_16x16x32_bf16 v[72:75], a[116:119], v[128:131], v[72:75]
    ds_read_b64_tr_b16 v[116:117], v13 offset:40960
    v_cvt_pk_bf16_f32 v200, v180, v181
    v_cvt_pk_bf16_f32 v201, v184, v185
    v_cvt_pk_bf16_f32 v202, v188, v189
    v_cvt_pk_bf16_f32 v203, v192, v193
    v_mfma_f32_16x16x32_bf16 v[76:79], a[108:111], v[132:135], v[76:79]
    buffer_load_dwordx4 a[0:3], v1, s[36:39], s26 offen offset:0 sc1
    v_permlane32_swap_b32 v200, v202
    v_mfma_f32_16x16x32_bf16 v[80:83], a[112:115], v[132:135], v[80:83]
    ds_read_b64_tr_b16 v[118:119], v13 offset:43008
    v_permlane32_swap_b32 v201, v203
    v_mfma_f32_16x16x32_bf16 v[84:87], a[116:119], v[132:135], v[84:87]
    ds_read_b64_tr_b16 v[120:121], v14 offset:40960
    v_permlane16_swap_b32 v200, v201
    v_mfma_f32_16x16x32_bf16 v[88:91], a[108:111], v[136:139], v[88:91]
    ds_read_b64_tr_b16 v[122:123], v14 offset:43008
    v_permlane16_swap_b32 v202, v203
    v_mfma_f32_16x16x32_bf16 v[92:95], a[112:115], v[136:139], v[92:95]
    buffer_store_dwordx4 v[200:203], v6, s[36:39], s16 offen offset:256 sc1
    v_pk_fma_f32 v[180:181], v[168:169], v[152:153], v[164:165] op_sel:[1,0,0] op_sel_hi:[1,1,1]
    v_pk_fma_f32 v[182:183], v[168:169], v[154:155], v[166:167] op_sel:[1,0,0] op_sel_hi:[1,1,1]
    v_pk_fma_f32 v[180:181], v[176:177], v[24:25], v[180:181] op_sel:[0,0,0] op_sel_hi:[0,1,1]
    v_pk_fma_f32 v[184:185], v[170:171], v[152:153], v[164:165] op_sel:[1,0,0] op_sel_hi:[1,1,1]
    v_pk_fma_f32 v[186:187], v[170:171], v[154:155], v[166:167] op_sel:[1,0,0] op_sel_hi:[1,1,1]
    v_pk_fma_f32 v[184:185], v[176:177], v[36:37], v[184:185] op_sel:[1,0,0] op_sel_hi:[1,1,1]
    v_pk_fma_f32 v[188:189], v[172:173], v[152:153], v[164:165] op_sel:[1,0,0] op_sel_hi:[1,1,1]
    v_pk_fma_f32 v[190:191], v[172:173], v[154:155], v[166:167] op_sel:[1,0,0] op_sel_hi:[1,1,1]
    v_pk_fma_f32 v[188:189], v[178:179], v[48:49], v[188:189] op_sel:[0,0,0] op_sel_hi:[0,1,1]
    v_pk_fma_f32 v[192:193], v[174:175], v[152:153], v[164:165] op_sel:[1,0,0] op_sel_hi:[1,1,1]
    v_pk_fma_f32 v[194:195], v[174:175], v[154:155], v[166:167] op_sel:[1,0,0] op_sel_hi:[1,1,1]
    v_pk_fma_f32 v[192:193], v[178:179], v[60:61], v[192:193] op_sel:[1,0,0] op_sel_hi:[1,1,1]
    v_pk_fma_f32 v[182:183], v[168:169], v[26:27], v[182:183] op_sel_hi:[0,1,1]
    v_pk_fma_f32 v[186:187], v[170:171], v[38:39], v[186:187] op_sel_hi:[0,1,1]
    v_pk_fma_f32 v[190:191], v[172:173], v[50:51], v[190:191] op_sel_hi:[0,1,1]
    v_pk_fma_f32 v[194:195], v[174:175], v[62:63], v[194:195] op_sel_hi:[0,1,1]
    v_mfma_f32_16x16x32_bf16 v[96:99], a[116:119], v[136:139], v[96:99]
    ds_read_b64_tr_b16 v[124:125], v15 offset:40960
    buffer_load_dwordx4 a[4:7], v1, s[36:39], s26 offen offset:1024 sc1
    s_waitcnt lgkmcnt(7)
    v_mfma_f32_16x16x32_bf16 v[100:103], a[108:111], v[140:143], v[100:103]
    ds_read_b64_tr_b16 v[126:127], v15 offset:43008
    v_exp_f32 v180, v180
    v_mfma_f32_16x16x32_bf16 v[104:107], a[112:115], v[140:143], v[104:107]
    buffer_load_dwordx4 a[8:11], v1, s[36:39], s27 offen offset:0 sc1
    v_exp_f32 v181, v181
    v_mfma_f32_16x16x32_bf16 v[108:111], a[116:119], v[140:143], v[108:111]
    s_waitcnt lgkmcnt(2)
    v_exp_f32 v184, v184
    v_exp_f32 v185, v185
    v_mfma_f32_16x16x32_bf16 v[64:67], a[120:123], v[112:115], v[64:67]
    ds_read_b64_tr_b16 v[128:129], v12 offset:45056
    v_exp_f32 v188, v188
    v_mfma_f32_16x16x32_bf16 v[68:71], a[124:127], v[112:115], v[68:71]
    ds_read_b64_tr_b16 v[130:131], v12 offset:47104
    v_exp_f32 v189, v189
    v_exp_f32 v192, v192
    v_mfma_f32_16x16x32_bf16 v[72:75], a[128:131], v[112:115], v[72:75]
    ds_read_b64_tr_b16 v[132:133], v13 offset:45056
    v_exp_f32 v193, v193
    v_pk_add_f32 v[180:181], v[180:181], 1.0 op_sel_hi:[1,0]
    v_pk_add_f32 v[184:185], v[184:185], 1.0 op_sel_hi:[1,0]
    v_pk_add_f32 v[188:189], v[188:189], 1.0 op_sel_hi:[1,0]
    v_pk_add_f32 v[192:193], v[192:193], 1.0 op_sel_hi:[1,0]
    v_mfma_f32_16x16x32_bf16 v[76:79], a[120:123], v[116:119], v[76:79]
    buffer_load_dwordx4 a[12:15], v1, s[36:39], s27 offen offset:1024 sc1
    s_add_u32 s26, s26, 4096
    s_add_u32 s27, s27, 4096
    v_mfma_f32_16x16x32_bf16 v[80:83], a[124:127], v[116:119], v[80:83]
    ds_read_b64_tr_b16 v[134:135], v13 offset:47104
    v_rcp_f32 v180, v180
    v_mfma_f32_16x16x32_bf16 v[84:87], a[128:131], v[116:119], v[84:87]
    ds_read_b64_tr_b16 v[136:137], v14 offset:45056
    v_rcp_f32 v181, v181
    v_rcp_f32 v184, v184
    v_mfma_f32_16x16x32_bf16 v[88:91], a[120:123], v[120:123], v[88:91]
    ds_read_b64_tr_b16 v[138:139], v14 offset:47104
    v_rcp_f32 v185, v185
    v_mfma_f32_16x16x32_bf16 v[92:95], a[124:127], v[120:123], v[92:95]
    buffer_load_dwordx4 a[16:19], v1, s[36:39], s26 offen offset:0 sc1
    v_rcp_f32 v188, v188
    v_mfma_f32_16x16x32_bf16 v[96:99], a[128:131], v[120:123], v[96:99]
    ds_read_b64_tr_b16 v[140:141], v15 offset:45056
    v_rcp_f32 v189, v189
    s_waitcnt lgkmcnt(7)
    v_mfma_f32_16x16x32_bf16 v[100:103], a[120:123], v[124:127], v[100:103]
    ds_read_b64_tr_b16 v[142:143], v15 offset:47104
    v_rcp_f32 v192, v192
    v_rcp_f32 v193, v193
    v_pk_mul_f32 v[180:181], v[180:181], v[182:183]
    v_pk_mul_f32 v[184:185], v[184:185], v[186:187]
    v_pk_mul_f32 v[188:189], v[188:189], v[190:191]
    v_pk_mul_f32 v[192:193], v[192:193], v[194:195]
    v_mfma_f32_16x16x32_bf16 v[104:107], a[124:127], v[124:127], v[104:107]
    buffer_load_dwordx4 a[20:23], v1, s[36:39], s26 offen offset:1024 sc1
    v_cvt_pk_bf16_f32 v204, v180, v181
    v_cvt_pk_bf16_f32 v205, v184, v185
    v_mfma_f32_16x16x32_bf16 v[108:111], a[128:131], v[124:127], v[108:111]
    s_waitcnt lgkmcnt(2)
    v_cvt_pk_bf16_f32 v206, v188, v189
    v_cvt_pk_bf16_f32 v207, v192, v193
    s_nop 0
    v_permlane32_swap_b32 v204, v206
    v_mfma_f32_16x16x32_bf16 v[64:67], a[132:135], v[128:131], v[64:67]
    ds_read_b64_tr_b16 v[112:113], v12 offset:49152
    v_permlane32_swap_b32 v205, v207
    v_mfma_f32_16x16x32_bf16 v[68:71], a[136:139], v[128:131], v[68:71]
    ds_read_b64_tr_b16 v[114:115], v12 offset:51200
    v_permlane16_swap_b32 v204, v205
    v_mfma_f32_16x16x32_bf16 v[72:75], a[140:143], v[128:131], v[72:75]
    ds_read_b64_tr_b16 v[116:117], v13 offset:49152
    v_permlane16_swap_b32 v206, v207
    v_mfma_f32_16x16x32_bf16 v[76:79], a[132:135], v[132:135], v[76:79]
    buffer_store_dwordx4 v[204:207], v6, s[36:39], s16 offen offset:512 sc1
    v_mfma_f32_16x16x32_bf16 v[80:83], a[136:139], v[132:135], v[80:83]
    ds_read_b64 v[212:213], v7
    buffer_load_dwordx4 a[24:27], v1, s[36:39], s27 offen offset:0 sc1
    v_mfma_f32_16x16x32_bf16 v[84:87], a[140:143], v[132:135], v[84:87]
    ds_read_b64 v[214:215], v7 offset:128
    v_mfma_f32_16x16x32_bf16 v[88:91], a[132:135], v[136:139], v[88:91]
    ds_read_b64_tr_b16 v[118:119], v13 offset:51200
    v_mfma_f32_16x16x32_bf16 v[92:95], a[136:139], v[136:139], v[92:95]
    ds_read_b64_tr_b16 v[120:121], v14 offset:49152
    buffer_load_dwordx4 a[28:31], v1, s[36:39], s27 offen offset:1024 sc1
    s_add_u32 s26, s26, 4096
    s_add_u32 s27, s27, 4096
    v_mfma_f32_16x16x32_bf16 v[96:99], a[140:143], v[136:139], v[96:99]
    ds_read_b64_tr_b16 v[122:123], v14 offset:51200
    s_waitcnt lgkmcnt(8)
    v_mfma_f32_16x16x32_bf16 v[100:103], a[132:135], v[140:143], v[100:103]
    ds_read_b64_tr_b16 v[124:125], v15 offset:49152
    v_mfma_f32_16x16x32_bf16 v[104:107], a[136:139], v[140:143], v[104:107]
    ds_read_b64_tr_b16 v[126:127], v15 offset:51200
    v_mfma_f32_16x16x32_bf16 v[108:111], a[140:143], v[140:143], v[108:111]
    buffer_load_dwordx4 a[32:35], v1, s[36:39], s26 offen offset:0 sc1
    s_waitcnt lgkmcnt(8)
    v_mfma_f32_16x16x32_bf16 v[64:67], a[144:147], v[112:115], v[64:67]
    ds_read_b64_tr_b16 v[128:129], v12 offset:53248
    v_mfma_f32_16x16x32_bf16 v[68:71], a[148:151], v[112:115], v[68:71]
    ds_read_b64_tr_b16 v[130:131], v12 offset:55296
    v_mfma_f32_16x16x32_bf16 v[72:75], a[152:155], v[112:115], v[72:75]
    ds_read_b64_tr_b16 v[132:133], v13 offset:53248
    s_waitcnt lgkmcnt(7)
    v_mfma_f32_16x16x32_bf16 v[76:79], a[144:147], v[116:119], v[76:79]
    buffer_load_dwordx4 a[36:39], v1, s[36:39], s26 offen offset:1024 sc1
    v_mfma_f32_16x16x32_bf16 v[80:83], a[148:151], v[116:119], v[80:83]
    ds_read_b64_tr_b16 v[134:135], v13 offset:55296
    v_mfma_f32_16x16x32_bf16 v[84:87], a[152:155], v[116:119], v[84:87]
    ds_read_b64_tr_b16 v[136:137], v14 offset:53248
    s_waitcnt lgkmcnt(7)
    v_mfma_f32_16x16x32_bf16 v[88:91], a[144:147], v[120:123], v[88:91]
    ds_read_b64_tr_b16 v[138:139], v14 offset:55296
    v_mfma_f32_16x16x32_bf16 v[92:95], a[148:151], v[120:123], v[92:95]
    buffer_load_dwordx4 a[40:43], v1, s[36:39], s27 offen offset:0 sc1
    v_mfma_f32_16x16x32_bf16 v[96:99], a[152:155], v[120:123], v[96:99]
    ds_read_b64_tr_b16 v[140:141], v15 offset:53248
    s_waitcnt lgkmcnt(7)
    v_mfma_f32_16x16x32_bf16 v[100:103], a[144:147], v[124:127], v[100:103]
    ds_read_b64_tr_b16 v[142:143], v15 offset:55296
    v_mfma_f32_16x16x32_bf16 v[104:107], a[148:151], v[124:127], v[104:107]
    buffer_load_dwordx4 a[44:47], v1, s[36:39], s27 offen offset:1024 sc1
    s_add_u32 s26, s26, 4096
    s_add_u32 s27, s27, 4096
    v_mfma_f32_16x16x32_bf16 v[108:111], a[152:155], v[124:127], v[108:111]
    s_waitcnt lgkmcnt(2)
    v_mfma_f32_16x16x32_bf16 v[64:67], a[156:159], v[128:131], v[64:67]
    ds_read_b64_tr_b16 v[112:113], v12 offset:57344
    v_mfma_f32_16x16x32_bf16 v[68:71], a[160:163], v[128:131], v[68:71]
    ds_read_b64_tr_b16 v[114:115], v12 offset:59392
    v_mfma_f32_16x16x32_bf16 v[72:75], a[164:167], v[128:131], v[72:75]
    ds_read_b64_tr_b16 v[116:117], v13 offset:57344
    v_mfma_f32_16x16x32_bf16 v[76:79], a[156:159], v[132:135], v[76:79]
    buffer_load_dwordx4 a[48:51], v1, s[36:39], s26 offen offset:0 sc1
    v_mfma_f32_16x16x32_bf16 v[80:83], a[160:163], v[132:135], v[80:83]
    ds_read_b64_tr_b16 v[118:119], v13 offset:59392
    v_mfma_f32_16x16x32_bf16 v[84:87], a[164:167], v[132:135], v[84:87]
    ds_read_b64_tr_b16 v[120:121], v14 offset:57344
    v_mfma_f32_16x16x32_bf16 v[88:91], a[156:159], v[136:139], v[88:91]
    ds_read_b64_tr_b16 v[122:123], v14 offset:59392
    v_mfma_f32_16x16x32_bf16 v[92:95], a[160:163], v[136:139], v[92:95]
    buffer_load_dwordx4 a[52:55], v1, s[36:39], s26 offen offset:1024 sc1
    v_mfma_f32_16x16x32_bf16 v[96:99], a[164:167], v[136:139], v[96:99]
    ds_read_b64_tr_b16 v[124:125], v15 offset:57344
    s_waitcnt lgkmcnt(7)
    v_mfma_f32_16x16x32_bf16 v[100:103], a[156:159], v[140:143], v[100:103]
    ds_read_b64_tr_b16 v[126:127], v15 offset:59392
    v_mfma_f32_16x16x32_bf16 v[104:107], a[160:163], v[140:143], v[104:107]
    buffer_load_dwordx4 a[56:59], v1, s[36:39], s27 offen offset:0 sc1
    v_mfma_f32_16x16x32_bf16 v[108:111], a[164:167], v[140:143], v[108:111]
    s_waitcnt lgkmcnt(2)
    v_mfma_f32_16x16x32_bf16 v[64:67], a[168:171], v[112:115], v[64:67]
    ds_read_b64_tr_b16 v[128:129], v12 offset:61440
    v_mfma_f32_16x16x32_bf16 v[68:71], a[172:175], v[112:115], v[68:71]
    ds_read_b64_tr_b16 v[130:131], v12 offset:63488
    v_mfma_f32_16x16x32_bf16 v[72:75], a[176:179], v[112:115], v[72:75]
    ds_read_b64_tr_b16 v[132:133], v13 offset:61440
    v_mfma_f32_16x16x32_bf16 v[76:79], a[168:171], v[116:119], v[76:79]
    buffer_load_dwordx4 a[60:63], v1, s[36:39], s27 offen offset:1024 sc1
    s_add_u32 s26, s26, 4096
    s_add_u32 s27, s27, 4096
    v_mfma_f32_16x16x32_bf16 v[80:83], a[172:175], v[116:119], v[80:83]
    ds_read_b64_tr_b16 v[134:135], v13 offset:63488
    v_mfma_f32_16x16x32_bf16 v[84:87], a[176:179], v[116:119], v[84:87]
    ds_read_b64_tr_b16 v[136:137], v14 offset:61440
    v_mfma_f32_16x16x32_bf16 v[88:91], a[168:171], v[120:123], v[88:91]
    ds_read_b64_tr_b16 v[138:139], v14 offset:63488
    v_mfma_f32_16x16x32_bf16 v[92:95], a[172:175], v[120:123], v[92:95]
    buffer_load_dwordx4 a[64:67], v1, s[36:39], s26 offen offset:0 sc1
    v_mfma_f32_16x16x32_bf16 v[96:99], a[176:179], v[120:123], v[96:99]
    ds_read_b64_tr_b16 v[140:141], v15 offset:61440
    s_waitcnt lgkmcnt(7)
    v_mfma_f32_16x16x32_bf16 v[100:103], a[168:171], v[124:127], v[100:103]
    ds_read_b64_tr_b16 v[142:143], v15 offset:63488
    v_mfma_f32_16x16x32_bf16 v[104:107], a[172:175], v[124:127], v[104:107]
    buffer_load_dwordx4 a[68:71], v1, s[36:39], s26 offen offset:1024 sc1
    v_mfma_f32_16x16x32_bf16 v[108:111], a[176:179], v[124:127], v[108:111]
    s_waitcnt vmcnt(12)
    s_mov_b64 exec, 1
    buffer_atomic_add v255, v254, s[36:39], s18 offen sc1
    s_mov_b64 exec, -1
    s_waitcnt lgkmcnt(6)
    v_mfma_f32_16x16x32_bf16 v[64:67], a[180:183], v[128:131], v[64:67]
    buffer_load_dwordx4 a[72:75], v1, s[36:39], s27 offen offset:0 sc1
    v_mfma_f32_16x16x32_bf16 v[68:71], a[184:187], v[128:131], v[68:71]
    s_waitcnt lgkmcnt(1)
    v_mfma_f32_16x16x32_bf16 v[72:75], a[188:191], v[128:131], v[72:75]
    s_waitcnt lgkmcnt(0)
    v_mfma_f32_16x16x32_bf16 v[76:79], a[180:183], v[132:135], v[76:79]
    v_mfma_f32_16x16x32_bf16 v[80:83], a[184:187], v[132:135], v[80:83]
    buffer_load_dwordx4 a[76:79], v1, s[36:39], s27 offen offset:1024 sc1
    s_add_u32 s26, s26, 4096
    s_add_u32 s27, s27, 4096
    v_mfma_f32_16x16x32_bf16 v[84:87], a[188:191], v[132:135], v[84:87]
    v_mfma_f32_16x16x32_bf16 v[88:91], a[180:183], v[136:139], v[88:91]
    v_mfma_f32_16x16x32_bf16 v[92:95], a[184:187], v[136:139], v[92:95]
    v_mfma_f32_16x16x32_bf16 v[96:99], a[188:191], v[136:139], v[96:99]
    v_mfma_f32_16x16x32_bf16 v[100:103], a[180:183], v[140:143], v[100:103]
    v_mfma_f32_16x16x32_bf16 v[104:107], a[184:187], v[140:143], v[104:107]
    v_mfma_f32_16x16x32_bf16 v[108:111], a[188:191], v[140:143], v[108:111]
    buffer_load_dwordx4 a[80:83], v1, s[36:39], s26 offen offset:0 sc1
    buffer_load_dwordx4 a[84:87], v1, s[36:39], s26 offen offset:1024 sc1
    buffer_load_dwordx4 a[88:91], v1, s[36:39], s27 offen offset:0 sc1
    s_barrier
    ds_read_b64 v[168:169], v249 offset:512
    ds_read_b64 v[170:171], v249 offset:640
    ds_read_b64 v[172:173], v249 offset:768
    ds_read_b64 v[174:175], v249 offset:896
    s_waitcnt lgkmcnt(3)
    v_mul_f32 v176, 0xbfb8aa3b, v168
    s_waitcnt lgkmcnt(2)
    v_mul_f32 v177, 0xbfb8aa3b, v170
    s_waitcnt lgkmcnt(1)
    v_mul_f32 v178, 0xbfb8aa3b, v172
    s_waitcnt lgkmcnt(0)
    v_mul_f32 v179, 0xbfb8aa3b, v174
    buffer_load_dwordx4 a[92:95], v1, s[36:39], s27 offen offset:1024 sc1
    s_add_u32 s26, s26, 4096
    s_add_u32 s27, s27, 4096
    v_pk_fma_f32 v[180:181], v[168:169], v[144:145], v[156:157] op_sel:[1,0,0] op_sel_hi:[1,1,1]
    v_pk_fma_f32 v[182:183], v[168:169], v[146:147], v[158:159] op_sel:[1,0,0] op_sel_hi:[1,1,1]
    v_pk_fma_f32 v[180:181], v[176:177], v[64:65], v[180:181] op_sel:[0,0,0] op_sel_hi:[0,1,1]
    v_pk_fma_f32 v[184:185], v[170:171], v[144:145], v[156:157] op_sel:[1,0,0] op_sel_hi:[1,1,1]
    v_pk_fma_f32 v[186:187], v[170:171], v[146:147], v[158:159] op_sel:[1,0,0] op_sel_hi:[1,1,1]
    v_pk_fma_f32 v[184:185], v[176:177], v[76:77], v[184:185] op_sel:[1,0,0] op_sel_hi:[1,1,1]
    v_pk_fma_f32 v[188:189], v[172:173], v[144:145], v[156:157] op_sel:[1,0,0] op_sel_hi:[1,1,1]
    v_pk_fma_f32 v[190:191], v[172:173], v[146:147], v[158:159] op_sel:[1,0,0] op_sel_hi:[1,1,1]
    v_pk_fma_f32 v[188:189], v[178:179], v[88:89], v[188:189] op_sel:[0,0,0] op_sel_hi:[0,1,1]
    v_pk_fma_f32 v[192:193], v[174:175], v[144:145], v[156:157] op_sel:[1,0,0] op_sel_hi:[1,1,1]
    s_mov_b64 exec, 1
    v_mov_b32 v253, 0
    buffer_atomic_add v253, v254, s[36:39], s20 offen sc0 sc1
    s_mov_b64 exec, -1
    v_pk_fma_f32 v[194:195], v[174:175], v[146:147], v[158:159] op_sel:[1,0,0] op_sel_hi:[1,1,1]
    v_pk_fma_f32 v[192:193], v[178:179], v[100:101], v[192:193] op_sel:[1,0,0] op_sel_hi:[1,1,1]
    v_exp_f32 v180, v180
    v_exp_f32 v181, v181
    v_pk_fma_f32 v[182:183], v[168:169], v[66:67], v[182:183] op_sel_hi:[0,1,1]
    v_exp_f32 v184, v184
    v_exp_f32 v185, v185
    v_pk_fma_f32 v[186:187], v[170:171], v[78:79], v[186:187] op_sel_hi:[0,1,1]
    v_exp_f32 v188, v188
    buffer_load_dwordx4 a[96:99], v1, s[36:39], s26 offen offset:0 sc1
    v_exp_f32 v189, v189
    v_pk_fma_f32 v[190:191], v[172:173], v[90:91], v[190:191] op_sel_hi:[0,1,1]
    v_exp_f32 v192, v192
    v_exp_f32 v193, v193
    v_pk_fma_f32 v[194:195], v[174:175], v[102:103], v[194:195] op_sel_hi:[0,1,1]
    v_pk_add_f32 v[180:181], v[180:181], 1.0 op_sel_hi:[1,0]
    v_pk_add_f32 v[184:185], v[184:185], 1.0 op_sel_hi:[1,0]
    v_pk_add_f32 v[188:189], v[188:189], 1.0 op_sel_hi:[1,0]
    v_pk_add_f32 v[192:193], v[192:193], 1.0 op_sel_hi:[1,0]
    v_rcp_f32 v180, v180
    v_rcp_f32 v181, v181
    v_rcp_f32 v184, v184
    v_rcp_f32 v185, v185
    v_rcp_f32 v188, v188
    v_rcp_f32 v189, v189
    v_rcp_f32 v192, v192
    v_rcp_f32 v193, v193
    v_pk_mul_f32 v[180:181], v[180:181], v[182:183]
    v_pk_mul_f32 v[184:185], v[184:185], v[186:187]
    buffer_load_dwordx4 a[100:103], v1, s[36:39], s26 offen offset:1024 sc1
    v_pk_mul_f32 v[188:189], v[188:189], v[190:191]
    v_pk_mul_f32 v[192:193], v[192:193], v[194:195]
    v_cvt_pk_bf16_f32 v196, v180, v181
    v_cvt_pk_bf16_f32 v197, v184, v185
    v_cvt_pk_bf16_f32 v198, v188, v189
    v_cvt_pk_bf16_f32 v199, v192, v193
    s_nop 0
    v_permlane32_swap_b32 v196, v198
    v_permlane32_swap_b32 v197, v199
    s_nop 1
    v_permlane16_swap_b32 v196, v197
    v_permlane16_swap_b32 v198, v199
    buffer_store_dwordx4 v[196:199], v6, s[36:39], s17 offen offset:0 sc1
    v_pk_fma_f32 v[180:181], v[168:169], v[148:149], v[160:161] op_sel:[1,0,0] op_sel_hi:[1,1,1]
    v_pk_fma_f32 v[182:183], v[168:169], v[150:151], v[162:163] op_sel:[1,0,0] op_sel_hi:[1,1,1]
    v_pk_fma_f32 v[180:181], v[176:177], v[68:69], v[180:181] op_sel:[0,0,0] op_sel_hi:[0,1,1]
    v_pk_fma_f32 v[184:185], v[170:171], v[148:149], v[160:161] op_sel:[1,0,0] op_sel_hi:[1,1,1]
    v_pk_fma_f32 v[186:187], v[170:171], v[150:151], v[162:163] op_sel:[1,0,0] op_sel_hi:[1,1,1]
    v_pk_fma_f32 v[184:185], v[176:177], v[80:81], v[184:185] op_sel:[1,0,0] op_sel_hi:[1,1,1]
    v_pk_fma_f32 v[188:189], v[172:173], v[148:149], v[160:161] op_sel:[1,0,0] op_sel_hi:[1,1,1]
    v_pk_fma_f32 v[190:191], v[172:173], v[150:151], v[162:163] op_sel:[1,0,0] op_sel_hi:[1,1,1]
    buffer_load_dwordx4 a[104:107], v1, s[36:39], s27 offen offset:0 sc1
    v_pk_fma_f32 v[188:189], v[178:179], v[92:93], v[188:189] op_sel:[0,0,0] op_sel_hi:[0,1,1]
    v_pk_fma_f32 v[192:193], v[174:175], v[148:149], v[160:161] op_sel:[1,0,0] op_sel_hi:[1,1,1]
    v_pk_fma_f32 v[194:195], v[174:175], v[150:151], v[162:163] op_sel:[1,0,0] op_sel_hi:[1,1,1]
    v_pk_fma_f32 v[192:193], v[178:179], v[104:105], v[192:193] op_sel:[1,0,0] op_sel_hi:[1,1,1]
    v_exp_f32 v180, v180
    v_exp_f32 v181, v181
    v_pk_fma_f32 v[182:183], v[168:169], v[70:71], v[182:183] op_sel_hi:[0,1,1]
    v_exp_f32 v184, v184
    v_exp_f32 v185, v185
    v_pk_fma_f32 v[186:187], v[170:171], v[82:83], v[186:187] op_sel_hi:[0,1,1]
    v_exp_f32 v188, v188
    v_exp_f32 v189, v189
    v_pk_fma_f32 v[190:191], v[172:173], v[94:95], v[190:191] op_sel_hi:[0,1,1]
    v_exp_f32 v192, v192
    v_exp_f32 v193, v193
    v_pk_fma_f32 v[194:195], v[174:175], v[106:107], v[194:195] op_sel_hi:[0,1,1]
    v_pk_add_f32 v[180:181], v[180:181], 1.0 op_sel_hi:[1,0]
    v_pk_add_f32 v[184:185], v[184:185], 1.0 op_sel_hi:[1,0]
    v_pk_add_f32 v[188:189], v[188:189], 1.0 op_sel_hi:[1,0]
    buffer_load_dwordx4 a[108:111], v1, s[36:39], s27 offen offset:1024 sc1
    v_pk_add_f32 v[192:193], v[192:193], 1.0 op_sel_hi:[1,0]
    v_rcp_f32 v180, v180
    v_rcp_f32 v181, v181
    v_rcp_f32 v184, v184
    v_rcp_f32 v185, v185
    v_rcp_f32 v188, v188
    v_rcp_f32 v189, v189
    v_rcp_f32 v192, v192
    v_rcp_f32 v193, v193
    v_pk_mul_f32 v[180:181], v[180:181], v[182:183]
    v_pk_mul_f32 v[184:185], v[184:185], v[186:187]
    v_pk_mul_f32 v[188:189], v[188:189], v[190:191]
    v_pk_mul_f32 v[192:193], v[192:193], v[194:195]
    v_cvt_pk_bf16_f32 v200, v180, v181
    v_cvt_pk_bf16_f32 v201, v184, v185
    v_cvt_pk_bf16_f32 v202, v188, v189
    v_cvt_pk_bf16_f32 v203, v192, v193
    s_nop 0
    v_permlane32_swap_b32 v200, v202
    v_permlane32_swap_b32 v201, v203
    s_nop 1
    v_permlane16_swap_b32 v200, v201
    s_waitcnt vmcnt(5)
    v_readfirstlane_b32 s61, v253
    s_cmp_ge_u32 s61, 16
    s_cbranch_scc1 L_pollD0N_go
    v_mov_b32 v252, 0
    s_mov_b64 exec, 1
    s_mov_b32 s62, 0
L_pollD0N:
    v_mov_b32 v253, 0
    buffer_atomic_add v253, v252, s[36:39], s20 offen sc0 sc1
    s_add_u32 s62, s62, 1
    s_cmp_ge_u32 s62, 262144
    s_cbranch_scc1 L_pollD0N_out
    s_waitcnt vmcnt(0)
    v_cmp_gt_u32 vcc, 16, v253
    s_cbranch_vccnz L_pollD0N
L_pollD0N_out:
    s_mov_b64 exec, -1
L_pollD0N_go:
    buffer_load_dwordx4 v[16:19], v1, s[36:39], s64 offen offset:0 sc1
    v_permlane16_swap_b32 v202, v203
    buffer_store_dwordx4 v[200:203], v6, s[36:39], s17 offen offset:256 sc1
    v_pk_fma_f32 v[180:181], v[168:169], v[152:153], v[164:165] op_sel:[1,0,0] op_sel_hi:[1,1,1]
    v_pk_fma_f32 v[182:183], v[168:169], v[154:155], v[166:167] op_sel:[1,0,0] op_sel_hi:[1,1,1]
    v_pk_fma_f32 v[180:181], v[176:177], v[72:73], v[180:181] op_sel:[0,0,0] op_sel_hi:[0,1,1]
    v_pk_fma_f32 v[184:185], v[170:171], v[152:153], v[164:165] op_sel:[1,0,0] op_sel_hi:[1,1,1]
    v_pk_fma_f32 v[186:187], v[170:171], v[154:155], v[166:167] op_sel:[1,0,0] op_sel_hi:[1,1,1]
    v_pk_fma_f32 v[184:185], v[176:177], v[84:85], v[184:185] op_sel:[1,0,0] op_sel_hi:[1,1,1]
    buffer_load_dwordx4 v[20:23], v1, s[36:39], s65 offen offset:0 sc1
    v_pk_fma_f32 v[188:189], v[172:173], v[152:153], v[164:165] op_sel:[1,0,0] op_sel_hi:[1,1,1]
    v_pk_fma_f32 v[190:191], v[172:173], v[154:155], v[166:167] op_sel:[1,0,0] op_sel_hi:[1,1,1]
    v_pk_fma_f32 v[188:189], v[178:179], v[96:97], v[188:189] op_sel:[0,0,0] op_sel_hi:[0,1,1]
    v_pk_fma_f32 v[192:193], v[174:175], v[152:153], v[164:165] op_sel:[1,0,0] op_sel_hi:[1,1,1]
    v_pk_fma_f32 v[194:195], v[174:175], v[154:155], v[166:167] op_sel:[1,0,0] op_sel_hi:[1,1,1]
    v_pk_fma_f32 v[192:193], v[178:179], v[108:109], v[192:193] op_sel:[1,0,0] op_sel_hi:[1,1,1]
    v_exp_f32 v180, v180
    v_exp_f32 v181, v181
    buffer_load_dwordx4 v[24:27], v1, s[36:39], s64 offen offset:1024 sc1
    v_pk_fma_f32 v[182:183], v[168:169], v[74:75], v[182:183] op_sel_hi:[0,1,1]
    v_exp_f32 v184, v184
    v_exp_f32 v185, v185
    v_pk_fma_f32 v[186:187], v[170:171], v[86:87], v[186:187] op_sel_hi:[0,1,1]
    v_exp_f32 v188, v188
    s_mov_b64 exec, 1
    buffer_atomic_add v255, v254, s[36:39], s19 offen sc1
    s_mov_b64 exec, -1
    v_exp_f32 v189, v189
    v_pk_fma_f32 v[190:191], v[172:173], v[98:99], v[190:191] op_sel_hi:[0,1,1]
    v_exp_f32 v192, v192
    buffer_load_dwordx4 v[28:31], v1, s[36:39], s65 offen offset:1024 sc1
    v_exp_f32 v193, v193
    v_pk_fma_f32 v[194:195], v[174:175], v[110:111], v[194:195] op_sel_hi:[0,1,1]
    v_pk_add_f32 v[180:181], v[180:181], 1.0 op_sel_hi:[1,0]
    v_pk_add_f32 v[184:185], v[184:185], 1.0 op_sel_hi:[1,0]
    v_pk_add_f32 v[188:189], v[188:189], 1.0 op_sel_hi:[1,0]
    v_pk_add_f32 v[192:193], v[192:193], 1.0 op_sel_hi:[1,0]
    v_rcp_f32 v180, v180
    v_rcp_f32 v181, v181
    buffer_load_dwordx4 v[32:35], v1, s[36:39], s64 offen offset:2048 sc1
    v_rcp_f32 v184, v184
    v_rcp_f32 v185, v185
    v_rcp_f32 v188, v188
    v_rcp_f32 v189, v189
    v_rcp_f32 v192, v192
    v_rcp_f32 v193, v193
    v_pk_mul_f32 v[180:181], v[180:181], v[182:183]
    v_pk_mul_f32 v[184:185], v[184:185], v[186:187]
    v_pk_mul_f32 v[188:189], v[188:189], v[190:191]
    v_pk_mul_f32 v[192:193], v[192:193], v[194:195]
    v_cvt_pk_bf16_f32 v204, v180, v181
    v_cvt_pk_bf16_f32 v205, v184, v185
    v_cvt_pk_bf16_f32 v206, v188, v189
    v_cvt_pk_bf16_f32 v207, v192, v193
    s_nop 0
    v_permlane32_swap_b32 v204, v206
    v_permlane32_swap_b32 v205, v207
    s_nop 1
    v_permlane16_swap_b32 v204, v205
    v_permlane16_swap_b32 v206, v207
    buffer_store_dwordx4 v[204:207], v6, s[36:39], s17 offen offset:512 sc1
    s_branch L_g2
L_g1_stat:
    buffer_load_dwordx4 a[60:63], v1, s[36:39], s8 offen offset:1024 sc1
    buffer_load_dwordx4 a[64:67], v1, s[36:39], s9 offen offset:1024 sc1
    s_mov_b64 exec, 255
    s_waitcnt vmcnt(4)
    v_cmp_gt_u32 vcc, 32, v251
    s_mov_b64 exec, -1
    s_cbranch_vccz L_pollCA_go
    s_and_b32 s61, s2, 31
    s_mul_i32 s61, s61, 2048
    s_add_u32 s61, s61, 4980736
    v_lshlrev_b32 v250, 8, v0
    s_mov_b64 exec, 255
    s_mov_b64 exec, vcc
    s_mov_b32 s62, 0
L_pollCA:
    v_mov_b32 v251, 0
    buffer_atomic_add v251, v250, s[36:39], s61 offen sc0 sc1
    s_add_u32 s62, s62, 1
    s_cmp_ge_u32 s62, 262144
    s_cbranch_scc1 L_pollCA_out
    s_waitcnt vmcnt(0)
    v_cmp_gt_u32 vcc, 32, v251
    s_and_b64 exec, exec, vcc
    s_cbranch_scc1 L_pollCA
L_pollCA_out:
    s_mov_b64 exec, -1
L_pollCA_go:
    s_barrier
    s_add_u32 m0, s25, 0
    s_add_u32 s6, m0, s48
    buffer_load_dwordx4 v1, s[36:39], s6 offen offset:0 sc1 lds
    buffer_load_dwordx4 v1, s[36:39], s6 offen offset:1024 sc1 lds
    s_add_u32 m0, s25, 8192
    s_add_u32 s6, m0, s48
    buffer_load_dwordx4 v1, s[36:39], s6 offen offset:0 sc1 lds
    buffer_load_dwordx4 v1, s[36:39], s6 offen offset:1024 sc1 lds
    s_add_u32 m0, s63, 16384
    s_add_u32 s6, m0, s48
    buffer_load_dwordx4 v1, s[36:39], s6 offen offset:0 sc1 lds
    buffer_load_dwordx4 v1, s[36:39], s6 offen offset:1024 sc1 lds
    buffer_load_dwordx4 v1, s[36:39], s6 offen offset:2048 sc1 lds
    buffer_load_dwordx4 v1, s[36:39], s6 offen offset:3072 sc1 lds
    s_mov_b32 s71, 45056
    v_lshlrev_b32 v6, 4, v4
    v_mad_u32_u24 v6, v5, s71, v6
    s_mul_i32 s16, s59, 180224
    s_lshl_b32 s71, s28, 8
    s_add_u32 s16, s16, s71
    s_add_u32 s16, s16, 10485760
    s_add_u32 s17, s16, 2883584
    s_lshl_b32 s71, s59, 11
    s_add_u32 s71, s71, 5111808
    s_lshr_b32 s75, s60, 2
    s_lshl_b32 s75, s75, 8
    s_add_u32 s18, s71, s75
    s_add_u32 s19, s18, 1024
    s_lshl_b32 s75, s3, 8
    s_add_u32 s20, s71, s75
    s_add_u32 s21, s20, 1024
    s_lshl_b32 s71, s23, 1
    s_add_u32 s71, s71, s68
    v_and_b32 v7, 3, v4
    v_xor_b32 v7, s71, v7
    v_lshlrev_b32 v7, 5, v7
    v_lshl_add_u32 v7, v4, 8, v7
    v_lshl_add_u32 v7, v5, 3, v7
    s_lshl_b32 s71, s24, 13
    s_lshl_b32 s75, s69, 12
    s_add_u32 s71, s71, s75
    v_add_u32 v7, s71, v7
    v_lshlrev_b32 v249, 3, v4
    v_add_u32 v249, 131072, v249
    s_mov_b32 s14, 0xcccccccc
    s_mov_b32 s15, s14
    v_lshlrev_b32 v248, 3, v0
    v_add_u32 v248, 131072, v248
    s_mov_b32 s32, 0x00f0000f
    s_mov_b32 s33, 0xf0000f00
    s_mov_b32 s30, 0xaaaaaaaa
    s_mov_b32 s31, s30
    s_mov_b32 s34, 0
    s_mov_b32 s35, 0xffff0000
    s_lshl_b32 s71, s59, 2
    s_lshl_b32 s75, s23, 1
    s_add_u32 s71, s71, s75
    s_add_u32 s12, s71, s68
    s_xor_b32 s75, s68, 1
    s_add_u32 s75, s71, s75
    s_mul_i32 s71, s3, 11264
    s_add_u32 s71, s71, 10485760
    s_mul_i32 s64, s12, 45056
    s_add_u32 s64, s64, s71
    s_mul_i32 s65, s75, 45056
    s_add_u32 s65, s65, s71
    s_add_u32 s66, s64, 2883584
    s_add_u32 s67, s65, 2883584
    s_lshl_b32 s12, s12, 14
    s_lshl_b32 s71, s24, 7
    s_add_u32 s12, s12, s71
    s_lshl_b32 s71, s69, 6
    s_add_u32 s12, s12, s71
    s_add_u32 s13, s12, 0x100000
    v_mul_u32_u24 v3, 12288, v5
    v_lshl_add_u32 v3, v4, 3, v3
    s_lshl_b32 s4, s24, 8
    s_lshl_b32 s5, s69, 7
    s_add_u32 s4, s4, s5
    s_add_u32 s4, s4, 4745216
    s_add_u32 s5, s4, 49152
    buffer_load_dwordx2 v[216:217], v3, s[36:39], s4 offen sc1
    buffer_load_dwordx2 v[218:219], v3, s[36:39], s5 offen sc1
    s_waitcnt vmcnt(8)
    s_barrier
    s_lshr_b32 s61, s2, 4
    s_and_b32 s61, s61, 7
    s_lshl_b32 s61, s61, 8
    s_add_u32 s61, s61, 5046272
    v_mul_u32_u24 v250, 2048, v0
    s_mov_b32 exec_hi, 0
    buffer_atomic_add v255, v250, s[36:39], s61 offen sc1
    s_mov_b64 exec, -1
    ds_read_b64_tr_b16 v[112:113], v8 offset:0
    ds_read_b64_tr_b16 v[114:115], v8 offset:2048
    ds_read_b64_tr_b16 v[116:117], v9 offset:0
    ds_read_b64_tr_b16 v[118:119], v9 offset:2048
    ds_read_b64_tr_b16 v[120:121], v10 offset:0
    ds_read_b64_tr_b16 v[122:123], v10 offset:2048
    ds_read_b64_tr_b16 v[124:125], v11 offset:0
    ds_read_b64_tr_b16 v[126:127], v11 offset:2048
    s_waitcnt lgkmcnt(6)
    v_mfma_f32_16x16x32_bf16 v[16:19], a[0:3], v[112:115], 0
    ds_read_b64_tr_b16 v[128:129], v8 offset:4096
    v_mfma_f32_16x16x32_bf16 v[20:23], a[4:7], v[112:115], 0
    ds_read_b64_tr_b16 v[130:131], v8 offset:6144
    v_mfma_f32_16x16x32_bf16 v[24:27], v[112:115], v[112:115], 0
    ds_read_b64_tr_b16 v[132:133], v9 offset:4096
    s_waitcnt lgkmcnt(7)
    v_mfma_f32_16x16x32_bf16 v[28:31], a[0:3], v[116:119], 0
    buffer_load_dwordx4 a[72:75], v1, s[36:39], s8 offen offset:2048 sc1
    v_mfma_f32_16x16x32_bf16 v[32:35], a[4:7], v[116:119], 0
    ds_read_b64_tr_b16 v[134:135], v9 offset:6144
    v_mfma_f32_16x16x32_bf16 v[36:39], v[116:119], v[116:119], 0
    ds_read_b64_tr_b16 v[136:137], v10 offset:4096
    s_waitcnt lgkmcnt(7)
    v_mfma_f32_16x16x32_bf16 v[40:43], a[0:3], v[120:123], 0
    ds_read_b64_tr_b16 v[138:139], v10 offset:6144
    v_mfma_f32_16x16x32_bf16 v[44:47], a[4:7], v[120:123], 0
    buffer_load_dwordx4 a[76:79], v1, s[36:39], s9 offen offset:2048 sc1
    v_mfma_f32_16x16x32_bf16 v[48:51], v[120:123], v[120:123], 0
    ds_read_b64_tr_b16 v[140:141], v11 offset:4096
    s_waitcnt lgkmcnt(7)
    v_mfma_f32_16x16x32_bf16 v[52:55], a[0:3], v[124:127], 0
    ds_read_b64_tr_b16 v[142:143], v11 offset:6144
    v_mfma_f32_16x16x32_bf16 v[56:59], a[4:7], v[124:127], 0
    buffer_load_dwordx4 a[84:87], v1, s[36:39], s8 offen offset:3072 sc1
    v_mfma_f32_16x16x32_bf16 v[60:63], v[124:127], v[124:127], 0
    s_waitcnt lgkmcnt(2)
    v_mfma_f32_16x16x32_bf16 v[16:19], a[12:15], v[128:131], v[16:19]
    s_waitcnt vmcnt(10)
    s_barrier
    v_mfma_f32_16x16x32_bf16 v[20:23], a[16:19], v[128:131], v[20:23]
    ds_read_b64_tr_b16 v[112:113], v8 offset:8192
    v_mfma_f32_16x16x32_bf16 v[24:27], v[128:131], v[128:131], v[24:27]
    ds_read_b64_tr_b16 v[114:115], v8 offset:10240
    v_mfma_f32_16x16x32_bf16 v[28:31], a[12:15], v[132:135], v[28:31]
    ds_read_b64_tr_b16 v[116:117], v9 offset:8192
    v_mfma_f32_16x16x32_bf16 v[32:35], a[16:19], v[132:135], v[32:35]
    buffer_load_dwordx4 a[88:91], v1, s[36:39], s9 offen offset:3072 sc1
    s_add_u32 s8, s8, 4096
    s_add_u32 s9, s9, 4096
    v_mfma_f32_16x16x32_bf16 v[36:39], v[132:135], v[132:135], v[36:39]
    ds_read_b64_tr_b16 v[118:119], v9 offset:10240
    v_mfma_f32_16x16x32_bf16 v[40:43], a[12:15], v[136:139], v[40:43]
    ds_read_b64_tr_b16 v[120:121], v10 offset:8192
    v_mfma_f32_16x16x32_bf16 v[44:47], a[16:19], v[136:139], v[44:47]
    ds_read_b64_tr_b16 v[122:123], v10 offset:10240
    v_mfma_f32_16x16x32_bf16 v[48:51], v[136:139], v[136:139], v[48:51]
    s_waitcnt lgkmcnt(3)
    v_mfma_f32_16x16x32_bf16 v[52:55], a[12:15], v[140:143], v[52:55]
    ds_read_b64_tr_b16 v[124:125], v11 offset:8192
    s_add_u32 m0, s63, 32768
    s_add_u32 s6, m0, s48
    v_mfma_f32_16x16x32_bf16 v[56:59], a[16:19], v[140:143], v[56:59]
    ds_read_b64_tr_b16 v[126:127], v11 offset:10240
    v_mfma_f32_16x16x32_bf16 v[60:63], v[140:143], v[140:143], v[60:63]
    buffer_load_dwordx4 v1, s[36:39], s6 offen offset:0 sc1 lds
    v_mfma_f32_16x16x32_bf16 v[16:19], a[24:27], v[112:115], v[16:19]
    ds_read_b64_tr_b16 v[128:129], v8 offset:12288
    v_mfma_f32_16x16x32_bf16 v[20:23], a[28:31], v[112:115], v[20:23]
    ds_read_b64_tr_b16 v[130:131], v8 offset:14336
    v_mfma_f32_16x16x32_bf16 v[24:27], v[112:115], v[112:115], v[24:27]
    ds_read_b64_tr_b16 v[132:133], v9 offset:12288
    s_waitcnt lgkmcnt(7)
    v_mfma_f32_16x16x32_bf16 v[28:31], a[24:27], v[116:119], v[28:31]
    buffer_load_dwordx4 v1, s[36:39], s6 offen offset:1024 sc1 lds
    v_mfma_f32_16x16x32_bf16 v[32:35], a[28:31], v[116:119], v[32:35]
    ds_read_b64_tr_b16 v[134:135], v9 offset:14336
    v_mfma_f32_16x16x32_bf16 v[36:39], v[116:119], v[116:119], v[36:39]
    ds_read_b64_tr_b16 v[136:137], v10 offset:12288
    s_waitcnt lgkmcnt(7)
    v_mfma_f32_16x16x32_bf16 v[40:43], a[24:27], v[120:123], v[40:43]
    ds_read_b64_tr_b16 v[138:139], v10 offset:14336
    v_mfma_f32_16x16x32_bf16 v[44:47], a[28:31], v[120:123], v[44:47]
    buffer_load_dwordx4 v1, s[36:39], s6 offen offset:2048 sc1 lds
    v_mfma_f32_16x16x32_bf16 v[48:51], v[120:123], v[120:123], v[48:51]
    ds_read_b64_tr_b16 v[140:141], v11 offset:12288
    s_waitcnt lgkmcnt(7)
    v_mfma_f32_16x16x32_bf16 v[52:55], a[24:27], v[124:127], v[52:55]
    ds_read_b64_tr_b16 v[142:143], v11 offset:14336
    v_mfma_f32_16x16x32_bf16 v[56:59], a[28:31], v[124:127], v[56:59]
    buffer_load_dwordx4 v1, s[36:39], s6 offen offset:3072 sc1 lds
    v_mfma_f32_16x16x32_bf16 v[60:63], v[124:127], v[124:127], v[60:63]
    s_waitcnt lgkmcnt(2)
    v_mfma_f32_16x16x32_bf16 v[16:19], a[36:39], v[128:131], v[16:19]
    s_waitcnt vmcnt(11)
    s_barrier
    v_mfma_f32_16x16x32_bf16 v[20:23], a[40:43], v[128:131], v[20:23]
    ds_read_b64_tr_b16 v[112:113], v8 offset:16384
    v_mfma_f32_16x16x32_bf16 v[24:27], v[128:131], v[128:131], v[24:27]
    ds_read_b64_tr_b16 v[114:115], v8 offset:18432
    v_mfma_f32_16x16x32_bf16 v[28:31], a[36:39], v[132:135], v[28:31]
    ds_read_b64_tr_b16 v[116:117], v9 offset:16384
    v_mfma_f32_16x16x32_bf16 v[32:35], a[40:43], v[132:135], v[32:35]
    buffer_load_dwordx4 a[96:99], v1, s[36:39], s8 offen offset:0 sc1
    v_mfma_f32_16x16x32_bf16 v[36:39], v[132:135], v[132:135], v[36:39]
    ds_read_b64_tr_b16 v[118:119], v9 offset:18432
    v_mfma_f32_16x16x32_bf16 v[40:43], a[36:39], v[136:139], v[40:43]
    ds_read_b64_tr_b16 v[120:121], v10 offset:16384
    v_mfma_f32_16x16x32_bf16 v[44:47], a[40:43], v[136:139], v[44:47]
    ds_read_b64_tr_b16 v[122:123], v10 offset:18432
    v_mfma_f32_16x16x32_bf16 v[48:51], v[136:139], v[136:139], v[48:51]
    s_and_b32 s61, s2, 31
    s_mul_i32 s61, s61, 2048
    s_add_u32 s61, s61, 5046272
    v_lshlrev_b32 v250, 8, v0
    s_mov_b64 exec, 255
    v_mov_b32 v251, 0
    buffer_atomic_add v251, v250, s[36:39], s61 offen sc0 sc1
    s_mov_b64 exec, -1
    s_waitcnt lgkmcnt(6)
    v_mfma_f32_16x16x32_bf16 v[52:55], a[36:39], v[140:143], v[52:55]
    ds_read_b64_tr_b16 v[124:125], v11 offset:16384
    buffer_load_dwordx4 a[100:103], v1, s[36:39], s9 offen offset:0 sc1
    v_mfma_f32_16x16x32_bf16 v[56:59], a[40:43], v[140:143], v[56:59]
    ds_read_b64_tr_b16 v[126:127], v11 offset:18432
    v_mfma_f32_16x16x32_bf16 v[60:63], v[140:143], v[140:143], v[60:63]
    s_waitcnt lgkmcnt(3)
    v_mfma_f32_16x16x32_bf16 v[16:19], a[48:51], v[112:115], v[16:19]
    ds_read_b64_tr_b16 v[128:129], v8 offset:20480
    v_mfma_f32_16x16x32_bf16 v[20:23], a[52:55], v[112:115], v[20:23]
    ds_read_b64_tr_b16 v[130:131], v8 offset:22528
    v_mfma_f32_16x16x32_bf16 v[24:27], v[112:115], v[112:115], v[24:27]
    ds_read_b64_tr_b16 v[132:133], v9 offset:20480
    v_mfma_f32_16x16x32_bf16 v[28:31], a[48:51], v[116:119], v[28:31]
    buffer_load_dwordx4 a[108:111], v1, s[36:39], s8 offen offset:1024 sc1
    v_mfma_f32_16x16x32_bf16 v[32:35], a[52:55], v[116:119], v[32:35]
    ds_read_b64_tr_b16 v[134:135], v9 offset:22528
    v_mfma_f32_16x16x32_bf16 v[36:39], v[116:119], v[116:119], v[36:39]
    ds_read_b64_tr_b16 v[136:137], v10 offset:20480
    s_waitcnt lgkmcnt(7)
    v_mfma_f32_16x16x32_bf16 v[40:43], a[48:51], v[120:123], v[40:43]
    ds_read_b64_tr_b16 v[138:139], v10 offset:22528
    v_mfma_f32_16x16x32_bf16 v[44:47], a[52:55], v[120:123], v[44:47]
    buffer_load_dwordx4 a[112:115], v1, s[36:39], s9 offen offset:1024 sc1
    v_mfma_f32_16x16x32_bf16 v[48:51], v[120:123], v[120:123], v[48:51]
    ds_read_b64_tr_b16 v[140:141], v11 offset:20480
    s_waitcnt lgkmcnt(7)
    v_mfma_f32_16x16x32_bf16 v[52:55], a[48:51], v[124:127], v[52:55]
    ds_read_b64_tr_b16 v[142:143], v11 offset:22528
    v_mfma_f32_16x16x32_bf16 v[56:59], a[52:55], v[124:127], v[56:59]
    buffer_load_dwordx4 a[120:123], v1, s[36:39], s8 offen offset:2048 sc1
    v_mfma_f32_16x16x32_bf16 v[60:63], v[124:127], v[124:127], v[60:63]
    s_waitcnt lgkmcnt(2)
    v_mfma_f32_16x16x32_bf16 v[16:19], a[60:63], v[128:131], v[16:19]
    ds_read_b64_tr_b16 v[112:113], v8 offset:24576
    v_mfma_f32_16x16x32_bf16 v[20:23], a[64:67], v[128:131], v[20:23]
    ds_read_b64_tr_b16 v[114:115], v8 offset:26624
    v_mfma_f32_16x16x32_bf16 v[24:27], v[128:131], v[128:131], v[24:27]
    ds_read_b64_tr_b16 v[116:117], v9 offset:24576
    v_mfma_f32_16x16x32_bf16 v[28:31], a[60:63], v[132:135], v[28:31]
    s_waitcnt lgkmcnt(3)
    v_mfma_f32_16x16x32_bf16 v[32:35], a[64:67], v[132:135], v[32:35]
    ds_read_b64_tr_b16 v[118:119], v9 offset:26624
    v_mfma_f32_16x16x32_bf16 v[36:39], v[132:135], v[132:135], v[36:39]
    ds_read_b64_tr_b16 v[120:121], v10 offset:24576
    v_mfma_f32_16x16x32_bf16 v[40:43], a[60:63], v[136:139], v[40:43]
    ds_read_b64_tr_b16 v[122:123], v10 offset:26624
    v_mfma_f32_16x16x32_bf16 v[44:47], a[64:67], v[136:139], v[44:47]
    buffer_load_dwordx4 a[124:127], v1, s[36:39], s9 offen offset:2048 sc1
    v_mfma_f32_16x16x32_bf16 v[48:51], v[136:139], v[136:139], v[48:51]
    ds_read_b64_tr_b16 v[124:125], v11 offset:24576
    v_mfma_f32_16x16x32_bf16 v[52:55], a[60:63], v[140:143], v[52:55]
    ds_read_b64_tr_b16 v[126:127], v11 offset:26624
    v_mfma_f32_16x16x32_bf16 v[56:59], a[64:67], v[140:143], v[56:59]
    buffer_load_dwordx4 a[132:135], v1, s[36:39], s8 offen offset:3072 sc1
    v_mfma_f32_16x16x32_bf16 v[60:63], v[140:143], v[140:143], v[60:63]
    s_waitcnt vmcnt(14) lgkmcnt(2)
    v_mfma_f32_16x16x32_bf16 v[16:19], a[72:75], v[112:115], v[16:19]
    ds_read_b64_tr_b16 v[128:129], v8 offset:28672
    v_mfma_f32_16x16x32_bf16 v[20:23], a[76:79], v[112:115], v[20:23]
    ds_read_b64_tr_b16 v[130:131], v8 offset:30720
    v_mfma_f32_16x16x32_bf16 v[24:27], v[112:115], v[112:115], v[24:27]
    ds_read_b64_tr_b16 v[132:133], v9 offset:28672
    v_mfma_f32_16x16x32_bf16 v[28:31], a[72:75], v[116:119], v[28:31]
    buffer_load_dwordx4 a[136:139], v1, s[36:39], s9 offen offset:3072 sc1
    s_add_u32 s8, s8, 4096
    s_add_u32 s9, s9, 4096
    v_mfma_f32_16x16x32_bf16 v[32:35], a[76:79], v[116:119], v[32:35]
    ds_read_b64_tr_b16 v[134:135], v9 offset:30720
    v_mfma_f32_16x16x32_bf16 v[36:39], v[116:119], v[116:119], v[36:39]
    ds_read_b64_tr_b16 v[136:137], v10 offset:28672
    v_mfma_f32_16x16x32_bf16 v[40:43], a[72:75], v[120:123], v[40:43]
    ds_read_b64_tr_b16 v[138:139], v10 offset:30720
    v_mfma_f32_16x16x32_bf16 v[44:47], a[76:79], v[120:123], v[44:47]
    buffer_load_dwordx4 a[144:147], v1, s[36:39], s8 offen offset:0 sc1
    v_mfma_f32_16x16x32_bf16 v[48:51], v[120:123], v[120:123], v[48:51]
    ds_read_b64_tr_b16 v[140:141], v11 offset:28672
    s_waitcnt lgkmcnt(7)
    v_mfma_f32_16x16x32_bf16 v[52:55], a[72:75], v[124:127], v[52:55]
    ds_read_b64_tr_b16 v[142:143], v11 offset:30720
    v_mfma_f32_16x16x32_bf16 v[56:59], a[76:79], v[124:127], v[56:59]
    s_waitcnt vmcnt(14) lgkmcnt(3)
    v_mfma_f32_16x16x32_bf16 v[60:63], v[124:127], v[124:127], v[60:63]
    s_waitcnt lgkmcnt(2)
    v_mfma_f32_16x16x32_bf16 v[16:19], a[84:87], v[128:131], v[16:19]
    s_waitcnt vmcnt(10)
    s_mov_b64 exec, 255
    s_waitcnt vmcnt(8)
    v_cmp_gt_u32 vcc, 32, v251
    s_mov_b64 exec, -1
    s_cbranch_vccz L_pollCB_go
    s_and_b32 s61, s2, 31
    s_mul_i32 s61, s61, 2048
    s_add_u32 s61, s61, 5046272
    v_lshlrev_b32 v250, 8, v0
    s_mov_b64 exec, 255
    s_mov_b64 exec, vcc
    s_mov_b32 s62, 0
L_pollCB:
    v_mov_b32 v251, 0
    buffer_atomic_add v251, v250, s[36:39], s61 offen sc0 sc1
    s_add_u32 s62, s62, 1
    s_cmp_ge_u32 s62, 262144
    s_cbranch_scc1 L_pollCB_out
    s_waitcnt vmcnt(0)
    v_cmp_gt_u32 vcc, 32, v251
    s_and_b64 exec, exec, vcc
    s_cbranch_scc1 L_pollCB
L_pollCB_out:
    s_mov_b64 exec, -1
L_pollCB_go:
    s_barrier
    v_mfma_f32_16x16x32_bf16 v[20:23], a[88:91], v[128:131], v[20:23]
    ds_read_b64_tr_b16 v[112:113], v8 offset:32768
    s_add_u32 m0, s63, 65536
    s_add_u32 s6, m0, s49
    v_mfma_f32_16x16x32_bf16 v[24:27], v[128:131], v[128:131], v[24:27]
    ds_read_b64_tr_b16 v[114:115], v8 offset:34816
    v_mfma_f32_16x16x32_bf16 v[28:31], a[84:87], v[132:135], v[28:31]
    ds_read_b64_tr_b16 v[116:117], v9 offset:32768
    v_mfma_f32_16x16x32_bf16 v[32:35], a[88:91], v[132:135], v[32:35]
    buffer_load_dwordx4 v1, s[36:39], s6 offen offset:0 sc1 lds
    v_mfma_f32_16x16x32_bf16 v[36:39], v[132:135], v[132:135], v[36:39]
    ds_read_b64_tr_b16 v[118:119], v9 offset:34816
    v_mfma_f32_16x16x32_bf16 v[40:43], a[84:87], v[136:139], v[40:43]
    ds_read_b64_tr_b16 v[120:121], v10 offset:32768
    v_mfma_f32_16x16x32_bf16 v[44:47], a[88:91], v[136:139], v[44:47]
    ds_read_b64_tr_b16 v[122:123], v10 offset:34816
    v_mfma_f32_16x16x32_bf16 v[48:51], v[136:139], v[136:139], v[48:51]
    buffer_load_dwordx4 v1, s[36:39], s6 offen offset:1024 sc1 lds
    s_waitcnt lgkmcnt(6)
    v_mfma_f32_16x16x32_bf16 v[52:55], a[84:87], v[140:143], v[52:55]
    ds_read_b64_tr_b16 v[124:125], v11 offset:32768
    v_mfma_f32_16x16x32_bf16 v[56:59], a[88:91], v[140:143], v[56:59]
    ds_read_b64_tr_b16 v[126:127], v11 offset:34816
    v_mfma_f32_16x16x32_bf16 v[60:63], v[140:143], v[140:143], v[60:63]
    buffer_load_dwordx4 v1, s[36:39], s6 offen offset:2048 sc1 lds
    s_waitcnt lgkmcnt(6)
    v_mfma_f32_16x16x32_bf16 v[16:19], a[96:99], v[112:115], v[16:19]
    ds_read_b64_tr_b16 v[128:129], v8 offset:36864
    s_waitcnt vmcnt(10)
    v_mfma_f32_16x16x32_bf16 v[20:23], a[100:103], v[112:115], v[20:23]
    ds_read_b64_tr_b16 v[130:131], v8 offset:38912
    v_mfma_f32_16x16x32_bf16 v[24:27], v[112:115], v[112:115], v[24:27]
    ds_read_b64_tr_b16 v[132:133], v9 offset:36864
    s_waitcnt lgkmcnt(7)
    v_mfma_f32_16x16x32_bf16 v[28:31], a[96:99], v[116:119], v[28:31]
    buffer_load_dwordx4 v1, s[36:39], s6 offen offset:3072 sc1 lds
    v_mfma_f32_16x16x32_bf16 v[32:35], a[100:103], v[116:119], v[32:35]
    ds_read_b64_tr_b16 v[134:135], v9 offset:38912
    v_mfma_f32_16x16x32_bf16 v[36:39], v[116:119], v[116:119], v[36:39]
    ds_read_b64_tr_b16 v[136:137], v10 offset:36864
    s_waitcnt lgkmcnt(7)
    v_mfma_f32_16x16x32_bf16 v[40:43], a[96:99], v[120:123], v[40:43]
    ds_read_b64_tr_b16 v[138:139], v10 offset:38912
    v_mfma_f32_16x16x32_bf16 v[44:47], a[100:103], v[120:123], v[44:47]
    buffer_load_dwordx4 v[144:147], v2, s[36:39], s11 offen offset:0 sc1
    v_mfma_f32_16x16x32_bf16 v[48:51], v[120:123], v[120:123], v[48:51]
    ds_read_b64_tr_b16 v[140:141], v11 offset:36864
    s_waitcnt lgkmcnt(7)
    v_mfma_f32_16x16x32_bf16 v[52:55], a[96:99], v[124:127], v[52:55]
    ds_read_b64_tr_b16 v[142:143], v11 offset:38912
    v_mfma_f32_16x16x32_bf16 v[56:59], a[100:103], v[124:127], v[56:59]
    buffer_load_dwordx4 v[220:223], v2, s[36:39], s11 offen offset:768 sc1
    v_mfma_f32_16x16x32_bf16 v[60:63], v[124:127], v[124:127], v[60:63]
    s_waitcnt vmcnt(11) lgkmcnt(2)
    v_mfma_f32_16x16x32_bf16 v[16:19], a[108:111], v[128:131], v[16:19]
    ds_read_b64_tr_b16 v[112:113], v8 offset:40960
    v_mfma_f32_16x16x32_bf16 v[20:23], a[112:115], v[128:131], v[20:23]
    ds_read_b64_tr_b16 v[114:115], v8 offset:43008
    s_add_u32 m0, s63, 49152
    s_add_u32 s6, m0, s48
    v_mfma_f32_16x16x32_bf16 v[24:27], v[128:131], v[128:131], v[24:27]
    ds_read_b64_tr_b16 v[116:117], v9 offset:40960
    v_mfma_f32_16x16x32_bf16 v[28:31], a[108:111], v[132:135], v[28:31]
    buffer_load_dwordx4 v1, s[36:39], s6 offen offset:0 sc1 lds
    v_mfma_f32_16x16x32_bf16 v[32:35], a[112:115], v[132:135], v[32:35]
    ds_read_b64_tr_b16 v[118:119], v9 offset:43008
    v_mfma_f32_16x16x32_bf16 v[36:39], v[132:135], v[132:135], v[36:39]
    ds_read_b64_tr_b16 v[120:121], v10 offset:40960
    v_mfma_f32_16x16x32_bf16 v[40:43], a[108:111], v[136:139], v[40:43]
    ds_read_b64_tr_b16 v[122:123], v10 offset:43008
    v_mfma_f32_16x16x32_bf16 v[44:47], a[112:115], v[136:139], v[44:47]
    buffer_load_dwordx4 v1, s[36:39], s6 offen offset:1024 sc1 lds
    v_mfma_f32_16x16x32_bf16 v[48:51], v[136:139], v[136:139], v[48:51]
    ds_read_b64_tr_b16 v[124:125], v11 offset:40960
    s_waitcnt lgkmcnt(7)
    v_mfma_f32_16x16x32_bf16 v[52:55], a[108:111], v[140:143], v[52:55]
    ds_read_b64_tr_b16 v[126:127], v11 offset:43008
    v_mfma_f32_16x16x32_bf16 v[56:59], a[112:115], v[140:143], v[56:59]
    buffer_load_dwordx4 v1, s[36:39], s6 offen offset:2048 sc1 lds
    v_mfma_f32_16x16x32_bf16 v[60:63], v[140:143], v[140:143], v[60:63]
    s_waitcnt vmcnt(12) lgkmcnt(2)
    v_mfma_f32_16x16x32_bf16 v[16:19], a[120:123], v[112:115], v[16:19]
    ds_read_b64_tr_b16 v[128:129], v8 offset:45056
    v_mfma_f32_16x16x32_bf16 v[20:23], a[124:127], v[112:115], v[20:23]
    ds_read_b64_tr_b16 v[130:131], v8 offset:47104
    v_mfma_f32_16x16x32_bf16 v[24:27], v[112:115], v[112:115], v[24:27]
    ds_read_b64_tr_b16 v[132:133], v9 offset:45056
    v_mfma_f32_16x16x32_bf16 v[28:31], a[120:123], v[116:119], v[28:31]
    buffer_load_dwordx4 v1, s[36:39], s6 offen offset:3072 sc1 lds
    v_mfma_f32_16x16x32_bf16 v[32:35], a[124:127], v[116:119], v[32:35]
    ds_read_b64_tr_b16 v[134:135], v9 offset:47104
    v_mfma_f32_16x16x32_bf16 v[36:39], v[116:119], v[116:119], v[36:39]
    ds_read_b64_tr_b16 v[136:137], v10 offset:45056
    v_mfma_f32_16x16x32_bf16 v[40:43], a[120:123], v[120:123], v[40:43]
    ds_read_b64_tr_b16 v[138:139], v10 offset:47104
    v_mfma_f32_16x16x32_bf16 v[44:47], a[124:127], v[120:123], v[44:47]
    buffer_load_dwordx4 a[148:151], v1, s[36:39], s9 offen offset:0 sc1
    v_mfma_f32_16x16x32_bf16 v[48:51], v[120:123], v[120:123], v[48:51]
    ds_read_b64_tr_b16 v[140:141], v11 offset:45056
    s_waitcnt lgkmcnt(7)
    v_mfma_f32_16x16x32_bf16 v[52:55], a[120:123], v[124:127], v[52:55]
    ds_read_b64_tr_b16 v[142:143], v11 offset:47104
    v_mfma_f32_16x16x32_bf16 v[56:59], a[124:127], v[124:127], v[56:59]
    buffer_load_dwordx4 a[156:159], v1, s[36:39], s8 offen offset:1024 sc1
    v_mfma_f32_16x16x32_bf16 v[60:63], v[124:127], v[124:127], v[60:63]
    s_waitcnt vmcnt(13) lgkmcnt(2)
    v_mfma_f32_16x16x32_bf16 v[16:19], a[132:135], v[128:131], v[16:19]
    s_waitcnt vmcnt(8)
    s_barrier
    v_mfma_f32_16x16x32_bf16 v[20:23], a[136:139], v[128:131], v[20:23]
    ds_read_b64_tr_b16 v[112:113], v12 offset:0
    v_mfma_f32_16x16x32_bf16 v[24:27], v[128:131], v[128:131], v[24:27]
    ds_read_b64_tr_b16 v[114:115], v12 offset:2048
    v_mfma_f32_16x16x32_bf16 v[28:31], a[132:135], v[132:135], v[28:31]
    ds_read_b64_tr_b16 v[116:117], v13 offset:0
    v_mfma_f32_16x16x32_bf16 v[32:35], a[136:139], v[132:135], v[32:35]
    buffer_load_dwordx4 a[160:163], v1, s[36:39], s9 offen offset:1024 sc1
    v_mfma_f32_16x16x32_bf16 v[36:39], v[132:135], v[132:135], v[36:39]
    ds_read_b64_tr_b16 v[118:119], v13 offset:2048
    v_mfma_f32_16x16x32_bf16 v[40:43], a[132:135], v[136:139], v[40:43]
    ds_read_b64_tr_b16 v[120:121], v14 offset:0
    v_mfma_f32_16x16x32_bf16 v[44:47], a[136:139], v[136:139], v[44:47]
    ds_read_b64_tr_b16 v[122:123], v14 offset:2048
    v_mfma_f32_16x16x32_bf16 v[48:51], v[136:139], v[136:139], v[48:51]
    s_waitcnt lgkmcnt(3)
    v_mfma_f32_16x16x32_bf16 v[52:55], a[132:135], v[140:143], v[52:55]
    ds_read_b64_tr_b16 v[124:125], v15 offset:0
    v_mfma_f32_16x16x32_bf16 v[56:59], a[136:139], v[140:143], v[56:59]
    ds_read_b64_tr_b16 v[126:127], v15 offset:2048
    s_waitcnt vmcnt(7)
    v_add_f32 v144, v144, v220
    v_add_f32 v145, v145, v221
    v_add_f32 v146, v146, v222
    v_mfma_f32_16x16x32_bf16 v[60:63], v[140:143], v[140:143], v[60:63]
    buffer_load_dwordx4 a[168:171], v1, s[36:39], s8 offen offset:2048 sc1
    v_add_f32 v147, v147, v223
    v_mfma_f32_16x16x32_bf16 v[64:67], a[0:3], v[112:115], 0
    ds_read_b64_tr_b16 v[128:129], v12 offset:4096
    v_mov_b32 v220, v144
    v_mfma_f32_16x16x32_bf16 v[68:71], a[4:7], v[112:115], 0
    ds_read_b64_tr_b16 v[130:131], v12 offset:6144
    v_mov_b32 v221, v145
    v_mfma_f32_16x16x32_bf16 v[72:75], v[112:115], v[112:115], 0
    ds_read_b64_tr_b16 v[132:133], v13 offset:4096
    v_mov_b32 v222, v146
    v_mov_b32 v223, v147
    s_waitcnt lgkmcnt(7)
    v_mfma_f32_16x16x32_bf16 v[76:79], a[0:3], v[116:119], 0
    buffer_load_dwordx4 a[172:175], v1, s[36:39], s9 offen offset:2048 sc1
    v_mov_b32 v224, 0xbfb8aa3b
    v_mfma_f32_16x16x32_bf16 v[80:83], a[4:7], v[116:119], 0
    ds_read_b64_tr_b16 v[134:135], v13 offset:6144
    v_cndmask_b32 v224, v224, 1.0, s[14:15]
    v_mfma_f32_16x16x32_bf16 v[84:87], v[116:119], v[116:119], 0
    ds_read_b64_tr_b16 v[136:137], v14 offset:4096
    s_add_u32 s71, s76, 132096
    v_add_u32 v2, s71, v1
    s_waitcnt lgkmcnt(7)
    v_mfma_f32_16x16x32_bf16 v[88:91], a[0:3], v[120:123], 0
    ds_read_b64_tr_b16 v[138:139], v14 offset:6144
    v_lshl_add_u32 v3, v5, 3, s71
    v_mfma_f32_16x16x32_bf16 v[92:95], a[4:7], v[120:123], 0
    s_waitcnt lgkmcnt(3)
    v_permlane32_swap_b32 v144, v220
    v_mfma_f32_16x16x32_bf16 v[96:99], v[120:123], v[120:123], 0
    ds_read_b64_tr_b16 v[140:141], v15 offset:4096
    v_mfma_f32_16x16x32_bf16 v[100:103], a[0:3], v[124:127], 0
    ds_read_b64_tr_b16 v[142:143], v15 offset:6144
    v_permlane32_swap_b32 v145, v221
    v_mfma_f32_16x16x32_bf16 v[104:107], a[4:7], v[124:127], 0
    buffer_load_dwordx4 a[180:183], v1, s[36:39], s8 offen offset:3072 sc1
    v_mfma_f32_16x16x32_bf16 v[108:111], v[124:127], v[124:127], 0
    s_waitcnt lgkmcnt(2)
    v_permlane32_swap_b32 v146, v222
    v_mfma_f32_16x16x32_bf16 v[64:67], a[12:15], v[128:131], v[64:67]
    ds_read_b64_tr_b16 v[112:113], v12 offset:8192
    v_permlane32_swap_b32 v147, v223
    v_mfma_f32_16x16x32_bf16 v[68:71], a[16:19], v[128:131], v[68:71]
    ds_read_b64_tr_b16 v[114:115], v12 offset:10240
    v_add_f32 v220, v144, v220
    v_mfma_f32_16x16x32_bf16 v[72:75], v[128:131], v[128:131], v[72:75]
    ds_read_b64_tr_b16 v[116:117], v13 offset:8192
    v_add_f32 v221, v145, v221
    v_mfma_f32_16x16x32_bf16 v[76:79], a[12:15], v[132:135], v[76:79]
    buffer_load_dwordx4 a[184:187], v1, s[36:39], s9 offen offset:3072 sc1
    v_add_f32 v222, v146, v222
    v_add_f32 v223, v147, v223
    v_mfma_f32_16x16x32_bf16 v[80:83], a[16:19], v[132:135], v[80:83]
    ds_read_b64_tr_b16 v[118:119], v13 offset:10240
    v_mul_f32 v220, v224, v220
    v_mfma_f32_16x16x32_bf16 v[84:87], v[132:135], v[132:135], v[84:87]
    ds_read_b64_tr_b16 v[120:121], v14 offset:8192
    v_mul_f32 v221, v224, v221
    v_mfma_f32_16x16x32_bf16 v[88:91], a[12:15], v[136:139], v[88:91]
    ds_read_b64_tr_b16 v[122:123], v14 offset:10240
    s_add_u32 m0, s63, 81920
    v_mfma_f32_16x16x32_bf16 v[92:95], a[16:19], v[136:139], v[92:95]
    s_waitcnt lgkmcnt(3)
    s_add_u32 s6, m0, s49
    v_mul_f32 v222, v224, v222
    v_mul_f32 v223, v224, v223
    v_mfma_f32_16x16x32_bf16 v[96:99], v[136:139], v[136:139], v[96:99]
    ds_write_b128 v2, v[220:223]
    v_mfma_f32_16x16x32_bf16 v[100:103], a[12:15], v[140:143], v[100:103]
    ds_read2_b64 v[156:159], v3 offset0:0 offset1:4
    buffer_load_dwordx4 v1, s[36:39], s6 offen offset:0 sc1 lds
    v_mfma_f32_16x16x32_bf16 v[104:107], a[16:19], v[140:143], v[104:107]
    ds_read_b64_tr_b16 v[124:125], v15 offset:8192
    v_mfma_f32_16x16x32_bf16 v[108:111], v[140:143], v[140:143], v[108:111]
    ds_read_b64_tr_b16 v[126:127], v15 offset:10240
    v_mfma_f32_16x16x32_bf16 v[64:67], a[24:27], v[112:115], v[64:67]
    ds_read2_b64 v[144:147], v3 offset0:8 offset1:12
    v_mfma_f32_16x16x32_bf16 v[68:71], a[28:31], v[112:115], v[68:71]
    ds_read2_b64 v[160:163], v3 offset0:16 offset1:20
    buffer_load_dwordx4 v1, s[36:39], s6 offen offset:1024 sc1 lds
    v_mfma_f32_16x16x32_bf16 v[72:75], v[112:115], v[112:115], v[72:75]
    ds_read_b64_tr_b16 v[128:129], v12 offset:12288
    s_waitcnt lgkmcnt(9)
    v_mfma_f32_16x16x32_bf16 v[76:79], a[24:27], v[116:119], v[76:79]
    ds_read_b64_tr_b16 v[130:131], v12 offset:14336
    v_mfma_f32_16x16x32_bf16 v[80:83], a[28:31], v[116:119], v[80:83]
    ds_read_b64_tr_b16 v[132:133], v13 offset:12288
    v_mfma_f32_16x16x32_bf16 v[84:87], v[116:119], v[116:119], v[84:87]
    ds_read2_b64 v[148:151], v3 offset0:24 offset1:28
    buffer_load_dwordx4 v1, s[36:39], s6 offen offset:2048 sc1 lds
    s_waitcnt lgkmcnt(10)
    v_mfma_f32_16x16x32_bf16 v[88:91], a[24:27], v[120:123], v[88:91]
    ds_read_b64_tr_b16 v[134:135], v13 offset:14336
    v_mfma_f32_16x16x32_bf16 v[92:95], a[28:31], v[120:123], v[92:95]
    ds_read_b64_tr_b16 v[136:137], v14 offset:12288
    v_mfma_f32_16x16x32_bf16 v[96:99], v[120:123], v[120:123], v[96:99]
    ds_read_b64_tr_b16 v[138:139], v14 offset:14336
    s_waitcnt lgkmcnt(9)
    v_mfma_f32_16x16x32_bf16 v[100:103], a[24:27], v[124:127], v[100:103]
    ds_read2_b64 v[164:167], v3 offset0:32 offset1:36
    buffer_load_dwordx4 v1, s[36:39], s6 offen offset:3072 sc1 lds
    v_mfma_f32_16x16x32_bf16 v[104:107], a[28:31], v[124:127], v[104:107]
    ds_read_b64_tr_b16 v[140:141], v15 offset:12288
    s_add_u32 m0, s63, 98304
    s_add_u32 s6, m0, s49
    v_mfma_f32_16x16x32_bf16 v[108:111], v[124:127], v[124:127], v[108:111]
    ds_read_b64_tr_b16 v[142:143], v15 offset:14336
    s_waitcnt lgkmcnt(8)
    v_mfma_f32_16x16x32_bf16 v[64:67], a[36:39], v[128:131], v[64:67]
    ds_read2_b64 v[152:155], v3 offset0:40 offset1:44
    v_mfma_f32_16x16x32_bf16 v[68:71], a[40:43], v[128:131], v[68:71]
    s_waitcnt vmcnt(11)
    s_barrier
    buffer_load_dwordx4 v1, s[36:39], s6 offen offset:0 sc1 lds
    v_mfma_f32_16x16x32_bf16 v[72:75], v[128:131], v[128:131], v[72:75]
    ds_read_b64_tr_b16 v[112:113], v8 offset:49152
    s_waitcnt lgkmcnt(7)
    v_mfma_f32_16x16x32_bf16 v[76:79], a[36:39], v[132:135], v[76:79]
    ds_read_b64 v[208:209], v7
    v_mfma_f32_16x16x32_bf16 v[80:83], a[40:43], v[132:135], v[80:83]
    ds_read_b64_tr_b16 v[114:115], v8 offset:51200
    v_mfma_f32_16x16x32_bf16 v[84:87], v[132:135], v[132:135], v[84:87]
    ds_read_b64_tr_b16 v[116:117], v9 offset:49152
    buffer_load_dwordx4 v1, s[36:39], s6 offen offset:1024 sc1 lds
    s_waitcnt lgkmcnt(8)
    v_mfma_f32_16x16x32_bf16 v[88:91], a[36:39], v[136:139], v[88:91]
    ds_read_b64 v[210:211], v7 offset:128
    v_add_u32 v7, 0x10000, v7
    v_mfma_f32_16x16x32_bf16 v[92:95], a[40:43], v[136:139], v[92:95]
    ds_read_b64_tr_b16 v[118:119], v9 offset:51200
    v_mfma_f32_16x16x32_bf16 v[96:99], v[136:139], v[136:139], v[96:99]
    ds_read_b64_tr_b16 v[120:121], v10 offset:49152
    s_waitcnt lgkmcnt(8)
    v_mfma_f32_16x16x32_bf16 v[100:103], a[36:39], v[140:143], v[100:103]
    ds_read_b64_tr_b16 v[122:123], v10 offset:51200
    buffer_load_dwordx4 v1, s[36:39], s6 offen offset:2048 sc1 lds
    v_mfma_f32_16x16x32_bf16 v[104:107], a[40:43], v[140:143], v[104:107]
    ds_read_b64_tr_b16 v[124:125], v11 offset:49152
    v_mfma_f32_16x16x32_bf16 v[108:111], v[140:143], v[140:143], v[108:111]
    ds_read_b64_tr_b16 v[126:127], v11 offset:51200
    s_waitcnt lgkmcnt(7)
    v_mfma_f32_16x16x32_bf16 v[16:19], a[144:147], v[112:115], v[16:19]
    ds_read_b64_tr_b16 v[128:129], v8 offset:53248
    s_waitcnt vmcnt(13)
    v_mfma_f32_16x16x32_bf16 v[20:23], a[148:151], v[112:115], v[20:23]
    ds_read_b64_tr_b16 v[130:131], v8 offset:55296
    buffer_load_dwordx4 v1, s[36:39], s6 offen offset:3072 sc1 lds
    v_mfma_f32_16x16x32_bf16 v[24:27], v[112:115], v[112:115], v[24:27]
    ds_read_b64_tr_b16 v[132:133], v9 offset:53248
    s_add_u32 m0, s63, 114688
    s_add_u32 s6, m0, s49
    s_waitcnt lgkmcnt(7)
    v_mfma_f32_16x16x32_bf16 v[28:31], a[144:147], v[116:119], v[28:31]
    buffer_load_dwordx4 v1, s[36:39], s6 offen offset:0 sc1 lds
    v_mfma_f32_16x16x32_bf16 v[32:35], a[148:151], v[116:119], v[32:35]
    ds_read_b64_tr_b16 v[134:135], v9 offset:55296
    v_mfma_f32_16x16x32_bf16 v[36:39], v[116:119], v[116:119], v[36:39]
    ds_read_b64_tr_b16 v[136:137], v10 offset:53248
    s_waitcnt lgkmcnt(7)
    v_mfma_f32_16x16x32_bf16 v[40:43], a[144:147], v[120:123], v[40:43]
    ds_read_b64_tr_b16 v[138:139], v10 offset:55296
    v_mfma_f32_16x16x32_bf16 v[44:47], a[148:151], v[120:123], v[44:47]
    buffer_load_dwordx4 v1, s[36:39], s6 offen offset:1024 sc1 lds
    v_mfma_f32_16x16x32_bf16 v[48:51], v[120:123], v[120:123], v[48:51]
    ds_read_b64_tr_b16 v[140:141], v11 offset:53248
    s_waitcnt lgkmcnt(7)
    v_mfma_f32_16x16x32_bf16 v[52:55], a[144:147], v[124:127], v[52:55]
    ds_read_b64_tr_b16 v[142:143], v11 offset:55296
    v_mfma_f32_16x16x32_bf16 v[56:59], a[148:151], v[124:127], v[56:59]
    buffer_load_dwordx4 v1, s[36:39], s6 offen offset:2048 sc1 lds
    v_mfma_f32_16x16x32_bf16 v[60:63], v[124:127], v[124:127], v[60:63]
    s_waitcnt vmcnt(15) lgkmcnt(2)
    v_mfma_f32_16x16x32_bf16 v[16:19], a[156:159], v[128:131], v[16:19]
    ds_read_b64_tr_b16 v[112:113], v8 offset:57344
    v_mfma_f32_16x16x32_bf16 v[20:23], a[160:163], v[128:131], v[20:23]
    ds_read_b64_tr_b16 v[114:115], v8 offset:59392
    v_mfma_f32_16x16x32_bf16 v[24:27], v[128:131], v[128:131], v[24:27]
    ds_read_b64_tr_b16 v[116:117], v9 offset:57344
    v_mfma_f32_16x16x32_bf16 v[28:31], a[156:159], v[132:135], v[28:31]
    buffer_load_dwordx4 v1, s[36:39], s6 offen offset:3072 sc1 lds
    v_mfma_f32_16x16x32_bf16 v[32:35], a[160:163], v[132:135], v[32:35]
    ds_read_b64_tr_b16 v[118:119], v9 offset:59392
    v_mfma_f32_16x16x32_bf16 v[36:39], v[132:135], v[132:135], v[36:39]
    ds_read_b64_tr_b16 v[120:121], v10 offset:57344
    v_mfma_f32_16x16x32_bf16 v[40:43], a[156:159], v[136:139], v[40:43]
    ds_read_b64_tr_b16 v[122:123], v10 offset:59392
    v_mov_b32 v228, -1
    v_mov_b32 v229, -1
    v_mov_b32 v230, -1
    v_mov_b32 v231, -1
    v_mfma_f32_16x16x32_bf16 v[44:47], a[160:163], v[136:139], v[44:47]
    buffer_store_dwordx4 v[228:231], v6, s[36:39], s17 offen offset:0 sc1
    v_mfma_f32_16x16x32_bf16 v[48:51], v[136:139], v[136:139], v[48:51]
    ds_read_b64_tr_b16 v[124:125], v11 offset:57344
    s_waitcnt lgkmcnt(7)
    v_mfma_f32_16x16x32_bf16 v[52:55], a[156:159], v[140:143], v[52:55]
    ds_read_b64_tr_b16 v[126:127], v11 offset:59392
    v_mfma_f32_16x16x32_bf16 v[56:59], a[160:163], v[140:143], v[56:59]
    buffer_store_dwordx4 v[228:231], v6, s[36:39], s17 offen offset:256 sc1
    v_mfma_f32_16x16x32_bf16 v[60:63], v[140:143], v[140:143], v[60:63]
    s_waitcnt vmcnt(16) lgkmcnt(2)
    v_mfma_f32_16x16x32_bf16 v[16:19], a[168:171], v[112:115], v[16:19]
    ds_read_b64_tr_b16 v[128:129], v8 offset:61440
    v_mfma_f32_16x16x32_bf16 v[20:23], a[172:175], v[112:115], v[20:23]
    ds_read_b64_tr_b16 v[130:131], v8 offset:63488
    v_mfma_f32_16x16x32_bf16 v[24:27], v[112:115], v[112:115], v[24:27]
    ds_read_b64_tr_b16 v[132:133], v9 offset:61440
    v_mfma_f32_16x16x32_bf16 v[28:31], a[168:171], v[116:119], v[28:31]
    buffer_load_dwordx4 a[192:195], v1, s[36:39], s26 offen offset:0 sc1
    v_mfma_f32_16x16x32_bf16 v[32:35], a[172:175], v[116:119], v[32:35]
    ds_read_b64_tr_b16 v[134:135], v9 offset:63488
    v_mfma_f32_16x16x32_bf16 v[36:39], v[116:119], v[116:119], v[36:39]
    ds_read_b64_tr_b16 v[136:137], v10 offset:61440
    v_mfma_f32_16x16x32_bf16 v[40:43], a[168:171], v[120:123], v[40:43]
    ds_read_b64_tr_b16 v[138:139], v10 offset:63488
    v_mfma_f32_16x16x32_bf16 v[44:47], a[172:175], v[120:123], v[44:47]
    buffer_load_dwordx4 a[196:199], v1, s[36:39], s26 offen offset:1024 sc1
    v_mfma_f32_16x16x32_bf16 v[48:51], v[120:123], v[120:123], v[48:51]
    ds_read_b64_tr_b16 v[140:141], v11 offset:61440
    s_waitcnt lgkmcnt(7)
    v_mfma_f32_16x16x32_bf16 v[52:55], a[168:171], v[124:127], v[52:55]
    ds_read_b64_tr_b16 v[142:143], v11 offset:63488
    v_mfma_f32_16x16x32_bf16 v[56:59], a[172:175], v[124:127], v[56:59]
    buffer_load_dwordx4 a[200:203], v1, s[36:39], s27 offen offset:0 sc1
    v_mfma_f32_16x16x32_bf16 v[60:63], v[124:127], v[124:127], v[60:63]
    s_waitcnt vmcnt(17) lgkmcnt(2)
    v_mfma_f32_16x16x32_bf16 v[24:27], v[128:131], v[128:131], v[24:27]
    s_waitcnt vmcnt(13)
    s_barrier
    v_mfma_f32_16x16x32_bf16 v[20:23], a[184:187], v[128:131], v[20:23]
    ds_read_b64_tr_b16 v[112:113], v12 offset:16384
    v_mfma_f32_16x16x32_bf16 v[36:39], v[132:135], v[132:135], v[36:39]
    ds_read_b64_tr_b16 v[114:115], v12 offset:18432
    v_mfma_f32_16x16x32_bf16 v[32:35], a[184:187], v[132:135], v[32:35]
    ds_read_b64_tr_b16 v[116:117], v13 offset:16384
    v_mfma_f32_16x16x32_bf16 v[48:51], v[136:139], v[136:139], v[48:51]
    buffer_load_dwordx4 a[204:207], v1, s[36:39], s27 offen offset:1024 sc1
    s_add_u32 s26, s26, 4096
    s_add_u32 s27, s27, 4096
    v_mfma_f32_16x16x32_bf16 v[44:47], a[184:187], v[136:139], v[44:47]
    ds_read_b64_tr_b16 v[118:119], v13 offset:18432
    s_waitcnt lgkmcnt(4)
    v_mfma_f32_16x16x32_bf16 v[60:63], v[140:143], v[140:143], v[60:63]
    ds_read_b64_tr_b16 v[120:121], v14 offset:16384
    v_mfma_f32_16x16x32_bf16 v[56:59], a[184:187], v[140:143], v[56:59]
    ds_read_b64_tr_b16 v[122:123], v14 offset:18432
    v_mfma_f32_16x16x32_bf16 v[16:19], a[180:183], v[128:131], v[16:19]
    buffer_load_dwordx4 a[208:211], v1, s[36:39], s26 offen offset:0 sc1
    v_mfma_f32_16x16x32_bf16 v[28:31], a[180:183], v[132:135], v[28:31]
    ds_read_b64_tr_b16 v[124:125], v15 offset:16384
    v_mfma_f32_16x16x32_bf16 v[40:43], a[180:183], v[136:139], v[40:43]
    ds_read_b64_tr_b16 v[126:127], v15 offset:18432
    v_mfma_f32_16x16x32_bf16 v[52:55], a[180:183], v[140:143], v[52:55]
    buffer_load_dwordx4 a[212:215], v1, s[36:39], s26 offen offset:1024 sc1
    s_waitcnt lgkmcnt(6)
    v_mfma_f32_16x16x32_bf16 v[64:67], a[48:51], v[112:115], v[64:67]
    v_cndmask_b32 v180, v24, v25, s[30:31]
    v_cndmask_b32 v188, v26, v27, s[30:31]
    v_cndmask_b32 v180, v180, v188, s[14:15]
    v_cndmask_b32 v180, 0, v180, s[32:33]
    v_cndmask_b32 v184, 0, v20, s[34:35]
    v_cndmask_b32 v181, v36, v37, s[30:31]
    v_cndmask_b32 v188, v38, v39, s[30:31]
    v_cndmask_b32 v181, v181, v188, s[14:15]
    v_cndmask_b32 v181, 0, v181, s[32:33]
    v_cndmask_b32 v185, 0, v32, s[34:35]
    v_cndmask_b32 v182, v48, v49, s[30:31]
    v_cndmask_b32 v188, v50, v51, s[30:31]
    v_cndmask_b32 v182, v182, v188, s[14:15]
    v_cndmask_b32 v182, 0, v182, s[32:33]
    v_cndmask_b32 v186, 0, v44, s[34:35]
    v_cndmask_b32 v183, v60, v61, s[30:31]
    v_cndmask_b32 v188, v62, v63, s[30:31]
    v_cndmask_b32 v183, v183, v188, s[14:15]
    v_cndmask_b32 v183, 0, v183, s[32:33]
    v_cndmask_b32 v187, 0, v56, s[34:35]
    v_permlane32_swap_b32 v180, v182
    v_permlane32_swap_b32 v181, v183
    v_permlane32_swap_b32 v184, v186
    v_permlane32_swap_b32 v185, v187
    v_add_f32 v180, v180, v182
    v_add_f32 v181, v181, v183
    v_add_f32 v184, v184, v186
    v_add_f32 v185, v185, v187
    v_permlane16_swap_b32 v180, v181
    s_nop 0
    v_permlane16_swap_b32 v184, v185
    v_add_f32 v184, v184, v185
    v_add_f32 v180, v180, v181
    v_mul_f32 v184, 0x3b000000, v184
    v_mul_f32 v180, 0x3b000000, v180
    v_fma_f32 v180, -v184, v184, v180
    v_max_f32 v180, 0, v180
    v_add_f32 v180, 0x3727c5ac, v180
    v_rsq_f32 v180, v180
    s_nop 0
    v_mul_f32 v181, -v184, v180
    ds_write_b64 v248, v[180:181] offset:0
    s_waitcnt lgkmcnt(0)
    s_barrier
    v_mfma_f32_16x16x32_bf16 v[68:71], a[52:55], v[112:115], v[68:71]
    ds_read_b64_tr_b16 v[128:129], v12 offset:20480
    v_mfma_f32_16x16x32_bf16 v[72:75], v[112:115], v[112:115], v[72:75]
    ds_read_b64_tr_b16 v[130:131], v12 offset:22528
    v_mfma_f32_16x16x32_bf16 v[76:79], a[48:51], v[116:119], v[76:79]
    ds_read_b64_tr_b16 v[132:133], v13 offset:20480
    v_mfma_f32_16x16x32_bf16 v[80:83], a[52:55], v[116:119], v[80:83]
    ds_read_b64_tr_b16 v[134:135], v13 offset:22528
    v_mfma_f32_16x16x32_bf16 v[84:87], v[116:119], v[116:119], v[84:87]
    ds_read_b64_tr_b16 v[136:137], v14 offset:20480
    buffer_load_dwordx4 a[216:219], v1, s[36:39], s27 offen offset:0 sc1
    v_mfma_f32_16x16x32_bf16 v[88:91], a[48:51], v[120:123], v[88:91]
    ds_read_b64_tr_b16 v[138:139], v14 offset:22528
    v_mfma_f32_16x16x32_bf16 v[92:95], a[52:55], v[120:123], v[92:95]
    buffer_load_dwordx4 a[220:223], v1, s[36:39], s27 offen offset:1024 sc1
    s_add_u32 s26, s26, 4096
    s_add_u32 s27, s27, 4096
    v_mfma_f32_16x16x32_bf16 v[96:99], v[120:123], v[120:123], v[96:99]
    ds_read_b64_tr_b16 v[140:141], v15 offset:20480
    v_mfma_f32_16x16x32_bf16 v[100:103], a[48:51], v[124:127], v[100:103]
    ds_read_b64_tr_b16 v[142:143], v15 offset:22528
    v_mfma_f32_16x16x32_bf16 v[104:107], a[52:55], v[124:127], v[104:107]
    buffer_load_dwordx4 a[224:227], v1, s[36:39], s26 offen offset:0 sc1
    v_mfma_f32_16x16x32_bf16 v[108:111], v[124:127], v[124:127], v[108:111]
    s_waitcnt lgkmcnt(2)
    v_mfma_f32_16x16x32_bf16 v[64:67], a[60:63], v[128:131], v[64:67]
    ds_read_b64_tr_b16 v[112:113], v12 offset:24576
    v_mfma_f32_16x16x32_bf16 v[68:71], a[64:67], v[128:131], v[68:71]
    ds_read_b64 v[168:169], v249 offset:0
    v_mfma_f32_16x16x32_bf16 v[72:75], v[128:131], v[128:131], v[72:75]
    ds_read_b64 v[170:171], v249 offset:128
    v_mfma_f32_16x16x32_bf16 v[76:79], a[60:63], v[132:135], v[76:79]
    ds_read_b64_tr_b16 v[114:115], v12 offset:26624
    v_mfma_f32_16x16x32_bf16 v[80:83], a[64:67], v[132:135], v[80:83]
    ds_read_b64_tr_b16 v[116:117], v13 offset:24576
    v_mfma_f32_16x16x32_bf16 v[84:87], v[132:135], v[132:135], v[84:87]
    ds_read_b64 v[172:173], v249 offset:256
    buffer_load_dwordx4 a[228:231], v1, s[36:39], s26 offen offset:1024 sc1
    v_mfma_f32_16x16x32_bf16 v[88:91], a[60:63], v[136:139], v[88:91]
    ds_read_b64_tr_b16 v[118:119], v13 offset:26624
    v_mfma_f32_16x16x32_bf16 v[92:95], a[64:67], v[136:139], v[92:95]
    ds_read_b64_tr_b16 v[120:121], v14 offset:24576
    v_mfma_f32_16x16x32_bf16 v[96:99], v[136:139], v[136:139], v[96:99]
    ds_read_b64_tr_b16 v[122:123], v14 offset:26624
    s_waitcnt lgkmcnt(9)
    v_mfma_f32_16x16x32_bf16 v[100:103], a[60:63], v[140:143], v[100:103]
    ds_read_b64 v[174:175], v249 offset:384
    buffer_load_dwordx4 a[232:235], v1, s[36:39], s27 offen offset:0 sc1
    s_waitcnt lgkmcnt(8)
    v_mul_f32 v176, 0xbfb8aa3b, v168
    v_mfma_f32_16x16x32_bf16 v[104:107], a[64:67], v[140:143], v[104:107]
    ds_read_b64_tr_b16 v[124:125], v15 offset:24576
    s_waitcnt lgkmcnt(8)
    v_mul_f32 v177, 0xbfb8aa3b, v170
    v_mfma_f32_16x16x32_bf16 v[108:111], v[140:143], v[140:143], v[108:111]
    ds_read_b64_tr_b16 v[126:127], v15 offset:26624
    s_waitcnt lgkmcnt(6)
    v_mul_f32 v178, 0xbfb8aa3b, v172
    v_mfma_f32_16x16x32_bf16 v[64:67], a[72:75], v[112:115], v[64:67]
    ds_read_b64_tr_b16 v[128:129], v12 offset:28672
    s_waitcnt lgkmcnt(3)
    v_mul_f32 v179, 0xbfb8aa3b, v174
    v_pk_fma_f32 v[180:181], v[168:169], v[144:145], v[156:157] op_sel:[1,0,0] op_sel_hi:[1,1,1]
    v_pk_fma_f32 v[182:183], v[168:169], v[146:147], v[158:159] op_sel:[1,0,0] op_sel_hi:[1,1,1]
    v_pk_fma_f32 v[180:181], v[176:177], v[16:17], v[180:181] op_sel:[0,0,0] op_sel_hi:[0,1,1]
    v_pk_fma_f32 v[184:185], v[170:171], v[144:145], v[156:157] op_sel:[1,0,0] op_sel_hi:[1,1,1]
    v_pk_fma_f32 v[186:187], v[170:171], v[146:147], v[158:159] op_sel:[1,0,0] op_sel_hi:[1,1,1]
    v_pk_fma_f32 v[184:185], v[176:177], v[28:29], v[184:185] op_sel:[1,0,0] op_sel_hi:[1,1,1]
    v_pk_fma_f32 v[188:189], v[172:173], v[144:145], v[156:157] op_sel:[1,0,0] op_sel_hi:[1,1,1]
    v_pk_fma_f32 v[190:191], v[172:173], v[146:147], v[158:159] op_sel:[1,0,0] op_sel_hi:[1,1,1]
    v_pk_fma_f32 v[188:189], v[178:179], v[40:41], v[188:189] op_sel:[0,0,0] op_sel_hi:[0,1,1]
    v_pk_fma_f32 v[192:193], v[174:175], v[144:145], v[156:157] op_sel:[1,0,0] op_sel_hi:[1,1,1]
    v_pk_fma_f32 v[194:195], v[174:175], v[146:147], v[158:159] op_sel:[1,0,0] op_sel_hi:[1,1,1]
    v_pk_fma_f32 v[192:193], v[178:179], v[52:53], v[192:193] op_sel:[1,0,0] op_sel_hi:[1,1,1]
    v_pk_fma_f32 v[182:183], v[168:169], v[18:19], v[182:183] op_sel_hi:[0,1,1]
    v_pk_fma_f32 v[186:187], v[170:171], v[30:31], v[186:187] op_sel_hi:[0,1,1]
    v_pk_fma_f32 v[190:191], v[172:173], v[42:43], v[190:191] op_sel_hi:[0,1,1]
    v_pk_fma_f32 v[194:195], v[174:175], v[54:55], v[194:195] op_sel_hi:[0,1,1]
    v_mfma_f32_16x16x32_bf16 v[68:71], a[76:79], v[112:115], v[68:71]
    ds_read_b64_tr_b16 v[130:131], v12 offset:30720
    buffer_load_dwordx4 a[236:239], v1, s[36:39], s27 offen offset:1024 sc1
    v_mfma_f32_16x16x32_bf16 v[72:75], v[112:115], v[112:115], v[72:75]
    ds_read_b64_tr_b16 v[132:133], v13 offset:28672
    s_add_u32 s26, s26, 4096
    s_add_u32 s27, s27, 4096
    v_mfma_f32_16x16x32_bf16 v[76:79], a[72:75], v[116:119], v[76:79]
    buffer_load_dwordx4 a[240:243], v1, s[36:39], s26 offen offset:0 sc1
    v_mfma_f32_16x16x32_bf16 v[80:83], a[76:79], v[116:119], v[80:83]
    ds_read_b64_tr_b16 v[134:135], v13 offset:30720
    v_exp_f32 v180, v180
    v_mfma_f32_16x16x32_bf16 v[84:87], v[116:119], v[116:119], v[84:87]
    ds_read_b64_tr_b16 v[136:137], v14 offset:28672
    v_exp_f32 v181, v181
    v_mfma_f32_16x16x32_bf16 v[88:91], a[72:75], v[120:123], v[88:91]
    ds_read_b64_tr_b16 v[138:139], v14 offset:30720
    v_exp_f32 v184, v184
    v_mfma_f32_16x16x32_bf16 v[92:95], a[76:79], v[120:123], v[92:95]
    buffer_load_dwordx4 a[244:247], v1, s[36:39], s26 offen offset:1024 sc1
    v_exp_f32 v185, v185
    v_mfma_f32_16x16x32_bf16 v[96:99], v[120:123], v[120:123], v[96:99]
    ds_read_b64_tr_b16 v[140:141], v15 offset:28672
    s_waitcnt lgkmcnt(7)
    v_mfma_f32_16x16x32_bf16 v[100:103], a[72:75], v[124:127], v[100:103]
    ds_read_b64_tr_b16 v[142:143], v15 offset:30720
    v_exp_f32 v188, v188
    v_mfma_f32_16x16x32_bf16 v[104:107], a[76:79], v[124:127], v[104:107]
    buffer_load_dwordx4 a[248:251], v1, s[36:39], s27 offen offset:0 sc1
    v_exp_f32 v189, v189
    v_mfma_f32_16x16x32_bf16 v[108:111], v[124:127], v[124:127], v[108:111]
    s_waitcnt lgkmcnt(2)
    v_exp_f32 v192, v192
    v_mfma_f32_16x16x32_bf16 v[64:67], a[84:87], v[128:131], v[64:67]
    s_waitcnt vmcnt(17)
    s_barrier
    v_exp_f32 v193, v193
    v_pk_add_f32 v[180:181], v[180:181], 1.0 op_sel_hi:[1,0]
    v_pk_add_f32 v[184:185], v[184:185], 1.0 op_sel_hi:[1,0]
    v_pk_add_f32 v[188:189], v[188:189], 1.0 op_sel_hi:[1,0]
    v_pk_add_f32 v[192:193], v[192:193], 1.0 op_sel_hi:[1,0]
    v_mfma_f32_16x16x32_bf16 v[68:71], a[88:91], v[128:131], v[68:71]
    ds_read_b64_tr_b16 v[112:113], v12 offset:32768
    v_rcp_f32 v180, v180
    v_mfma_f32_16x16x32_bf16 v[72:75], v[128:131], v[128:131], v[72:75]
    ds_read_b64_tr_b16 v[114:115], v12 offset:34816
    v_rcp_f32 v181, v181
    v_mfma_f32_16x16x32_bf16 v[76:79], a[84:87], v[132:135], v[76:79]
    ds_read_b64_tr_b16 v[116:117], v13 offset:32768
    v_rcp_f32 v184, v184
    v_mfma_f32_16x16x32_bf16 v[80:83], a[88:91], v[132:135], v[80:83]
    buffer_load_dwordx4 a[252:255], v1, s[36:39], s27 offen offset:1024 sc1
    s_add_u32 s26, s26, 4096
    s_add_u32 s27, s27, 4096
    v_mfma_f32_16x16x32_bf16 v[84:87], v[132:135], v[132:135], v[84:87]
    ds_read_b64_tr_b16 v[118:119], v13 offset:34816
    v_rcp_f32 v185, v185
    v_mfma_f32_16x16x32_bf16 v[88:91], a[84:87], v[136:139], v[88:91]
    ds_read_b64_tr_b16 v[120:121], v14 offset:32768
    v_mfma_f32_16x16x32_bf16 v[92:95], a[88:91], v[136:139], v[92:95]
    ds_read_b64_tr_b16 v[122:123], v14 offset:34816
    v_rcp_f32 v188, v188
    v_mfma_f32_16x16x32_bf16 v[96:99], v[136:139], v[136:139], v[96:99]
    buffer_load_dwordx4 a[0:3], v1, s[36:39], s26 offen offset:0 sc1
    v_rcp_f32 v189, v189
    s_waitcnt lgkmcnt(6)
    v_mfma_f32_16x16x32_bf16 v[100:103], a[84:87], v[140:143], v[100:103]
    ds_read_b64_tr_b16 v[124:125], v15 offset:32768
    v_rcp_f32 v192, v192
    v_mfma_f32_16x16x32_bf16 v[104:107], a[88:91], v[140:143], v[104:107]
    ds_read_b64_tr_b16 v[126:127], v15 offset:34816
    v_rcp_f32 v193, v193
    v_pk_mul_f32 v[180:181], v[180:181], v[182:183]
    v_pk_mul_f32 v[184:185], v[184:185], v[186:187]
    v_pk_mul_f32 v[188:189], v[188:189], v[190:191]
    v_pk_mul_f32 v[192:193], v[192:193], v[194:195]
    v_mfma_f32_16x16x32_bf16 v[108:111], v[140:143], v[140:143], v[108:111]
    buffer_load_dwordx4 a[4:7], v1, s[36:39], s26 offen offset:1024 sc1
    v_cvt_pk_bf16_f32 v196, v180, v181
    s_waitcnt lgkmcnt(6)
    v_mfma_f32_16x16x32_bf16 v[64:67], a[96:99], v[112:115], v[64:67]
    ds_read_b64_tr_b16 v[128:129], v12 offset:36864
    v_cvt_pk_bf16_f32 v197, v184, v185
    v_cvt_pk_bf16_f32 v198, v188, v189
    v_mfma_f32_16x16x32_bf16 v[68:71], a[100:103], v[112:115], v[68:71]
    ds_read_b64_tr_b16 v[130:131], v12 offset:38912
    v_cvt_pk_bf16_f32 v199, v192, v193
    v_mfma_f32_16x16x32_bf16 v[72:75], v[112:115], v[112:115], v[72:75]
    ds_read_b64_tr_b16 v[132:133], v13 offset:36864
    v_permlane32_swap_b32 v196, v198
    s_waitcnt lgkmcnt(7)
    v_mfma_f32_16x16x32_bf16 v[76:79], a[96:99], v[116:119], v[76:79]
    buffer_load_dwordx4 a[8:11], v1, s[36:39], s27 offen offset:0 sc1
    v_permlane32_swap_b32 v197, v199
    v_mfma_f32_16x16x32_bf16 v[80:83], a[100:103], v[116:119], v[80:83]
    ds_read_b64_tr_b16 v[134:135], v13 offset:38912
    v_permlane16_swap_b32 v196, v197
    v_mfma_f32_16x16x32_bf16 v[84:87], v[116:119], v[116:119], v[84:87]
    ds_read_b64_tr_b16 v[136:137], v14 offset:36864
    v_permlane16_swap_b32 v198, v199
    s_waitcnt lgkmcnt(7)
    v_mfma_f32_16x16x32_bf16 v[88:91], a[96:99], v[120:123], v[88:91]
    buffer_store_dwordx4 v[196:199], v6, s[36:39], s16 offen offset:0 sc1
    v_pk_fma_f32 v[180:181], v[168:169], v[148:149], v[160:161] op_sel:[1,0,0] op_sel_hi:[1,1,1]
    v_pk_fma_f32 v[182:183], v[168:169], v[150:151], v[162:163] op_sel:[1,0,0] op_sel_hi:[1,1,1]
    v_pk_fma_f32 v[180:181], v[176:177], v[20:21], v[180:181] op_sel:[0,0,0] op_sel_hi:[0,1,1]
    v_pk_fma_f32 v[184:185], v[170:171], v[148:149], v[160:161] op_sel:[1,0,0] op_sel_hi:[1,1,1]
    v_pk_fma_f32 v[186:187], v[170:171], v[150:151], v[162:163] op_sel:[1,0,0] op_sel_hi:[1,1,1]
    v_pk_fma_f32 v[184:185], v[176:177], v[32:33], v[184:185] op_sel:[1,0,0] op_sel_hi:[1,1,1]
    v_pk_fma_f32 v[188:189], v[172:173], v[148:149], v[160:161] op_sel:[1,0,0] op_sel_hi:[1,1,1]
    v_pk_fma_f32 v[190:191], v[172:173], v[150:151], v[162:163] op_sel:[1,0,0] op_sel_hi:[1,1,1]
    v_pk_fma_f32 v[188:189], v[178:179], v[44:45], v[188:189] op_sel:[0,0,0] op_sel_hi:[0,1,1]
    v_pk_fma_f32 v[192:193], v[174:175], v[148:149], v[160:161] op_sel:[1,0,0] op_sel_hi:[1,1,1]
    v_pk_fma_f32 v[194:195], v[174:175], v[150:151], v[162:163] op_sel:[1,0,0] op_sel_hi:[1,1,1]
    v_pk_fma_f32 v[192:193], v[178:179], v[56:57], v[192:193] op_sel:[1,0,0] op_sel_hi:[1,1,1]
    v_pk_fma_f32 v[182:183], v[168:169], v[22:23], v[182:183] op_sel_hi:[0,1,1]
    v_pk_fma_f32 v[186:187], v[170:171], v[34:35], v[186:187] op_sel_hi:[0,1,1]
    v_pk_fma_f32 v[190:191], v[172:173], v[46:47], v[190:191] op_sel_hi:[0,1,1]
    v_pk_fma_f32 v[194:195], v[174:175], v[58:59], v[194:195] op_sel_hi:[0,1,1]
    v_mfma_f32_16x16x32_bf16 v[92:95], a[100:103], v[120:123], v[92:95]
    ds_read_b64_tr_b16 v[138:139], v14 offset:38912
    v_exp_f32 v180, v180
    v_mfma_f32_16x16x32_bf16 v[96:99], v[120:123], v[120:123], v[96:99]
    ds_read_b64_tr_b16 v[140:141], v15 offset:36864
    v_exp_f32 v181, v181
    s_waitcnt lgkmcnt(7)
    v_mfma_f32_16x16x32_bf16 v[100:103], a[96:99], v[124:127], v[100:103]
    ds_read_b64_tr_b16 v[142:143], v15 offset:38912
    buffer_load_dwordx4 a[12:15], v1, s[36:39], s27 offen offset:1024 sc1
    v_mfma_f32_16x16x32_bf16 v[104:107], a[100:103], v[124:127], v[104:107]
    s_waitcnt lgkmcnt(3)
    s_add_u32 s26, s26, 4096
    s_add_u32 s27, s27, 4096
    v_mfma_f32_16x16x32_bf16 v[108:111], v[124:127], v[124:127], v[108:111]
    buffer_load_dwordx4 a[16:19], v1, s[36:39], s26 offen offset:0 sc1
    v_exp_f32 v184, v184
    v_mfma_f32_16x16x32_bf16 v[64:67], a[108:111], v[128:131], v[64:67]
    ds_read_b64_tr_b16 v[112:113], v12 offset:40960
    v_exp_f32 v185, v185
    v_mfma_f32_16x16x32_bf16 v[68:71], a[112:115], v[128:131], v[68:71]
    ds_read_b64_tr_b16 v[114:115], v12 offset:43008
    v_exp_f32 v188, v188
    v_mfma_f32_16x16x32_bf16 v[72:75], v[128:131], v[128:131], v[72:75]
    ds_read_b64_tr_b16 v[116:117], v13 offset:40960
    v_exp_f32 v189, v189
    v_mfma_f32_16x16x32_bf16 v[76:79], a[108:111], v[132:135], v[76:79]
    buffer_load_dwordx4 a[20:23], v1, s[36:39], s26 offen offset:1024 sc1
    v_exp_f32 v192, v192
    v_mfma_f32_16x16x32_bf16 v[80:83], a[112:115], v[132:135], v[80:83]
    ds_read_b64_tr_b16 v[118:119], v13 offset:43008
    v_exp_f32 v193, v193
    v_pk_add_f32 v[180:181], v[180:181], 1.0 op_sel_hi:[1,0]
    v_pk_add_f32 v[184:185], v[184:185], 1.0 op_sel_hi:[1,0]
    v_pk_add_f32 v[188:189], v[188:189], 1.0 op_sel_hi:[1,0]
    v_pk_add_f32 v[192:193], v[192:193], 1.0 op_sel_hi:[1,0]
    v_mfma_f32_16x16x32_bf16 v[84:87], v[132:135], v[132:135], v[84:87]
    ds_read_b64_tr_b16 v[120:121], v14 offset:40960
    v_rcp_f32 v180, v180
    s_waitcnt lgkmcnt(7)
    v_mfma_f32_16x16x32_bf16 v[88:91], a[108:111], v[136:139], v[88:91]
    ds_read_b64_tr_b16 v[122:123], v14 offset:43008
    v_rcp_f32 v181, v181
    v_mfma_f32_16x16x32_bf16 v[92:95], a[112:115], v[136:139], v[92:95]
    buffer_load_dwordx4 a[24:27], v1, s[36:39], s27 offen offset:0 sc1
    v_mfma_f32_16x16x32_bf16 v[96:99], v[136:139], v[136:139], v[96:99]
    ds_read_b64_tr_b16 v[124:125], v15 offset:40960
    v_rcp_f32 v184, v184
    s_waitcnt lgkmcnt(7)
    v_mfma_f32_16x16x32_bf16 v[100:103], a[108:111], v[140:143], v[100:103]
    ds_read_b64_tr_b16 v[126:127], v15 offset:43008
    v_rcp_f32 v185, v185
    v_mfma_f32_16x16x32_bf16 v[104:107], a[112:115], v[140:143], v[104:107]
    buffer_load_dwordx4 a[28:31], v1, s[36:39], s27 offen offset:1024 sc1
    s_add_u32 s26, s26, 4096
    s_add_u32 s27, s27, 4096
    v_mfma_f32_16x16x32_bf16 v[108:111], v[140:143], v[140:143], v[108:111]
    s_waitcnt lgkmcnt(2)
    v_rcp_f32 v188, v188
    v_mfma_f32_16x16x32_bf16 v[64:67], a[120:123], v[112:115], v[64:67]
    ds_read_b64_tr_b16 v[128:129], v12 offset:45056
    v_rcp_f32 v189, v189
    v_mfma_f32_16x16x32_bf16 v[68:71], a[124:127], v[112:115], v[68:71]
    ds_read_b64_tr_b16 v[130:131], v12 offset:47104
    v_rcp_f32 v192, v192
    v_mfma_f32_16x16x32_bf16 v[72:75], v[112:115], v[112:115], v[72:75]
    ds_read_b64_tr_b16 v[132:133], v13 offset:45056
    v_rcp_f32 v193, v193
    v_pk_mul_f32 v[180:181], v[180:181], v[182:183]
    v_pk_mul_f32 v[184:185], v[184:185], v[186:187]
    v_pk_mul_f32 v[188:189], v[188:189], v[190:191]
    v_pk_mul_f32 v[192:193], v[192:193], v[194:195]
    v_mfma_f32_16x16x32_bf16 v[76:79], a[120:123], v[116:119], v[76:79]
    buffer_load_dwordx4 a[32:35], v1, s[36:39], s26 offen offset:0 sc1
    v_cvt_pk_bf16_f32 v200, v180, v181
    v_cvt_pk_bf16_f32 v201, v184, v185
    v_mfma_f32_16x16x32_bf16 v[80:83], a[124:127], v[116:119], v[80:83]
    ds_read_b64_tr_b16 v[134:135], v13 offset:47104
    v_cvt_pk_bf16_f32 v202, v188, v189
    v_cvt_pk_bf16_f32 v203, v192, v193
    v_mfma_f32_16x16x32_bf16 v[84:87], v[116:119], v[116:119], v[84:87]
    ds_read_b64_tr_b16 v[136:137], v14 offset:45056
    v_mfma_f32_16x16x32_bf16 v[88:91], a[120:123], v[120:123], v[88:91]
    ds_read_b64_tr_b16 v[138:139], v14 offset:47104
    v_permlane32_swap_b32 v200, v202
    v_mfma_f32_16x16x32_bf16 v[92:95], a[124:127], v[120:123], v[92:95]
    buffer_load_dwordx4 a[36:39], v1, s[36:39], s26 offen offset:1024 sc1
    v_permlane32_swap_b32 v201, v203
    v_mfma_f32_16x16x32_bf16 v[96:99], v[120:123], v[120:123], v[96:99]
    ds_read_b64_tr_b16 v[140:141], v15 offset:45056
    v_permlane16_swap_b32 v200, v201
    s_waitcnt lgkmcnt(7)
    v_mfma_f32_16x16x32_bf16 v[100:103], a[120:123], v[124:127], v[100:103]
    ds_read_b64_tr_b16 v[142:143], v15 offset:47104
    v_permlane16_swap_b32 v202, v203
    v_mfma_f32_16x16x32_bf16 v[104:107], a[124:127], v[124:127], v[104:107]
    buffer_store_dwordx4 v[200:203], v6, s[36:39], s16 offen offset:256 sc1
    v_mfma_f32_16x16x32_bf16 v[108:111], v[124:127], v[124:127], v[108:111]
    ds_read_b64 v[212:213], v7
    s_waitcnt lgkmcnt(7)
    v_mfma_f32_16x16x32_bf16 v[64:67], a[132:135], v[128:131], v[64:67]
    ds_read_b64 v[214:215], v7 offset:128
    v_mfma_f32_16x16x32_bf16 v[68:71], a[136:139], v[128:131], v[68:71]
    ds_read_b64_tr_b16 v[112:113], v12 offset:49152
    buffer_load_dwordx4 a[40:43], v1, s[36:39], s27 offen offset:0 sc1
    v_mfma_f32_16x16x32_bf16 v[72:75], v[128:131], v[128:131], v[72:75]
    ds_read_b64_tr_b16 v[114:115], v12 offset:51200
    s_waitcnt lgkmcnt(8)
    v_mfma_f32_16x16x32_bf16 v[76:79], a[132:135], v[132:135], v[76:79]
    ds_read_b64_tr_b16 v[116:117], v13 offset:49152
    v_mfma_f32_16x16x32_bf16 v[80:83], a[136:139], v[132:135], v[80:83]
    ds_read_b64_tr_b16 v[118:119], v13 offset:51200
    v_mfma_f32_16x16x32_bf16 v[84:87], v[132:135], v[132:135], v[84:87]
    ds_read_b64_tr_b16 v[120:121], v14 offset:49152
    buffer_load_dwordx4 a[44:47], v1, s[36:39], s27 offen offset:1024 sc1
    s_add_u32 s26, s26, 4096
    s_add_u32 s27, s27, 4096
    s_waitcnt lgkmcnt(9)
    v_mfma_f32_16x16x32_bf16 v[88:91], a[132:135], v[136:139], v[88:91]
    ds_read_b64_tr_b16 v[122:123], v14 offset:51200
    v_mfma_f32_16x16x32_bf16 v[92:95], a[136:139], v[136:139], v[92:95]
    buffer_load_dwordx4 a[48:51], v1, s[36:39], s26 offen offset:0 sc1
    v_mfma_f32_16x16x32_bf16 v[96:99], v[136:139], v[136:139], v[96:99]
    ds_read_b64_tr_b16 v[124:125], v15 offset:49152
    s_waitcnt lgkmcnt(9)
    v_mfma_f32_16x16x32_bf16 v[100:103], a[132:135], v[140:143], v[100:103]
    ds_read_b64_tr_b16 v[126:127], v15 offset:51200
    v_mfma_f32_16x16x32_bf16 v[104:107], a[136:139], v[140:143], v[104:107]
    buffer_load_dwordx4 a[52:55], v1, s[36:39], s26 offen offset:1024 sc1
    v_mfma_f32_16x16x32_bf16 v[108:111], v[140:143], v[140:143], v[108:111]
    s_waitcnt lgkmcnt(2)
    v_mfma_f32_16x16x32_bf16 v[64:67], a[144:147], v[112:115], v[64:67]
    ds_read_b64_tr_b16 v[128:129], v12 offset:53248
    v_mfma_f32_16x16x32_bf16 v[68:71], a[148:151], v[112:115], v[68:71]
    ds_read_b64_tr_b16 v[130:131], v12 offset:55296
    v_mfma_f32_16x16x32_bf16 v[72:75], v[112:115], v[112:115], v[72:75]
    ds_read_b64_tr_b16 v[132:133], v13 offset:53248
    v_mfma_f32_16x16x32_bf16 v[76:79], a[144:147], v[116:119], v[76:79]
    buffer_load_dwordx4 a[56:59], v1, s[36:39], s27 offen offset:0 sc1
    v_mfma_f32_16x16x32_bf16 v[80:83], a[148:151], v[116:119], v[80:83]
    ds_read_b64_tr_b16 v[134:135], v13 offset:55296
    v_mfma_f32_16x16x32_bf16 v[84:87], v[116:119], v[116:119], v[84:87]
    ds_read_b64_tr_b16 v[136:137], v14 offset:53248
    v_mfma_f32_16x16x32_bf16 v[88:91], a[144:147], v[120:123], v[88:91]
    ds_read_b64_tr_b16 v[138:139], v14 offset:55296
    v_mfma_f32_16x16x32_bf16 v[92:95], a[148:151], v[120:123], v[92:95]
    buffer_load_dwordx4 a[60:63], v1, s[36:39], s27 offen offset:1024 sc1
    s_add_u32 s26, s26, 4096
    s_add_u32 s27, s27, 4096
    v_mfma_f32_16x16x32_bf16 v[96:99], v[120:123], v[120:123], v[96:99]
    ds_read_b64_tr_b16 v[140:141], v15 offset:53248
    s_waitcnt lgkmcnt(7)
    v_mfma_f32_16x16x32_bf16 v[100:103], a[144:147], v[124:127], v[100:103]
    ds_read_b64_tr_b16 v[142:143], v15 offset:55296
    v_mfma_f32_16x16x32_bf16 v[104:107], a[148:151], v[124:127], v[104:107]
    buffer_load_dwordx4 a[64:67], v1, s[36:39], s26 offen offset:0 sc1
    v_mfma_f32_16x16x32_bf16 v[108:111], v[124:127], v[124:127], v[108:111]
    s_waitcnt lgkmcnt(2)
    v_mfma_f32_16x16x32_bf16 v[64:67], a[156:159], v[128:131], v[64:67]
    ds_read_b64_tr_b16 v[112:113], v12 offset:57344
    v_mfma_f32_16x16x32_bf16 v[68:71], a[160:163], v[128:131], v[68:71]
    ds_read_b64_tr_b16 v[114:115], v12 offset:59392
    v_mfma_f32_16x16x32_bf16 v[72:75], v[128:131], v[128:131], v[72:75]
    ds_read_b64_tr_b16 v[116:117], v13 offset:57344
    v_mfma_f32_16x16x32_bf16 v[76:79], a[156:159], v[132:135], v[76:79]
    buffer_load_dwordx4 a[68:71], v1, s[36:39], s26 offen offset:1024 sc1
    v_mfma_f32_16x16x32_bf16 v[80:83], a[160:163], v[132:135], v[80:83]
    ds_read_b64_tr_b16 v[118:119], v13 offset:59392
    v_mfma_f32_16x16x32_bf16 v[84:87], v[132:135], v[132:135], v[84:87]
    ds_read_b64_tr_b16 v[120:121], v14 offset:57344
    v_mfma_f32_16x16x32_bf16 v[88:91], a[156:159], v[136:139], v[88:91]
    ds_read_b64_tr_b16 v[122:123], v14 offset:59392
    v_mfma_f32_16x16x32_bf16 v[92:95], a[160:163], v[136:139], v[92:95]
    buffer_load_dwordx4 a[72:75], v1, s[36:39], s27 offen offset:0 sc1
    v_mfma_f32_16x16x32_bf16 v[96:99], v[136:139], v[136:139], v[96:99]
    ds_read_b64_tr_b16 v[124:125], v15 offset:57344
    s_waitcnt lgkmcnt(7)
    v_mfma_f32_16x16x32_bf16 v[100:103], a[156:159], v[140:143], v[100:103]
    ds_read_b64_tr_b16 v[126:127], v15 offset:59392
    v_mfma_f32_16x16x32_bf16 v[104:107], a[160:163], v[140:143], v[104:107]
    buffer_load_dwordx4 a[76:79], v1, s[36:39], s27 offen offset:1024 sc1
    s_add_u32 s26, s26, 4096
    s_add_u32 s27, s27, 4096
    v_mfma_f32_16x16x32_bf16 v[108:111], v[140:143], v[140:143], v[108:111]
    s_waitcnt lgkmcnt(2)
    v_mfma_f32_16x16x32_bf16 v[64:67], a[168:171], v[112:115], v[64:67]
    ds_read_b64_tr_b16 v[128:129], v12 offset:61440
    v_mfma_f32_16x16x32_bf16 v[68:71], a[172:175], v[112:115], v[68:71]
    ds_read_b64_tr_b16 v[130:131], v12 offset:63488
    v_mfma_f32_16x16x32_bf16 v[72:75], v[112:115], v[112:115], v[72:75]
    ds_read_b64_tr_b16 v[132:133], v13 offset:61440
    v_mfma_f32_16x16x32_bf16 v[76:79], a[168:171], v[116:119], v[76:79]
    s_waitcnt lgkmcnt(3)
    v_mfma_f32_16x16x32_bf16 v[80:83], a[172:175], v[116:119], v[80:83]
    ds_read_b64_tr_b16 v[134:135], v13 offset:63488
    v_mfma_f32_16x16x32_bf16 v[84:87], v[116:119], v[116:119], v[84:87]
    ds_read_b64_tr_b16 v[136:137], v14 offset:61440
    v_mfma_f32_16x16x32_bf16 v[88:91], a[168:171], v[120:123], v[88:91]
    s_waitcnt vmcnt(10)
    s_mov_b64 exec, 1
    buffer_atomic_add v255, v254, s[36:39], s18 offen sc1
    s_mov_b64 exec, -1
    v_mfma_f32_16x16x32_bf16 v[92:95], a[172:175], v[120:123], v[92:95]
    ds_read_b64_tr_b16 v[138:139], v14 offset:63488
    v_mfma_f32_16x16x32_bf16 v[96:99], v[120:123], v[120:123], v[96:99]
    ds_read_b64_tr_b16 v[140:141], v15 offset:61440
    v_mfma_f32_16x16x32_bf16 v[100:103], a[168:171], v[124:127], v[100:103]
    ds_read_b64_tr_b16 v[142:143], v15 offset:63488
    v_mfma_f32_16x16x32_bf16 v[104:107], a[172:175], v[124:127], v[104:107]
    s_waitcnt lgkmcnt(3)
    v_mfma_f32_16x16x32_bf16 v[108:111], v[124:127], v[124:127], v[108:111]
    v_mfma_f32_16x16x32_bf16 v[72:75], v[128:131], v[128:131], v[72:75]
    s_waitcnt lgkmcnt(2)
    v_mfma_f32_16x16x32_bf16 v[68:71], a[184:187], v[128:131], v[68:71]
    s_waitcnt lgkmcnt(1)
    v_mfma_f32_16x16x32_bf16 v[84:87], v[132:135], v[132:135], v[84:87]
    s_waitcnt lgkmcnt(0)
    v_mfma_f32_16x16x32_bf16 v[80:83], a[184:187], v[132:135], v[80:83]
    v_mfma_f32_16x16x32_bf16 v[96:99], v[136:139], v[136:139], v[96:99]
    v_mfma_f32_16x16x32_bf16 v[92:95], a[184:187], v[136:139], v[92:95]
    v_mfma_f32_16x16x32_bf16 v[108:111], v[140:143], v[140:143], v[108:111]
    v_mfma_f32_16x16x32_bf16 v[104:107], a[184:187], v[140:143], v[104:107]
    v_mfma_f32_16x16x32_bf16 v[64:67], a[180:183], v[128:131], v[64:67]
    v_mfma_f32_16x16x32_bf16 v[76:79], a[180:183], v[132:135], v[76:79]
    v_mfma_f32_16x16x32_bf16 v[88:91], a[180:183], v[136:139], v[88:91]
    v_mfma_f32_16x16x32_bf16 v[100:103], a[180:183], v[140:143], v[100:103]
    v_cndmask_b32 v180, v72, v73, s[30:31]
    v_cndmask_b32 v188, v74, v75, s[30:31]
    v_cndmask_b32 v180, v180, v188, s[14:15]
    v_cndmask_b32 v180, 0, v180, s[32:33]
    v_cndmask_b32 v184, 0, v68, s[34:35]
    v_cndmask_b32 v181, v84, v85, s[30:31]
    v_cndmask_b32 v188, v86, v87, s[30:31]
    v_cndmask_b32 v181, v181, v188, s[14:15]
    v_cndmask_b32 v181, 0, v181, s[32:33]
    v_cndmask_b32 v185, 0, v80, s[34:35]
    v_cndmask_b32 v182, v96, v97, s[30:31]
    v_cndmask_b32 v188, v98, v99, s[30:31]
    v_cndmask_b32 v182, v182, v188, s[14:15]
    v_cndmask_b32 v182, 0, v182, s[32:33]
    v_cndmask_b32 v186, 0, v92, s[34:35]
    v_cndmask_b32 v183, v108, v109, s[30:31]
    v_cndmask_b32 v188, v110, v111, s[30:31]
    v_cndmask_b32 v183, v183, v188, s[14:15]
    v_cndmask_b32 v183, 0, v183, s[32:33]
    v_cndmask_b32 v187, 0, v104, s[34:35]
    v_permlane32_swap_b32 v180, v182
    v_permlane32_swap_b32 v181, v183
    v_permlane32_swap_b32 v184, v186
    v_permlane32_swap_b32 v185, v187
    v_add_f32 v180, v180, v182
    v_add_f32 v181, v181, v183
    v_add_f32 v184, v184, v186
    v_add_f32 v185, v185, v187
    v_permlane16_swap_b32 v180, v181
    s_nop 0
    v_permlane16_swap_b32 v184, v185
    v_add_f32 v184, v184, v185
    v_add_f32 v180, v180, v181
    v_mul_f32 v184, 0x3b000000, v184
    v_mul_f32 v180, 0x3b000000, v180
    v_fma_f32 v180, -v184, v184, v180
    v_max_f32 v180, 0, v180
    v_add_f32 v180, 0x3727c5ac, v180
    v_rsq_f32 v180, v180
    s_nop 0
    v_mul_f32 v181, -v184, v180
    ds_write_b64 v248, v[180:181] offset:512
    s_waitcnt lgkmcnt(0)
    s_barrier
    ds_read_b64 v[168:169], v249 offset:512
    ds_read_b64 v[170:171], v249 offset:640
    ds_read_b64 v[172:173], v249 offset:768
    ds_read_b64 v[174:175], v249 offset:896
    s_waitcnt lgkmcnt(3)
    v_mul_f32 v176, 0xbfb8aa3b, v168
    s_waitcnt lgkmcnt(2)
    v_mul_f32 v177, 0xbfb8aa3b, v170
    s_waitcnt lgkmcnt(1)
    v_mul_f32 v178, 0xbfb8aa3b, v172
    s_waitcnt lgkmcnt(0)
    v_mul_f32 v179, 0xbfb8aa3b, v174
    buffer_load_dwordx4 a[80:83], v1, s[36:39], s26 offen offset:0 sc1
    v_pk_fma_f32 v[180:181], v[168:169], v[144:145], v[156:157] op_sel:[1,0,0] op_sel_hi:[1,1,1]
    v_pk_fma_f32 v[182:183], v[168:169], v[146:147], v[158:159] op_sel:[1,0,0] op_sel_hi:[1,1,1]
    v_pk_fma_f32 v[180:181], v[176:177], v[64:65], v[180:181] op_sel:[0,0,0] op_sel_hi:[0,1,1]
    v_pk_fma_f32 v[184:185], v[170:171], v[144:145], v[156:157] op_sel:[1,0,0] op_sel_hi:[1,1,1]
    v_pk_fma_f32 v[186:187], v[170:171], v[146:147], v[158:159] op_sel:[1,0,0] op_sel_hi:[1,1,1]
    v_pk_fma_f32 v[184:185], v[176:177], v[76:77], v[184:185] op_sel:[1,0,0] op_sel_hi:[1,1,1]
    v_pk_fma_f32 v[188:189], v[172:173], v[144:145], v[156:157] op_sel:[1,0,0] op_sel_hi:[1,1,1]
    v_pk_fma_f32 v[190:191], v[172:173], v[146:147], v[158:159] op_sel:[1,0,0] op_sel_hi:[1,1,1]
    v_pk_fma_f32 v[188:189], v[178:179], v[88:89], v[188:189] op_sel:[0,0,0] op_sel_hi:[0,1,1]
    v_pk_fma_f32 v[192:193], v[174:175], v[144:145], v[156:157] op_sel:[1,0,0] op_sel_hi:[1,1,1]
    v_pk_fma_f32 v[194:195], v[174:175], v[146:147], v[158:159] op_sel:[1,0,0] op_sel_hi:[1,1,1]
    buffer_load_dwordx4 a[84:87], v1, s[36:39], s26 offen offset:1024 sc1
    v_pk_fma_f32 v[192:193], v[178:179], v[100:101], v[192:193] op_sel:[1,0,0] op_sel_hi:[1,1,1]
    v_exp_f32 v180, v180
    v_exp_f32 v181, v181
    s_mov_b64 exec, 1
    v_mov_b32 v253, 0
    buffer_atomic_add v253, v254, s[36:39], s20 offen sc0 sc1
    s_mov_b64 exec, -1
    v_pk_fma_f32 v[182:183], v[168:169], v[66:67], v[182:183] op_sel_hi:[0,1,1]
    v_exp_f32 v184, v184
    v_exp_f32 v185, v185
    v_pk_fma_f32 v[186:187], v[170:171], v[78:79], v[186:187] op_sel_hi:[0,1,1]
    v_exp_f32 v188, v188
    v_exp_f32 v189, v189
    v_pk_fma_f32 v[190:191], v[172:173], v[90:91], v[190:191] op_sel_hi:[0,1,1]
    v_exp_f32 v192, v192
    buffer_load_dwordx4 a[88:91], v1, s[36:39], s27 offen offset:0 sc1
    v_exp_f32 v193, v193
    v_pk_fma_f32 v[194:195], v[174:175], v[102:103], v[194:195] op_sel_hi:[0,1,1]
    v_pk_add_f32 v[180:181], v[180:181], 1.0 op_sel_hi:[1,0]
    v_pk_add_f32 v[184:185], v[184:185], 1.0 op_sel_hi:[1,0]
    v_pk_add_f32 v[188:189], v[188:189], 1.0 op_sel_hi:[1,0]
    v_pk_add_f32 v[192:193], v[192:193], 1.0 op_sel_hi:[1,0]
    v_rcp_f32 v180, v180
    v_rcp_f32 v181, v181
    v_rcp_f32 v184, v184
    v_rcp_f32 v185, v185
    v_rcp_f32 v188, v188
    buffer_load_dwordx4 a[92:95], v1, s[36:39], s27 offen offset:1024 sc1
    s_add_u32 s26, s26, 4096
    s_add_u32 s27, s27, 4096
    v_rcp_f32 v189, v189
    v_rcp_f32 v192, v192
    v_rcp_f32 v193, v193
    v_pk_mul_f32 v[180:181], v[180:181], v[182:183]
    v_pk_mul_f32 v[184:185], v[184:185], v[186:187]
    v_pk_mul_f32 v[188:189], v[188:189], v[190:191]
    v_pk_mul_f32 v[192:193], v[192:193], v[194:195]
    v_cvt_pk_bf16_f32 v196, v180, v181
    v_cvt_pk_bf16_f32 v197, v184, v185
    v_cvt_pk_bf16_f32 v198, v188, v189
    v_cvt_pk_bf16_f32 v199, v192, v193
    buffer_load_dwordx4 a[96:99], v1, s[36:39], s26 offen offset:0 sc1
    v_permlane32_swap_b32 v196, v198
    v_permlane32_swap_b32 v197, v199
    s_nop 1
    v_permlane16_swap_b32 v196, v197
    v_permlane16_swap_b32 v198, v199
    buffer_store_dwordx4 v[196:199], v6, s[36:39], s17 offen offset:0 sc1
    v_pk_fma_f32 v[180:181], v[168:169], v[148:149], v[160:161] op_sel:[1,0,0] op_sel_hi:[1,1,1]
    v_pk_fma_f32 v[182:183], v[168:169], v[150:151], v[162:163] op_sel:[1,0,0] op_sel_hi:[1,1,1]
    v_pk_fma_f32 v[180:181], v[176:177], v[68:69], v[180:181] op_sel:[0,0,0] op_sel_hi:[0,1,1]
    v_pk_fma_f32 v[184:185], v[170:171], v[148:149], v[160:161] op_sel:[1,0,0] op_sel_hi:[1,1,1]
    v_pk_fma_f32 v[186:187], v[170:171], v[150:151], v[162:163] op_sel:[1,0,0] op_sel_hi:[1,1,1]
    v_pk_fma_f32 v[184:185], v[176:177], v[80:81], v[184:185] op_sel:[1,0,0] op_sel_hi:[1,1,1]
    buffer_load_dwordx4 a[100:103], v1, s[36:39], s26 offen offset:1024 sc1
    v_pk_fma_f32 v[188:189], v[172:173], v[148:149], v[160:161] op_sel:[1,0,0] op_sel_hi:[1,1,1]
    v_pk_fma_f32 v[190:191], v[172:173], v[150:151], v[162:163] op_sel:[1,0,0] op_sel_hi:[1,1,1]
    v_pk_fma_f32 v[188:189], v[178:179], v[92:93], v[188:189] op_sel:[0,0,0] op_sel_hi:[0,1,1]
    v_pk_fma_f32 v[192:193], v[174:175], v[148:149], v[160:161] op_sel:[1,0,0] op_sel_hi:[1,1,1]
    v_pk_fma_f32 v[194:195], v[174:175], v[150:151], v[162:163] op_sel:[1,0,0] op_sel_hi:[1,1,1]
    v_pk_fma_f32 v[192:193], v[178:179], v[104:105], v[192:193] op_sel:[1,0,0] op_sel_hi:[1,1,1]
    v_exp_f32 v180, v180
    v_exp_f32 v181, v181
    v_pk_fma_f32 v[182:183], v[168:169], v[70:71], v[182:183] op_sel_hi:[0,1,1]
    v_exp_f32 v184, v184
    v_exp_f32 v185, v185
    buffer_load_dwordx4 a[104:107], v1, s[36:39], s27 offen offset:0 sc1
    v_pk_fma_f32 v[186:187], v[170:171], v[82:83], v[186:187] op_sel_hi:[0,1,1]
    v_exp_f32 v188, v188
    v_exp_f32 v189, v189
    v_pk_fma_f32 v[190:191], v[172:173], v[94:95], v[190:191] op_sel_hi:[0,1,1]
    v_exp_f32 v192, v192
    v_exp_f32 v193, v193
    v_pk_fma_f32 v[194:195], v[174:175], v[106:107], v[194:195] op_sel_hi:[0,1,1]
    v_pk_add_f32 v[180:181], v[180:181], 1.0 op_sel_hi:[1,0]
    v_pk_add_f32 v[184:185], v[184:185], 1.0 op_sel_hi:[1,0]
    v_pk_add_f32 v[188:189], v[188:189], 1.0 op_sel_hi:[1,0]
    v_pk_add_f32 v[192:193], v[192:193], 1.0 op_sel_hi:[1,0]
    buffer_load_dwordx4 a[108:111], v1, s[36:39], s27 offen offset:1024 sc1
    v_rcp_f32 v180, v180
    s_mov_b64 exec, 1
    buffer_atomic_add v255, v254, s[36:39], s19 offen sc1
    s_mov_b64 exec, -1
    v_rcp_f32 v181, v181
    v_rcp_f32 v184, v184
    v_rcp_f32 v185, v185
    v_rcp_f32 v188, v188
    v_rcp_f32 v189, v189
    v_rcp_f32 v192, v192
    v_rcp_f32 v193, v193
    v_pk_mul_f32 v[180:181], v[180:181], v[182:183]
    v_pk_mul_f32 v[184:185], v[184:185], v[186:187]
    v_pk_mul_f32 v[188:189], v[188:189], v[190:191]
    v_pk_mul_f32 v[192:193], v[192:193], v[194:195]
    v_cvt_pk_bf16_f32 v200, v180, v181
    v_cvt_pk_bf16_f32 v201, v184, v185
    s_waitcnt vmcnt(8)
    v_readfirstlane_b32 s61, v253
    s_cmp_ge_u32 s61, 16
    s_cbranch_scc1 L_pollD0S_go
    v_mov_b32 v252, 0
    s_mov_b64 exec, 1
    s_mov_b32 s62, 0
L_pollD0S:
    v_mov_b32 v253, 0
    buffer_atomic_add v253, v252, s[36:39], s20 offen sc0 sc1
    s_add_u32 s62, s62, 1
    s_cmp_ge_u32 s62, 262144
    s_cbranch_scc1 L_pollD0S_out
    s_waitcnt vmcnt(0)
    v_cmp_gt_u32 vcc, 16, v253
    s_cbranch_vccnz L_pollD0S
L_pollD0S_out:
    s_mov_b64 exec, -1
L_pollD0S_go:
    buffer_load_dwordx4 v[16:19], v1, s[36:39], s64 offen offset:0 sc1
    v_cvt_pk_bf16_f32 v202, v188, v189
    buffer_load_dwordx4 v[20:23], v1, s[36:39], s65 offen offset:0 sc1
    v_cvt_pk_bf16_f32 v203, v192, v193
    buffer_load_dwordx4 v[24:27], v1, s[36:39], s64 offen offset:1024 sc1
    v_permlane32_swap_b32 v200, v202
    buffer_load_dwordx4 v[28:31], v1, s[36:39], s65 offen offset:1024 sc1
    v_permlane32_swap_b32 v201, v203
    buffer_load_dwordx4 v[32:35], v1, s[36:39], s64 offen offset:2048 sc1
    s_nop 0
    v_permlane16_swap_b32 v200, v201
    v_permlane16_swap_b32 v202, v203
    buffer_store_dwordx4 v[200:203], v6, s[36:39], s17 offen offset:256 sc1
L_g2:
    buffer_load_dwordx4 v[36:39], v1, s[36:39], s65 offen offset:2048 sc1
    buffer_load_dwordx4 v[40:43], v1, s[36:39], s64 offen offset:3072 sc1
    buffer_load_dwordx4 v[44:47], v1, s[36:39], s65 offen offset:3072 sc1
    s_add_u32 s64, s64, 4096
    s_add_u32 s65, s65, 4096
    buffer_load_dwordx4 v[48:51], v1, s[36:39], s64 offen offset:0 sc1
    s_waitcnt vmcnt(9)
    v_mfma_f32_16x16x32_bf16 v[220:223], v[16:19], a[192:195], 0
    buffer_load_dwordx4 v[52:55], v1, s[36:39], s65 offen offset:0 sc1
    s_xor_b32 s71, s3, 1
    v_mfma_f32_16x16x32_bf16 v[224:227], v[16:19], a[196:199], 0
    s_waitcnt vmcnt(9)
    s_mul_i32 s71, s71, 6144
    s_add_u32 s71, s71, 0
    v_mfma_f32_16x16x32_bf16 v[228:231], v[16:19], a[200:203], 0
    v_add_u32 v8, s71, v1
    s_xor_b32 s71, s3, 2
    v_mfma_f32_16x16x32_bf16 v[232:235], v[16:19], a[204:207], 0
    buffer_load_dwordx4 v[56:59], v1, s[36:39], s64 offen offset:1024 sc1
    s_mul_i32 s71, s71, 6144
    v_mfma_f32_16x16x32_bf16 v[236:239], v[20:23], a[192:195], 0
    s_waitcnt vmcnt(9)
    s_add_u32 s71, s71, 2048
    v_add_u32 v9, s71, v1
    v_mfma_f32_16x16x32_bf16 v[240:243], v[20:23], a[196:199], 0
    s_xor_b32 s71, s3, 3
    s_mul_i32 s71, s71, 6144
    s_add_u32 s71, s71, 4096
    v_mfma_f32_16x16x32_bf16 v[244:247], v[20:23], a[200:203], 0
    buffer_load_dwordx4 v[60:63], v1, s[36:39], s65 offen offset:1024 sc1
    v_add_u32 v10, s71, v1
    v_mfma_f32_16x16x32_bf16 v[248:251], v[20:23], a[204:207], 0
    s_mul_i32 s71, s3, 6144
    v_add_u32 v11, s71, v1
    v_lshlrev_b32 v12, 2, v4
    v_mfma_f32_16x16x32_bf16 v[220:223], v[24:27], a[208:211], v[220:223]
    s_mov_b64 exec, 1
    v_mov_b32 v253, 0
    buffer_atomic_add v253, v254, s[36:39], s21 offen sc0 sc1
    s_mov_b64 exec, -1
    v_mfma_f32_16x16x32_bf16 v[224:227], v[24:27], a[212:215], v[224:227]
    buffer_load_dwordx4 a[112:115], v1, s[36:39], s64 offen offset:2048 sc1
    v_lshl_add_u32 v12, v5, 12, v12
    v_mfma_f32_16x16x32_bf16 v[228:231], v[24:27], a[216:219], v[228:231]
    s_waitcnt vmcnt(11)
    v_lshlrev_b32 v192, 16, v208
    v_and_b32 v193, 0xffff0000, v208
    v_lshlrev_b32 v194, 16, v209
    v_mfma_f32_16x16x32_bf16 v[232:235], v[24:27], a[220:223], v[232:235]
    v_and_b32 v195, 0xffff0000, v209
    v_lshlrev_b32 v196, 16, v210
    v_mfma_f32_16x16x32_bf16 v[236:239], v[28:31], a[208:211], v[236:239]
    buffer_load_dwordx4 a[116:119], v1, s[36:39], s65 offen offset:2048 sc1
    v_and_b32 v197, 0xffff0000, v210
    v_mfma_f32_16x16x32_bf16 v[240:243], v[28:31], a[212:215], v[240:243]
    s_waitcnt vmcnt(11)
    v_lshlrev_b32 v198, 16, v211
    v_and_b32 v199, 0xffff0000, v211
    v_mfma_f32_16x16x32_bf16 v[244:247], v[28:31], a[216:219], v[244:247]
    v_lshlrev_b32 v200, 16, v212
    v_and_b32 v201, 0xffff0000, v212
    v_mfma_f32_16x16x32_bf16 v[248:251], v[28:31], a[220:223], v[248:251]
    buffer_load_dwordx4 a[120:123], v1, s[36:39], s64 offen offset:3072 sc1
    v_lshlrev_b32 v202, 16, v213
    v_mfma_f32_16x16x32_bf16 v[220:223], v[32:35], a[224:227], v[220:223]
    s_waitcnt vmcnt(10)
    v_and_b32 v203, 0xffff0000, v213
    v_lshlrev_b32 v204, 16, v214
    v_mfma_f32_16x16x32_bf16 v[224:227], v[32:35], a[228:231], v[224:227]
    v_and_b32 v205, 0xffff0000, v214
    v_lshlrev_b32 v206, 16, v215
    v_mfma_f32_16x16x32_bf16 v[228:231], v[32:35], a[232:235], v[228:231]
    buffer_load_dwordx4 a[124:127], v1, s[36:39], s65 offen offset:3072 sc1
    s_add_u32 s64, s64, 4096
    v_mfma_f32_16x16x32_bf16 v[232:235], v[32:35], a[236:239], v[232:235]
    s_add_u32 s65, s65, 4096
    v_and_b32 v207, 0xffff0000, v215
    v_add_f32 v216, v216, v218
    v_mfma_f32_16x16x32_bf16 v[236:239], v[36:39], a[224:227], v[236:239]
    s_waitcnt vmcnt(10)
    v_add_f32 v217, v217, v219
    v_mov_b32 v218, v216
    v_mov_b32 v219, v217
    v_mfma_f32_16x16x32_bf16 v[240:243], v[36:39], a[228:231], v[240:243]
    buffer_load_dwordx4 a[128:131], v1, s[36:39], s64 offen offset:0 sc1
    v_mfma_f32_16x16x32_bf16 v[244:247], v[36:39], a[232:235], v[244:247]
    v_permlane32_swap_b32 v216, v218
    v_mfma_f32_16x16x32_bf16 v[248:251], v[36:39], a[236:239], v[248:251]
    v_permlane32_swap_b32 v217, v219
    v_mfma_f32_16x16x32_bf16 v[220:223], v[40:43], a[240:243], v[220:223]
    buffer_load_dwordx4 a[132:135], v1, s[36:39], s65 offen offset:0 sc1
    v_add_f32 v216, v216, v218
    v_mfma_f32_16x16x32_bf16 v[224:227], v[40:43], a[244:247], v[224:227]
    s_waitcnt vmcnt(11)
    v_add_f32 v217, v217, v219
    v_mov_b32 v218, v216
    v_mfma_f32_16x16x32_bf16 v[228:231], v[40:43], a[248:251], v[228:231]
    v_mov_b32 v219, v217
    v_mfma_f32_16x16x32_bf16 v[232:235], v[40:43], a[252:255], v[232:235]
    buffer_load_dwordx4 a[136:139], v1, s[36:39], s64 offen offset:1024 sc1
    v_mfma_f32_16x16x32_bf16 v[236:239], v[44:47], a[240:243], v[236:239]
    s_waitcnt vmcnt(11)
    v_permlane16_swap_b32 v216, v218
    v_mfma_f32_16x16x32_bf16 v[240:243], v[44:47], a[244:247], v[240:243]
    v_permlane16_swap_b32 v217, v219
    v_mfma_f32_16x16x32_bf16 v[244:247], v[44:47], a[248:251], v[244:247]
    buffer_load_dwordx4 a[140:143], v1, s[36:39], s65 offen offset:1024 sc1
    v_add_f32 v216, v216, v218
    v_add_f32 v217, v217, v219
    v_mfma_f32_16x16x32_bf16 v[248:251], v[44:47], a[252:255], v[248:251]
    v_cvt_pk_bf16_f32 v217, v216, v217
    v_lshlrev_b32 v216, 16, v217
    v_mfma_f32_16x16x32_bf16 v[220:223], v[48:51], a[0:3], v[220:223]
    s_waitcnt vmcnt(11)
    v_and_b32 v217, 0xffff0000, v217
    v_mfma_f32_16x16x32_bf16 v[224:227], v[48:51], a[4:7], v[224:227]
    buffer_load_dwordx4 a[144:147], v1, s[36:39], s64 offen offset:2048 sc1
    v_mfma_f32_16x16x32_bf16 v[228:231], v[48:51], a[8:11], v[228:231]
    v_mfma_f32_16x16x32_bf16 v[232:235], v[48:51], a[12:15], v[232:235]
    v_mfma_f32_16x16x32_bf16 v[236:239], v[52:55], a[0:3], v[236:239]
    buffer_load_dwordx4 a[148:151], v1, s[36:39], s65 offen offset:2048 sc1
    v_mfma_f32_16x16x32_bf16 v[240:243], v[52:55], a[4:7], v[240:243]
    s_waitcnt vmcnt(12)
    v_mfma_f32_16x16x32_bf16 v[244:247], v[52:55], a[8:11], v[244:247]
    v_mfma_f32_16x16x32_bf16 v[248:251], v[52:55], a[12:15], v[248:251]
    v_mfma_f32_16x16x32_bf16 v[220:223], v[56:59], a[16:19], v[220:223]
    s_waitcnt vmcnt(11)
    v_mfma_f32_16x16x32_bf16 v[224:227], v[56:59], a[20:23], v[224:227]
    v_mfma_f32_16x16x32_bf16 v[228:231], v[56:59], a[24:27], v[228:231]
    v_mfma_f32_16x16x32_bf16 v[232:235], v[56:59], a[28:31], v[232:235]
    v_mfma_f32_16x16x32_bf16 v[236:239], v[60:63], a[16:19], v[236:239]
    s_waitcnt vmcnt(9)
    v_mfma_f32_16x16x32_bf16 v[240:243], v[60:63], a[20:23], v[240:243]
    v_mfma_f32_16x16x32_bf16 v[244:247], v[60:63], a[24:27], v[244:247]
    v_mfma_f32_16x16x32_bf16 v[248:251], v[60:63], a[28:31], v[248:251]
    v_mfma_f32_16x16x32_bf16 v[220:223], a[112:115], a[32:35], v[220:223]
    v_readfirstlane_b32 s61, v253
    s_cmp_ge_u32 s61, 16
    s_cbranch_scc1 L_pollD1_go
    v_mov_b32 v252, 0
    s_mov_b64 exec, 1
    s_mov_b32 s62, 0
L_pollD1:
    v_mov_b32 v253, 0
    buffer_atomic_add v253, v252, s[36:39], s21 offen sc0 sc1
    s_add_u32 s62, s62, 1
    s_cmp_ge_u32 s62, 262144
    s_cbranch_scc1 L_pollD1_out
    s_waitcnt vmcnt(0)
    v_cmp_gt_u32 vcc, 16, v253
    s_cbranch_vccnz L_pollD1
L_pollD1_out:
    s_mov_b64 exec, -1
L_pollD1_go:
    v_mfma_f32_16x16x32_bf16 v[224:227], a[112:115], a[36:39], v[224:227]
    buffer_load_dwordx4 v[104:107], v1, s[36:39], s66 offen offset:0 sc1
    v_mfma_f32_16x16x32_bf16 v[228:231], a[112:115], a[40:43], v[228:231]
    s_waitcnt vmcnt(9)
    v_mfma_f32_16x16x32_bf16 v[232:235], a[112:115], a[44:47], v[232:235]
    buffer_load_dwordx4 v[108:111], v1, s[36:39], s67 offen offset:0 sc1
    v_mfma_f32_16x16x32_bf16 v[236:239], a[116:119], a[32:35], v[236:239]
    s_waitcnt vmcnt(9)
    v_mfma_f32_16x16x32_bf16 v[240:243], a[116:119], a[36:39], v[240:243]
    v_mfma_f32_16x16x32_bf16 v[244:247], a[116:119], a[40:43], v[244:247]
    buffer_load_dwordx4 v[112:115], v1, s[36:39], s66 offen offset:1024 sc1
    v_mfma_f32_16x16x32_bf16 v[248:251], a[116:119], a[44:47], v[248:251]
    s_waitcnt vmcnt(9)
    v_mfma_f32_16x16x32_bf16 v[228:231], a[120:123], a[56:59], v[228:231]
    buffer_load_dwordx4 v[116:119], v1, s[36:39], s67 offen offset:1024 sc1
    v_mfma_f32_16x16x32_bf16 v[232:235], a[120:123], a[60:63], v[232:235]
    v_mfma_f32_16x16x32_bf16 v[236:239], a[124:127], a[48:51], v[236:239]
    s_waitcnt vmcnt(9)
    v_mfma_f32_16x16x32_bf16 v[240:243], a[124:127], a[52:55], v[240:243]
    buffer_load_dwordx4 v[120:123], v1, s[36:39], s66 offen offset:2048 sc1
    v_mfma_f32_16x16x32_bf16 v[244:247], a[124:127], a[56:59], v[244:247]
    s_waitcnt vmcnt(9)
    v_mfma_f32_16x16x32_bf16 v[248:251], a[124:127], a[60:63], v[248:251]
    buffer_load_dwordx4 v[124:127], v1, s[36:39], s67 offen offset:2048 sc1
    v_mfma_f32_16x16x32_bf16 v[228:231], a[128:131], a[72:75], v[228:231]
    v_mfma_f32_16x16x32_bf16 v[232:235], a[128:131], a[76:79], v[232:235]
    v_mfma_f32_16x16x32_bf16 v[236:239], a[132:135], a[64:67], v[236:239]
    buffer_load_dwordx4 v[128:131], v1, s[36:39], s66 offen offset:3072 sc1
    v_mfma_f32_16x16x32_bf16 v[240:243], a[132:135], a[68:71], v[240:243]
    s_waitcnt vmcnt(10)
    v_mfma_f32_16x16x32_bf16 v[244:247], a[132:135], a[72:75], v[244:247]
    buffer_load_dwordx4 v[132:135], v1, s[36:39], s67 offen offset:3072 sc1
    s_add_u32 s66, s66, 4096
    s_add_u32 s67, s67, 4096
    v_mfma_f32_16x16x32_bf16 v[248:251], a[132:135], a[76:79], v[248:251]
    s_waitcnt vmcnt(10)
    v_mfma_f32_16x16x32_bf16 v[228:231], a[136:139], a[88:91], v[228:231]
    v_mfma_f32_16x16x32_bf16 v[232:235], a[136:139], a[92:95], v[232:235]
    buffer_load_dwordx4 v[136:139], v1, s[36:39], s66 offen offset:0 sc1
    v_mfma_f32_16x16x32_bf16 v[236:239], a[140:143], a[80:83], v[236:239]
    s_waitcnt vmcnt(10)
    v_mfma_f32_16x16x32_bf16 v[240:243], a[140:143], a[84:87], v[240:243]
    buffer_load_dwordx4 v[140:143], v1, s[36:39], s67 offen offset:0 sc1
    v_mfma_f32_16x16x32_bf16 v[244:247], a[140:143], a[88:91], v[244:247]
    s_waitcnt vmcnt(10)
    v_mfma_f32_16x16x32_bf16 v[248:251], a[140:143], a[92:95], v[248:251]
    v_mfma_f32_16x16x32_bf16 v[228:231], a[144:147], a[104:107], v[228:231]
    buffer_load_dwordx4 v[144:147], v1, s[36:39], s66 offen offset:1024 sc1
    v_mfma_f32_16x16x32_bf16 v[232:235], a[144:147], a[108:111], v[232:235]
    v_mfma_f32_16x16x32_bf16 v[236:239], a[148:151], a[96:99], v[236:239]
    buffer_load_dwordx4 v[148:151], v1, s[36:39], s67 offen offset:1024 sc1
    v_mfma_f32_16x16x32_bf16 v[240:243], a[148:151], a[100:103], v[240:243]
    v_mfma_f32_16x16x32_bf16 v[244:247], a[148:151], a[104:107], v[244:247]
    v_mfma_f32_16x16x32_bf16 v[248:251], a[148:151], a[108:111], v[248:251]
    buffer_load_dwordx4 v[152:155], v1, s[36:39], s66 offen offset:2048 sc1
    v_mfma_f32_16x16x32_bf16 v[220:223], a[120:123], a[48:51], v[220:223]
    v_mfma_f32_16x16x32_bf16 v[224:227], a[120:123], a[52:55], v[224:227]
    v_mfma_f32_16x16x32_bf16 v[220:223], a[128:131], a[64:67], v[220:223]
    buffer_load_dwordx4 v[156:159], v1, s[36:39], s67 offen offset:2048 sc1
    v_mfma_f32_16x16x32_bf16 v[224:227], a[128:131], a[68:71], v[224:227]
    ds_write_b128 v8, v[228:231] offset:0
    v_mfma_f32_16x16x32_bf16 v[220:223], a[136:139], a[80:83], v[220:223]
    ds_write_b128 v8, v[232:235] offset:1024
    v_mfma_f32_16x16x32_bf16 v[224:227], a[136:139], a[84:87], v[224:227]
    s_waitcnt vmcnt(13)
    v_mfma_f32_16x16x32_bf16 v[220:223], a[144:147], a[96:99], v[220:223]
    buffer_load_dwordx4 v[160:163], v1, s[36:39], s66 offen offset:3072 sc1
    v_mfma_f32_16x16x32_bf16 v[224:227], a[144:147], a[100:103], v[224:227]
    ds_write_b128 v9, v[236:239] offset:0
    v_mfma_f32_16x16x32_bf16 v[64:67], v[104:107], a[192:195], 0
    ds_write_b128 v9, v[240:243] offset:1024
    v_mfma_f32_16x16x32_bf16 v[68:71], v[104:107], a[196:199], 0
    buffer_load_dwordx4 v[164:167], v1, s[36:39], s67 offen offset:3072 sc1
    s_add_u32 s66, s66, 4096
    v_mfma_f32_16x16x32_bf16 v[72:75], v[104:107], a[200:203], 0
    ds_write_b128 v10, v[244:247] offset:0
    v_mfma_f32_16x16x32_bf16 v[76:79], v[104:107], a[204:207], 0
    s_waitcnt vmcnt(14)
    s_add_u32 s67, s67, 4096
    v_mfma_f32_16x16x32_bf16 v[80:83], v[108:111], a[192:195], 0
    ds_write_b128 v10, v[248:251] offset:1024
    v_mfma_f32_16x16x32_bf16 v[84:87], v[108:111], a[196:199], 0
    buffer_load_dwordx4 v[168:171], v1, s[36:39], s66 offen offset:0 sc1
    v_max_u32 v13, v104, v105
    v_mfma_f32_16x16x32_bf16 v[88:91], v[108:111], a[200:203], 0
    s_waitcnt vmcnt(14)
    v_max3_u32 v13, v13, v106, v107
    v_max3_u32 v13, v13, v108, v109
    v_max3_u32 v13, v13, v110, v111
    v_mfma_f32_16x16x32_bf16 v[92:95], v[108:111], a[204:207], 0
    v_mfma_f32_16x16x32_bf16 v[64:67], v[112:115], a[208:211], v[64:67]
    buffer_load_dwordx4 v[172:175], v1, s[36:39], s67 offen offset:0 sc1
    v_mfma_f32_16x16x32_bf16 v[68:71], v[112:115], a[212:215], v[68:71]
    s_waitcnt vmcnt(14)
    v_mfma_f32_16x16x32_bf16 v[72:75], v[112:115], a[216:219], v[72:75]
    v_mfma_f32_16x16x32_bf16 v[76:79], v[112:115], a[220:223], v[76:79]
    v_mfma_f32_16x16x32_bf16 v[80:83], v[116:119], a[208:211], v[80:83]
    buffer_load_dwordx4 v[176:179], v1, s[36:39], s66 offen offset:1024 sc1
    v_max3_u32 v13, v13, v112, v113
    v_mfma_f32_16x16x32_bf16 v[84:87], v[116:119], a[212:215], v[84:87]
    s_waitcnt vmcnt(14)
    v_max3_u32 v13, v13, v114, v115
    v_max3_u32 v13, v13, v116, v117
    v_mfma_f32_16x16x32_bf16 v[88:91], v[116:119], a[216:219], v[88:91]
    v_max3_u32 v13, v13, v118, v119
    v_mfma_f32_16x16x32_bf16 v[92:95], v[116:119], a[220:223], v[92:95]
    buffer_load_dwordx4 v[180:183], v1, s[36:39], s67 offen offset:1024 sc1
    v_mfma_f32_16x16x32_bf16 v[64:67], v[120:123], a[224:227], v[64:67]
    s_waitcnt vmcnt(14)
    v_mfma_f32_16x16x32_bf16 v[68:71], v[120:123], a[228:231], v[68:71]
    v_mfma_f32_16x16x32_bf16 v[72:75], v[120:123], a[232:235], v[72:75]
    s_waitcnt lgkmcnt(0)
    s_barrier
    v_mfma_f32_16x16x32_bf16 v[76:79], v[120:123], a[236:239], v[76:79]
    buffer_load_dwordx4 v[184:187], v1, s[36:39], s66 offen offset:2048 sc1
    v_mfma_f32_16x16x32_bf16 v[80:83], v[124:127], a[224:227], v[80:83]
    ds_read_b128 v[16:19], v11 offset:0
    v_max3_u32 v13, v13, v120, v121
    v_max3_u32 v13, v13, v122, v123
    v_mfma_f32_16x16x32_bf16 v[84:87], v[124:127], a[228:231], v[84:87]
    ds_read_b128 v[20:23], v11 offset:1024
    v_max3_u32 v13, v13, v124, v125
    v_mfma_f32_16x16x32_bf16 v[88:91], v[124:127], a[232:235], v[88:91]
    buffer_load_dwordx4 v[188:191], v1, s[36:39], s67 offen offset:2048 sc1
    v_max3_u32 v13, v13, v126, v127
    v_mfma_f32_16x16x32_bf16 v[92:95], v[124:127], a[236:239], v[92:95]
    ds_read_b128 v[24:27], v11 offset:2048
    s_waitcnt vmcnt(15)
    v_mfma_f32_16x16x32_bf16 v[72:75], v[128:131], a[248:251], v[72:75]
    ds_read_b128 v[28:31], v11 offset:3072
    v_mfma_f32_16x16x32_bf16 v[76:79], v[128:131], a[252:255], v[76:79]
    ds_read_b128 v[32:35], v11 offset:4096
    s_waitcnt vmcnt(14)
    v_mfma_f32_16x16x32_bf16 v[80:83], v[132:135], a[240:243], v[80:83]
    ds_read_b128 v[36:39], v11 offset:5120
    v_max3_u32 v13, v13, v128, v129
    v_max3_u32 v13, v13, v130, v131
    v_mfma_f32_16x16x32_bf16 v[84:87], v[132:135], a[244:247], v[84:87]
    s_waitcnt vmcnt(13) lgkmcnt(4)
    v_max3_u32 v13, v13, v132, v133
    v_max3_u32 v13, v13, v134, v135
    v_mfma_f32_16x16x32_bf16 v[88:91], v[132:135], a[248:251], v[88:91]
    s_waitcnt vmcnt(12) lgkmcnt(3)
    v_fmac_f32 v192, v216, v220
    v_fmac_f32 v193, v216, v221
    v_mfma_f32_16x16x32_bf16 v[92:95], v[132:135], a[252:255], v[92:95]
    s_waitcnt lgkmcnt(2)
    v_fmac_f32 v194, v216, v222
    v_fmac_f32 v195, v216, v223
    v_mfma_f32_16x16x32_bf16 v[72:75], v[136:139], a[8:11], v[72:75]
    s_waitcnt lgkmcnt(1)
    v_fmac_f32 v196, v217, v224
    v_fmac_f32 v197, v217, v225
    v_mfma_f32_16x16x32_bf16 v[76:79], v[136:139], a[12:15], v[76:79]
    s_waitcnt lgkmcnt(0)
    v_fmac_f32 v198, v217, v226
    v_fmac_f32 v199, v217, v227
    v_mfma_f32_16x16x32_bf16 v[80:83], v[140:143], a[0:3], v[80:83]
    s_waitcnt vmcnt(11)
    v_max3_u32 v13, v13, v136, v137
    v_max3_u32 v13, v13, v138, v139
    v_mfma_f32_16x16x32_bf16 v[84:87], v[140:143], a[4:7], v[84:87]
    v_max3_u32 v13, v13, v140, v141
    v_max3_u32 v13, v13, v142, v143
    v_mfma_f32_16x16x32_bf16 v[88:91], v[140:143], a[8:11], v[88:91]
    s_waitcnt vmcnt(10)
    v_fmac_f32 v192, v216, v16
    v_fmac_f32 v193, v216, v17
    v_mfma_f32_16x16x32_bf16 v[92:95], v[140:143], a[12:15], v[92:95]
    v_fmac_f32 v194, v216, v18
    v_fmac_f32 v195, v216, v19
    v_fmac_f32 v196, v217, v20
    v_mfma_f32_16x16x32_bf16 v[72:75], v[144:147], a[24:27], v[72:75]
    v_fmac_f32 v197, v217, v21
    v_fmac_f32 v198, v217, v22
    v_mfma_f32_16x16x32_bf16 v[76:79], v[144:147], a[28:31], v[76:79]
    v_fmac_f32 v199, v217, v23
    v_fmac_f32 v192, v216, v24
    v_mfma_f32_16x16x32_bf16 v[80:83], v[148:151], a[16:19], v[80:83]
    s_waitcnt vmcnt(9)
    v_max3_u32 v13, v13, v144, v145
    v_max3_u32 v13, v13, v146, v147
    v_mfma_f32_16x16x32_bf16 v[84:87], v[148:151], a[20:23], v[84:87]
    v_max3_u32 v13, v13, v148, v149
    v_max3_u32 v13, v13, v150, v151
    v_mfma_f32_16x16x32_bf16 v[88:91], v[148:151], a[24:27], v[88:91]
    s_waitcnt vmcnt(8)
    v_fmac_f32 v193, v216, v25
    v_fmac_f32 v194, v216, v26
    v_mfma_f32_16x16x32_bf16 v[92:95], v[148:151], a[28:31], v[92:95]
    v_fmac_f32 v195, v216, v27
    v_fmac_f32 v196, v217, v28
    v_mfma_f32_16x16x32_bf16 v[72:75], v[152:155], a[40:43], v[72:75]
    v_fmac_f32 v197, v217, v29
    v_fmac_f32 v198, v217, v30
    v_mfma_f32_16x16x32_bf16 v[76:79], v[152:155], a[44:47], v[76:79]
    v_fmac_f32 v199, v217, v31
    v_fmac_f32 v192, v216, v32
    v_mfma_f32_16x16x32_bf16 v[80:83], v[156:159], a[32:35], v[80:83]
    s_waitcnt vmcnt(7)
    v_max3_u32 v13, v13, v152, v153
    v_max3_u32 v13, v13, v154, v155
    v_mfma_f32_16x16x32_bf16 v[84:87], v[156:159], a[36:39], v[84:87]
    v_max3_u32 v13, v13, v156, v157
    v_max3_u32 v13, v13, v158, v159
    v_fmac_f32 v193, v216, v33
    v_mfma_f32_16x16x32_bf16 v[88:91], v[156:159], a[40:43], v[88:91]
    s_waitcnt vmcnt(6)
    v_fmac_f32 v194, v216, v34
    v_fmac_f32 v195, v216, v35
    v_mfma_f32_16x16x32_bf16 v[92:95], v[156:159], a[44:47], v[92:95]
    v_fmac_f32 v196, v217, v36
    v_fmac_f32 v197, v217, v37
    v_mfma_f32_16x16x32_bf16 v[72:75], v[160:163], a[56:59], v[72:75]
    v_fmac_f32 v198, v217, v38
    v_fmac_f32 v199, v217, v39
    v_mfma_f32_16x16x32_bf16 v[76:79], v[160:163], a[60:63], v[76:79]
    v_cvt_pk_bf16_f32 v192, v192, v196
    v_cvt_pk_bf16_f32 v193, v193, v197
    v_mfma_f32_16x16x32_bf16 v[80:83], v[164:167], a[48:51], v[80:83]
    s_waitcnt vmcnt(5)
    v_max3_u32 v13, v13, v160, v161
    v_max3_u32 v13, v13, v162, v163
    v_mfma_f32_16x16x32_bf16 v[84:87], v[164:167], a[52:55], v[84:87]
    v_max3_u32 v13, v13, v164, v165
    v_max3_u32 v13, v13, v166, v167
    v_mfma_f32_16x16x32_bf16 v[88:91], v[164:167], a[56:59], v[88:91]
    s_waitcnt vmcnt(4)
    v_cvt_pk_bf16_f32 v194, v194, v198
    v_cvt_pk_bf16_f32 v195, v195, v199
    v_mfma_f32_16x16x32_bf16 v[92:95], v[164:167], a[60:63], v[92:95]
    buffer_store_dword v192, v12, s[40:43], s12 offen offset:0 nt
    v_mfma_f32_16x16x32_bf16 v[72:75], v[168:171], a[72:75], v[72:75]
    buffer_store_dword v193, v12, s[40:43], s12 offen offset:1024 nt
    v_mfma_f32_16x16x32_bf16 v[76:79], v[168:171], a[76:79], v[76:79]
    buffer_store_dword v194, v12, s[40:43], s12 offen offset:2048 nt
    v_mfma_f32_16x16x32_bf16 v[80:83], v[172:175], a[64:67], v[80:83]
    buffer_store_dword v195, v12, s[40:43], s12 offen offset:3072 nt
    v_max3_u32 v13, v13, v168, v169
    v_mfma_f32_16x16x32_bf16 v[84:87], v[172:175], a[68:71], v[84:87]
    s_waitcnt vmcnt(7)
    v_max3_u32 v13, v13, v170, v171
    v_max3_u32 v13, v13, v172, v173
    v_mfma_f32_16x16x32_bf16 v[88:91], v[172:175], a[72:75], v[88:91]
    s_waitcnt vmcnt(6)
    v_max3_u32 v13, v13, v174, v175
    v_mfma_f32_16x16x32_bf16 v[92:95], v[172:175], a[76:79], v[92:95]
    v_mfma_f32_16x16x32_bf16 v[72:75], v[176:179], a[88:91], v[72:75]
    v_mfma_f32_16x16x32_bf16 v[76:79], v[176:179], a[92:95], v[76:79]
    v_mfma_f32_16x16x32_bf16 v[80:83], v[180:183], a[80:83], v[80:83]
    s_waitcnt vmcnt(5)
    v_max3_u32 v13, v13, v176, v177
    v_max3_u32 v13, v13, v178, v179
    v_mfma_f32_16x16x32_bf16 v[84:87], v[180:183], a[84:87], v[84:87]
    v_max3_u32 v13, v13, v180, v181
    v_max3_u32 v13, v13, v182, v183
    v_mfma_f32_16x16x32_bf16 v[88:91], v[180:183], a[88:91], v[88:91]
    s_waitcnt vmcnt(4)
    v_mfma_f32_16x16x32_bf16 v[92:95], v[180:183], a[92:95], v[92:95]
    v_mfma_f32_16x16x32_bf16 v[72:75], v[184:187], a[104:107], v[72:75]
    v_mfma_f32_16x16x32_bf16 v[76:79], v[184:187], a[108:111], v[76:79]
    v_mfma_f32_16x16x32_bf16 v[80:83], v[188:191], a[96:99], v[80:83]
    v_max3_u32 v13, v13, v184, v185
    v_max3_u32 v13, v13, v186, v187
    v_max3_u32 v13, v13, v188, v189
    v_mfma_f32_16x16x32_bf16 v[84:87], v[188:191], a[100:103], v[84:87]
    v_max3_u32 v13, v13, v190, v191
    v_mfma_f32_16x16x32_bf16 v[88:91], v[188:191], a[104:107], v[88:91]
    v_mfma_f32_16x16x32_bf16 v[92:95], v[188:191], a[108:111], v[92:95]
    v_mfma_f32_16x16x32_bf16 v[64:67], v[128:131], a[240:243], v[64:67]
    v_cmp_eq_u32 vcc, -1, v13
    s_cbranch_vccnz L_fix
L_fixed:
    v_mfma_f32_16x16x32_bf16 v[68:71], v[128:131], a[244:247], v[68:71]
    ds_write_b128 v8, v[72:75] offset:32768
    v_mfma_f32_16x16x32_bf16 v[64:67], v[136:139], a[0:3], v[64:67]
    ds_write_b128 v8, v[76:79] offset:33792
    v_mfma_f32_16x16x32_bf16 v[68:71], v[136:139], a[4:7], v[68:71]
    ds_write_b128 v9, v[80:83] offset:32768
    v_mfma_f32_16x16x32_bf16 v[64:67], v[144:147], a[16:19], v[64:67]
    ds_write_b128 v9, v[84:87] offset:33792
    v_mfma_f32_16x16x32_bf16 v[68:71], v[144:147], a[20:23], v[68:71]
    ds_write_b128 v10, v[88:91] offset:32768
    v_mfma_f32_16x16x32_bf16 v[64:67], v[152:155], a[32:35], v[64:67]
    ds_write_b128 v10, v[92:95] offset:33792
    v_mfma_f32_16x16x32_bf16 v[68:71], v[152:155], a[36:39], v[68:71]
    v_mfma_f32_16x16x32_bf16 v[64:67], v[160:163], a[48:51], v[64:67]
    v_mfma_f32_16x16x32_bf16 v[68:71], v[160:163], a[52:55], v[68:71]
    v_mfma_f32_16x16x32_bf16 v[64:67], v[168:171], a[64:67], v[64:67]
    v_mfma_f32_16x16x32_bf16 v[68:71], v[168:171], a[68:71], v[68:71]
    s_waitcnt lgkmcnt(0)
    s_barrier
    v_mfma_f32_16x16x32_bf16 v[64:67], v[176:179], a[80:83], v[64:67]
    ds_read_b128 v[16:19], v11 offset:32768
    v_mfma_f32_16x16x32_bf16 v[68:71], v[176:179], a[84:87], v[68:71]
    ds_read_b128 v[20:23], v11 offset:33792
    v_mfma_f32_16x16x32_bf16 v[64:67], v[184:187], a[96:99], v[64:67]
    ds_read_b128 v[24:27], v11 offset:34816
    v_mfma_f32_16x16x32_bf16 v[68:71], v[184:187], a[100:103], v[68:71]
    ds_read_b128 v[28:31], v11 offset:35840
    ds_read_b128 v[32:35], v11 offset:36864
    ds_read_b128 v[36:39], v11 offset:37888
    s_waitcnt lgkmcnt(5)
    v_pk_fma_f32 v[200:201], v[216:217], v[16:17], v[200:201] op_sel:[0,0,0] op_sel_hi:[0,1,1]
    v_pk_fma_f32 v[202:203], v[216:217], v[18:19], v[202:203] op_sel:[0,0,0] op_sel_hi:[0,1,1]
    s_waitcnt lgkmcnt(4)
    v_pk_fma_f32 v[204:205], v[216:217], v[20:21], v[204:205] op_sel:[1,0,0] op_sel_hi:[1,1,1]
    v_pk_fma_f32 v[206:207], v[216:217], v[22:23], v[206:207] op_sel:[1,0,0] op_sel_hi:[1,1,1]
    s_waitcnt lgkmcnt(3)
    v_pk_fma_f32 v[200:201], v[216:217], v[24:25], v[200:201] op_sel:[0,0,0] op_sel_hi:[0,1,1]
    v_pk_fma_f32 v[202:203], v[216:217], v[26:27], v[202:203] op_sel:[0,0,0] op_sel_hi:[0,1,1]
    s_waitcnt lgkmcnt(2)
    v_pk_fma_f32 v[204:205], v[216:217], v[28:29], v[204:205] op_sel:[1,0,0] op_sel_hi:[1,1,1]
    v_pk_fma_f32 v[206:207], v[216:217], v[30:31], v[206:207] op_sel:[1,0,0] op_sel_hi:[1,1,1]
    s_waitcnt lgkmcnt(1)
    v_pk_fma_f32 v[200:201], v[216:217], v[32:33], v[200:201] op_sel:[0,0,0] op_sel_hi:[0,1,1]
    v_pk_fma_f32 v[202:203], v[216:217], v[34:35], v[202:203] op_sel:[0,0,0] op_sel_hi:[0,1,1]
    s_waitcnt lgkmcnt(0)
    v_pk_fma_f32 v[204:205], v[216:217], v[36:37], v[204:205] op_sel:[1,0,0] op_sel_hi:[1,1,1]
    v_pk_fma_f32 v[206:207], v[216:217], v[38:39], v[206:207] op_sel:[1,0,0] op_sel_hi:[1,1,1]
    v_pk_fma_f32 v[200:201], v[216:217], v[64:65], v[200:201] op_sel:[0,0,0] op_sel_hi:[0,1,1]
    v_pk_fma_f32 v[202:203], v[216:217], v[66:67], v[202:203] op_sel:[0,0,0] op_sel_hi:[0,1,1]
    v_pk_fma_f32 v[204:205], v[216:217], v[68:69], v[204:205] op_sel:[1,0,0] op_sel_hi:[1,1,1]
    v_pk_fma_f32 v[206:207], v[216:217], v[70:71], v[206:207] op_sel:[1,0,0] op_sel_hi:[1,1,1]
    v_cvt_pk_bf16_f32 v200, v200, v204
    v_cvt_pk_bf16_f32 v201, v201, v205
    v_cvt_pk_bf16_f32 v202, v202, v206
    v_cvt_pk_bf16_f32 v203, v203, v207
    buffer_store_dword v200, v12, s[40:43], s13 offen offset:0 nt
    buffer_store_dword v201, v12, s[40:43], s13 offen offset:1024 nt
    buffer_store_dword v202, v12, s[40:43], s13 offen offset:2048 nt
    buffer_store_dword v203, v12, s[40:43], s13 offen offset:3072 nt
L_exit:
    s_endpgm
code_hot_end:
L_fix:
    s_mov_b32 s62, 0
    s_waitcnt vmcnt(0) lgkmcnt(0)
L_fix_loop:
    s_sub_u32 s66, s66, 8192
    s_sub_u32 s67, s67, 8192
    buffer_load_dwordx4 v[104:107], v1, s[36:39], s66 offen offset:0 sc1
    buffer_load_dwordx4 v[108:111], v1, s[36:39], s67 offen offset:0 sc1
    buffer_load_dwordx4 v[112:115], v1, s[36:39], s66 offen offset:1024 sc1
    buffer_load_dwordx4 v[116:119], v1, s[36:39], s67 offen offset:1024 sc1
    buffer_load_dwordx4 v[120:123], v1, s[36:39], s66 offen offset:2048 sc1
    buffer_load_dwordx4 v[124:127], v1, s[36:39], s67 offen offset:2048 sc1
    buffer_load_dwordx4 v[128:131], v1, s[36:39], s66 offen offset:3072 sc1
    buffer_load_dwordx4 v[132:135], v1, s[36:39], s67 offen offset:3072 sc1
    s_add_u32 s66, s66, 4096
    s_add_u32 s67, s67, 4096
    buffer_load_dwordx4 v[136:139], v1, s[36:39], s66 offen offset:0 sc1
    buffer_load_dwordx4 v[140:143], v1, s[36:39], s67 offen offset:0 sc1
    buffer_load_dwordx4 v[144:147], v1, s[36:39], s66 offen offset:1024 sc1
    buffer_load_dwordx4 v[148:151], v1, s[36:39], s67 offen offset:1024 sc1
    buffer_load_dwordx4 v[152:155], v1, s[36:39], s66 offen offset:2048 sc1
    buffer_load_dwordx4 v[156:159], v1, s[36:39], s67 offen offset:2048 sc1
    buffer_load_dwordx4 v[160:163], v1, s[36:39], s66 offen offset:3072 sc1
    buffer_load_dwordx4 v[164:167], v1, s[36:39], s67 offen offset:3072 sc1
    s_add_u32 s66, s66, 4096
    s_add_u32 s67, s67, 4096
    buffer_load_dwordx4 v[168:171], v1, s[36:39], s66 offen offset:0 sc1
    buffer_load_dwordx4 v[172:175], v1, s[36:39], s67 offen offset:0 sc1
    buffer_load_dwordx4 v[176:179], v1, s[36:39], s66 offen offset:1024 sc1
    buffer_load_dwordx4 v[180:183], v1, s[36:39], s67 offen offset:1024 sc1
    buffer_load_dwordx4 v[184:187], v1, s[36:39], s66 offen offset:2048 sc1
    buffer_load_dwordx4 v[188:191], v1, s[36:39], s67 offen offset:2048 sc1
    s_waitcnt vmcnt(0)
    v_max_u32 v13, v104, v105
    v_max3_u32 v13, v13, v106, v107
    v_max3_u32 v13, v13, v108, v109
    v_max3_u32 v13, v13, v110, v111
    v_max3_u32 v13, v13, v112, v113
    v_max3_u32 v13, v13, v114, v115
    v_max3_u32 v13, v13, v116, v117
    v_max3_u32 v13, v13, v118, v119
    v_max3_u32 v13, v13, v120, v121
    v_max3_u32 v13, v13, v122, v123
    v_max3_u32 v13, v13, v124, v125
    v_max3_u32 v13, v13, v126, v127
    v_max3_u32 v13, v13, v128, v129
    v_max3_u32 v13, v13, v130, v131
    v_max3_u32 v13, v13, v132, v133
    v_max3_u32 v13, v13, v134, v135
    v_max3_u32 v13, v13, v136, v137
    v_max3_u32 v13, v13, v138, v139
    v_max3_u32 v13, v13, v140, v141
    v_max3_u32 v13, v13, v142, v143
    v_max3_u32 v13, v13, v144, v145
    v_max3_u32 v13, v13, v146, v147
    v_max3_u32 v13, v13, v148, v149
    v_max3_u32 v13, v13, v150, v151
    v_max3_u32 v13, v13, v152, v153
    v_max3_u32 v13, v13, v154, v155
    v_max3_u32 v13, v13, v156, v157
    v_max3_u32 v13, v13, v158, v159
    v_max3_u32 v13, v13, v160, v161
    v_max3_u32 v13, v13, v162, v163
    v_max3_u32 v13, v13, v164, v165
    v_max3_u32 v13, v13, v166, v167
    v_max3_u32 v13, v13, v168, v169
    v_max3_u32 v13, v13, v170, v171
    v_max3_u32 v13, v13, v172, v173
    v_max3_u32 v13, v13, v174, v175
    v_max3_u32 v13, v13, v176, v177
    v_max3_u32 v13, v13, v178, v179
    v_max3_u32 v13, v13, v180, v181
    v_max3_u32 v13, v13, v182, v183
    v_max3_u32 v13, v13, v184, v185
    v_max3_u32 v13, v13, v186, v187
    v_max3_u32 v13, v13, v188, v189
    v_max3_u32 v13, v13, v190, v191
    s_add_u32 s62, s62, 1
    s_cmp_ge_u32 s62, 4096
    s_cbranch_scc1 L_fix_go
    v_cmp_eq_u32 vcc, -1, v13
    s_cbranch_vccnz L_fix_loop
L_fix_go:
    v_mfma_f32_16x16x32_bf16 v[64:67], v[104:107], a[192:195], 0
    v_mfma_f32_16x16x32_bf16 v[68:71], v[104:107], a[196:199], 0
    v_mfma_f32_16x16x32_bf16 v[72:75], v[104:107], a[200:203], 0
    v_mfma_f32_16x16x32_bf16 v[76:79], v[104:107], a[204:207], 0
    v_mfma_f32_16x16x32_bf16 v[80:83], v[108:111], a[192:195], 0
    v_mfma_f32_16x16x32_bf16 v[84:87], v[108:111], a[196:199], 0
    v_mfma_f32_16x16x32_bf16 v[88:91], v[108:111], a[200:203], 0
    v_mfma_f32_16x16x32_bf16 v[92:95], v[108:111], a[204:207], 0
    v_mfma_f32_16x16x32_bf16 v[64:67], v[112:115], a[208:211], v[64:67]
    v_mfma_f32_16x16x32_bf16 v[68:71], v[112:115], a[212:215], v[68:71]
    v_mfma_f32_16x16x32_bf16 v[72:75], v[112:115], a[216:219], v[72:75]
    v_mfma_f32_16x16x32_bf16 v[76:79], v[112:115], a[220:223], v[76:79]
    v_mfma_f32_16x16x32_bf16 v[80:83], v[116:119], a[208:211], v[80:83]
    v_mfma_f32_16x16x32_bf16 v[84:87], v[116:119], a[212:215], v[84:87]
    v_mfma_f32_16x16x32_bf16 v[88:91], v[116:119], a[216:219], v[88:91]
    v_mfma_f32_16x16x32_bf16 v[92:95], v[116:119], a[220:223], v[92:95]
    v_mfma_f32_16x16x32_bf16 v[64:67], v[120:123], a[224:227], v[64:67]
    v_mfma_f32_16x16x32_bf16 v[68:71], v[120:123], a[228:231], v[68:71]
    v_mfma_f32_16x16x32_bf16 v[72:75], v[120:123], a[232:235], v[72:75]
    v_mfma_f32_16x16x32_bf16 v[76:79], v[120:123], a[236:239], v[76:79]
    v_mfma_f32_16x16x32_bf16 v[80:83], v[124:127], a[224:227], v[80:83]
    v_mfma_f32_16x16x32_bf16 v[84:87], v[124:127], a[228:231], v[84:87]
    v_mfma_f32_16x16x32_bf16 v[88:91], v[124:127], a[232:235], v[88:91]
    v_mfma_f32_16x16x32_bf16 v[92:95], v[124:127], a[236:239], v[92:95]
    v_mfma_f32_16x16x32_bf16 v[72:75], v[128:131], a[248:251], v[72:75]
    v_mfma_f32_16x16x32_bf16 v[76:79], v[128:131], a[252:255], v[76:79]
    v_mfma_f32_16x16x32_bf16 v[80:83], v[132:135], a[240:243], v[80:83]
    v_mfma_f32_16x16x32_bf16 v[84:87], v[132:135], a[244:247], v[84:87]
    v_mfma_f32_16x16x32_bf16 v[88:91], v[132:135], a[248:251], v[88:91]
    v_mfma_f32_16x16x32_bf16 v[92:95], v[132:135], a[252:255], v[92:95]
    v_mfma_f32_16x16x32_bf16 v[72:75], v[136:139], a[8:11], v[72:75]
    v_mfma_f32_16x16x32_bf16 v[76:79], v[136:139], a[12:15], v[76:79]
    v_mfma_f32_16x16x32_bf16 v[80:83], v[140:143], a[0:3], v[80:83]
    v_mfma_f32_16x16x32_bf16 v[84:87], v[140:143], a[4:7], v[84:87]
    v_mfma_f32_16x16x32_bf16 v[88:91], v[140:143], a[8:11], v[88:91]
    v_mfma_f32_16x16x32_bf16 v[92:95], v[140:143], a[12:15], v[92:95]
    v_mfma_f32_16x16x32_bf16 v[72:75], v[144:147], a[24:27], v[72:75]
    v_mfma_f32_16x16x32_bf16 v[76:79], v[144:147], a[28:31], v[76:79]
    v_mfma_f32_16x16x32_bf16 v[80:83], v[148:151], a[16:19], v[80:83]
    v_mfma_f32_16x16x32_bf16 v[84:87], v[148:151], a[20:23], v[84:87]
    v_mfma_f32_16x16x32_bf16 v[88:91], v[148:151], a[24:27], v[88:91]
    v_mfma_f32_16x16x32_bf16 v[92:95], v[148:151], a[28:31], v[92:95]
    v_mfma_f32_16x16x32_bf16 v[72:75], v[152:155], a[40:43], v[72:75]
    v_mfma_f32_16x16x32_bf16 v[76:79], v[152:155], a[44:47], v[76:79]
    v_mfma_f32_16x16x32_bf16 v[80:83], v[156:159], a[32:35], v[80:83]
    v_mfma_f32_16x16x32_bf16 v[84:87], v[156:159], a[36:39], v[84:87]
    v_mfma_f32_16x16x32_bf16 v[88:91], v[156:159], a[40:43], v[88:91]
    v_mfma_f32_16x16x32_bf16 v[92:95], v[156:159], a[44:47], v[92:95]
    v_mfma_f32_16x16x32_bf16 v[72:75], v[160:163], a[56:59], v[72:75]
    v_mfma_f32_16x16x32_bf16 v[76:79], v[160:163], a[60:63], v[76:79]
    v_mfma_f32_16x16x32_bf16 v[80:83], v[164:167], a[48:51], v[80:83]
    v_mfma_f32_16x16x32_bf16 v[84:87], v[164:167], a[52:55], v[84:87]
    v_mfma_f32_16x16x32_bf16 v[88:91], v[164:167], a[56:59], v[88:91]
    v_mfma_f32_16x16x32_bf16 v[92:95], v[164:167], a[60:63], v[92:95]
    v_mfma_f32_16x16x32_bf16 v[72:75], v[168:171], a[72:75], v[72:75]
    v_mfma_f32_16x16x32_bf16 v[76:79], v[168:171], a[76:79], v[76:79]
    v_mfma_f32_16x16x32_bf16 v[80:83], v[172:175], a[64:67], v[80:83]
    v_mfma_f32_16x16x32_bf16 v[84:87], v[172:175], a[68:71], v[84:87]
    v_mfma_f32_16x16x32_bf16 v[88:91], v[172:175], a[72:75], v[88:91]
    v_mfma_f32_16x16x32_bf16 v[92:95], v[172:175], a[76:79], v[92:95]
    v_mfma_f32_16x16x32_bf16 v[72:75], v[176:179], a[88:91], v[72:75]
    v_mfma_f32_16x16x32_bf16 v[76:79], v[176:179], a[92:95], v[76:79]
    v_mfma_f32_16x16x32_bf16 v[80:83], v[180:183], a[80:83], v[80:83]
    v_mfma_f32_16x16x32_bf16 v[84:87], v[180:183], a[84:87], v[84:87]
    v_mfma_f32_16x16x32_bf16 v[88:91], v[180:183], a[88:91], v[88:91]
    v_mfma_f32_16x16x32_bf16 v[92:95], v[180:183], a[92:95], v[92:95]
    v_mfma_f32_16x16x32_bf16 v[72:75], v[184:187], a[104:107], v[72:75]
    v_mfma_f32_16x16x32_bf16 v[76:79], v[184:187], a[108:111], v[76:79]
    v_mfma_f32_16x16x32_bf16 v[80:83], v[188:191], a[96:99], v[80:83]
    v_mfma_f32_16x16x32_bf16 v[84:87], v[188:191], a[100:103], v[84:87]
    v_mfma_f32_16x16x32_bf16 v[88:91], v[188:191], a[104:107], v[88:91]
    v_mfma_f32_16x16x32_bf16 v[92:95], v[188:191], a[108:111], v[92:95]
    v_mfma_f32_16x16x32_bf16 v[64:67], v[128:131], a[240:243], v[64:67]
    s_nop 7
    s_branch L_fixed
code_end:

.section .rodata,"a"
.p2align 6
.amdhsa_kernel adaLN_cond__ssm_conv_s4d__glu_gated_glu__prompt_kernel
  .amdhsa_next_free_vgpr 512
  .amdhsa_next_free_sgpr 102
  .amdhsa_accum_offset 256
  .amdhsa_group_segment_fixed_size 0
  .amdhsa_kernarg_size 128
  .amdhsa_user_sgpr_count 2
  .amdhsa_user_sgpr_kernarg_segment_ptr 1
  .amdhsa_system_sgpr_workgroup_id_x 1
.end_amdhsa_kernel
```
